```python
import torch

def _softmax(x, axis=-1):
    return torch.softmax(x, dim=axis)
def _gelu(x):
    return torch.nn.functional.gelu(x, approximate="tanh")
def _silu(x):
    return torch.nn.functional.silu(x)
def _sigmoid(x):
    return torch.sigmoid(x)
def _layernorm(x, axis=-1, eps=1e-5):
    m = x.mean(dim=axis, keepdim=True)
    v = x.var(dim=axis, keepdim=True, unbiased=False)
    return (x - m) / torch.sqrt(v + eps)
def _scatter_add(tgt, idx, src, axis=0):
    return tgt.clone().index_add_(axis, idx, src)
def _segment_sum(src, seg, n):
    out = torch.zeros((n,) + src.shape[1:], dtype=src.dtype)
    return out.index_add_(0, seg, src)
def _pad(x, pw):
    flat = tuple(v for pair in reversed(pw) for v in pair)
    return torch.nn.functional.pad(x, flat)

kernel_name = 'parallel_sum__sliding_block__glu_gated_geglu__prompt'

def setup_inputs():

    _w = (lambda a: (lambda t: t.to(torch.bfloat16) if t.is_floating_point() else t)(torch.as_tensor(a)))
    def _A_setup():
        B, S, D = 1, 2048, 512
        return {
            "x": _w((lambda *s: torch.randn(*s, dtype=torch.bfloat16) * 0.05)(B, S, D)),
            "wqkv": _w((lambda *s: torch.randn(*s, dtype=torch.bfloat16) * 0.05)(D, 3 * D)),
            "wo": _w((lambda *s: torch.randn(*s, dtype=torch.bfloat16) * 0.05)(D, D)),
        }
    _A_in = _A_setup()

    def _B_setup():
        B, S, Dm, Df = 1, 2048, 512, 1792
        return {
            "x": _w((lambda *s: torch.randn(*s, dtype=torch.bfloat16) * 0.05)(B, S, Dm)),
            "w_gate": _w((lambda *s: torch.randn(*s, dtype=torch.bfloat16) * 0.8)(Dm, Df) * (Dm ** -0.5)),
            "w_up": _w((lambda *s: torch.randn(*s, dtype=torch.bfloat16) * 0.8)(Dm, Df) * (Dm ** -0.5)),
            "w_down": _w((lambda *s: torch.randn(*s, dtype=torch.bfloat16) * 0.8)(Df, Dm) * (Df ** -0.5)),
        }
    _B_in = _B_setup()

    return {
        "A_x": _A_in["x"],
        "A_wqkv": _A_in["wqkv"],
        "A_wo": _A_in["wo"],
        "B_x": _B_in["x"],
        "B_w_gate": _B_in["w_gate"],
        "B_w_up": _B_in["w_up"],
        "B_w_down": _B_in["w_down"],
    }

def reference(A_x, A_wqkv, A_wo, B_x, B_w_gate, B_w_up, B_w_down):
    def _A_ref(x, wqkv, wo):
        B, S, D = x.shape
        H = 32; Dh = D // H; W = 256
        qkv = (lambda x, *d: x.permute(*d))((x @ wqkv).reshape(B, S, 3, H, Dh), 2, 0, 3, 1, 4)
        q, k, v = qkv[0], qkv[1], qkv[2]
        scores = torch.einsum("bhqd,bhkd->bhqk", q, k) * (Dh ** -0.5)
        idx = torch.arange(S)
        mask = (idx[:, None] - idx[None, :] >= 0) & (idx[:, None] - idx[None, :] < W)
        scores = torch.where(mask[None, None], scores, -1e9)
        p = _softmax(scores, axis=-1)
        o = torch.einsum("bhqk,bhkd->bhqd", p, v)
        return (lambda x, *d: x.permute(*d))(o, 0, 2, 1, 3).reshape(B, S, D) @ wo

    def _B_ref(x, w_gate, w_up, w_down):
        g = torch.einsum("bsd,df->bsf", x, w_gate)
        u = torch.einsum("bsd,df->bsf", x, w_up)
        h = _gelu(g) * u
        return torch.einsum("bsf,fd->bsd", h, w_down)

    x = A_x
    xn = _layernorm(x, axis=-1)
    return x + _A_ref(xn, A_wqkv, A_wo) + _B_ref(xn, B_w_gate, B_w_up, B_w_down)
```

```asm
; @launch grid=(256,1,1) block=(512,1,1) lds=163840
.amdgcn_target "amdgcn-amd-amdhsa--gfx950"
.text
.globl parallel_sum__sliding_block__glu_gated_geglu__prompt_kernel
.p2align 8
.type parallel_sum__sliding_block__glu_gated_geglu__prompt_kernel,@function
parallel_sum__sliding_block__glu_gated_geglu__prompt_kernel:
    s_cmp_ge_u32 s2, 256
    s_cbranch_scc1 L_end
    s_load_dwordx16 s[76:91], s[0:1], 0
    s_load_dwordx4 s[92:95], s[0:1], 64
    v_lshrrev_b32 v1, 6, v0
    v_and_b32 v251, 63, v0
    v_readfirstlane_b32 s40, v1
    s_and_b32 s56, s2, 7
    s_lshr_b32 s57, s2, 3
    s_and_b32 s58, s56, 1
    s_lshl_b32 s58, s58, 3
    s_and_b32 s59, s57, 7
    s_add_u32 s41, s58, s59
    s_lshr_b32 s42, s56, 1
    s_lshr_b32 s43, s57, 3
    s_lshl_b32 s58, s56, 2
    s_and_b32 s59, s57, 3
    s_add_u32 s65, s58, s59
    s_lshr_b32 s66, s57, 2
    v_lshlrev_b32 v250, 4, v251
    s_lshl_b32 s56, s41, 7
    s_lshl_b32 s57, s40, 4
    s_add_u32 s56, s56, s57
    s_lshl_b32 s56, s56, 10
    s_lshl_b32 s57, s40, 14
    s_waitcnt lgkmcnt(0)
    s_mov_b32 s4, s76
    s_and_b32 s5, s77, 0xffff
    s_mov_b32 s6, 0x200000
    s_mov_b32 s7, 0x00020000
    v_xor_b32 v224, 0, v250
    s_add_u32 s58, s56, 0
    s_add_u32 m0, s57, 32768
    s_nop 0
    buffer_load_dwordx4 v224, s[4:7], s58 offen lds
    v_xor_b32 v225, 16, v250
    s_add_u32 s58, s56, 1024
    s_add_u32 m0, s57, 33792
    s_nop 0
    buffer_load_dwordx4 v225, s[4:7], s58 offen lds
    v_xor_b32 v224, 32, v250
    s_add_u32 s58, s56, 2048
    s_add_u32 m0, s57, 34816
    s_nop 0
    buffer_load_dwordx4 v224, s[4:7], s58 offen lds
    v_xor_b32 v225, 48, v250
    s_add_u32 s58, s56, 3072
    s_add_u32 m0, s57, 35840
    s_nop 0
    buffer_load_dwordx4 v225, s[4:7], s58 offen lds
    v_xor_b32 v224, 64, v250
    s_add_u32 s58, s56, 4096
    s_add_u32 m0, s57, 36864
    s_nop 0
    s_nop 0
    buffer_load_dwordx4 v224, s[4:7], s58 offen lds
    v_xor_b32 v225, 80, v250
    s_add_u32 s58, s56, 5120
    s_add_u32 m0, s57, 37888
    s_nop 0
    s_nop 0
    buffer_load_dwordx4 v225, s[4:7], s58 offen lds
    v_xor_b32 v224, 96, v250
    s_add_u32 s58, s56, 6144
    s_add_u32 m0, s57, 38912
    s_nop 0
    s_nop 0
    buffer_load_dwordx4 v224, s[4:7], s58 offen lds
    v_xor_b32 v225, 112, v250
    s_add_u32 s58, s56, 7168
    s_add_u32 m0, s57, 39936
    s_nop 0
    s_nop 0
    buffer_load_dwordx4 v225, s[4:7], s58 offen lds
    v_xor_b32 v224, 128, v250
    s_add_u32 s58, s56, 8192
    s_add_u32 m0, s57, 40960
    s_nop 0
    s_nop 0
    buffer_load_dwordx4 v224, s[4:7], s58 offen lds
    v_xor_b32 v225, 144, v250
    s_add_u32 s58, s56, 9216
    s_add_u32 m0, s57, 41984
    s_nop 0
    s_nop 0
    buffer_load_dwordx4 v225, s[4:7], s58 offen lds
    v_xor_b32 v224, 160, v250
    s_add_u32 s58, s56, 10240
    s_add_u32 m0, s57, 43008
    s_nop 0
    s_nop 0
    buffer_load_dwordx4 v224, s[4:7], s58 offen lds
    v_xor_b32 v225, 176, v250
    s_add_u32 s58, s56, 11264
    s_add_u32 m0, s57, 44032
    s_nop 0
    s_nop 0
    buffer_load_dwordx4 v225, s[4:7], s58 offen lds
    v_xor_b32 v224, 192, v250
    s_add_u32 s58, s56, 12288
    s_add_u32 m0, s57, 45056
    s_nop 0
    s_nop 0
    buffer_load_dwordx4 v224, s[4:7], s58 offen lds
    v_xor_b32 v225, 208, v250
    s_add_u32 s58, s56, 13312
    s_add_u32 m0, s57, 46080
    s_nop 0
    s_nop 0
    buffer_load_dwordx4 v225, s[4:7], s58 offen lds
    v_xor_b32 v224, 224, v250
    s_add_u32 s58, s56, 14336
    s_add_u32 m0, s57, 47104
    s_nop 0
    s_nop 0
    buffer_load_dwordx4 v224, s[4:7], s58 offen lds
    v_xor_b32 v225, 240, v250
    s_add_u32 s58, s56, 15360
    s_add_u32 m0, s57, 48128
    s_nop 0
    buffer_load_dwordx4 v225, s[4:7], s58 offen lds
    s_mov_b32 s8, s78
    s_and_b32 s9, s79, 0xffff
    s_mov_b32 s10, 0x180000
    s_mov_b32 s11, 0x00020000
    s_mov_b32 s24, s80
    s_and_b32 s25, s81, 0xffff
    s_mov_b32 s26, 0x80000
    s_mov_b32 s27, 0x00020000
    s_mov_b32 s12, s84
    s_and_b32 s13, s85, 0xffff
    s_mov_b32 s14, 0x1c0000
    s_mov_b32 s15, 0x00020000
    s_mov_b32 s16, s86
    s_and_b32 s17, s87, 0xffff
    s_mov_b32 s18, 0x1c0000
    s_mov_b32 s19, 0x00020000
    s_mov_b32 s20, s88
    s_and_b32 s21, s89, 0xffff
    s_mov_b32 s22, 0x1c0000
    s_mov_b32 s23, 0x00020000
    s_mov_b32 s28, s90
    s_and_b32 s29, s91, 0xffff
    s_mov_b32 s30, 0x200000
    s_mov_b32 s31, 0x00020000
    s_mov_b32 s36, s92
    s_and_b32 s37, s93, 0xffff
    s_mov_b32 s38, 0x100
    s_mov_b32 s39, 0x00020000
    s_mov_b32 s32, s94
    s_and_b32 s33, s95, 0xffff
    s_mov_b32 s34, 0x1004000
    s_mov_b32 s35, 0x00020000
    s_and_b32 s44, s40, 3
    s_lshr_b32 s45, s40, 2
    s_lshl_b32 s46, s40, 10
    s_mov_b32 s60, 0x3f803f80
    s_mov_b32 s61, 0xffff0000
    s_lshl_b32 s95, s42, 2
    s_add_u32 s95, s95, s43
    s_lshl_b32 s95, s95, 2
    s_or_b32 s56, s2, s40
    s_cmp_lg_u32 s56, 0
    s_cbranch_scc1 L_noep_1
    s_memrealtime s[58:59]
    s_waitcnt lgkmcnt(0)
    s_or_b32 s58, s58, 1
    v_mov_b32 v247, s58
    buffer_store_dword v247, off, s[36:39], 0 sc0 sc1
    s_nop 1
L_noep_1:
    v_and_b32 v226, 15, v251
    v_lshrrev_b32 v227, 4, v251
    s_add_u32 s56, s57, 32768
    v_lshlrev_b32 v228, 10, v226
    v_add_u32 v228, s56, v228
    v_and_b32 v229, 3, v226
    v_xor_b32 v229, v229, v227
    v_lshl_add_u32 v228, v229, 4, v228
    v_lshrrev_b32 v229, 2, v226
    v_xor_b32 v230, 0, v229
    v_lshl_add_u32 v160, v230, 6, v228
    v_xor_b32 v230, 1, v229
    v_lshl_add_u32 v161, v230, 6, v228
    v_xor_b32 v230, 2, v229
    v_lshl_add_u32 v162, v230, 6, v228
    v_xor_b32 v230, 3, v229
    v_lshl_add_u32 v163, v230, 6, v228
    s_lshl_b32 s56, s44, 15
    s_add_u32 s56, s56, 32768
    v_and_b32 v228, 31, v251
    v_lshlrev_b32 v228, 10, v228
    v_add_u32 v228, s56, v228
    v_lshrrev_b32 v229, 5, v251
    v_xor_b32 v230, v229, v226
    v_lshl_add_u32 v164, v230, 4, v228
    v_lshrrev_b32 v228, 2, v226
    v_lshl_add_u32 v228, v229, 3, v228
    v_lshlrev_b32 v228, 7, v228
    v_and_b32 v230, 1, v227
    v_lshl_add_u32 v228, v230, 5, v228
    v_lshlrev_b32 v231, 16, v230
    v_lshl_add_u32 v231, v229, 9, v231
    v_lshl_add_u32 v231, v226, 4, v231
    v_and_b32 v230, 3, v226
    v_lshl_add_u32 v228, v230, 3, v228
    v_bfe_u32 v230, v226, 3, 1
    v_xor_b32 v230, s45, v230
    v_lshl_add_u32 v243, v230, 6, v228
    v_add_u32 v244, 0x10000, v243
    v_add_u32 v245, 0x20000, v243
    v_lshrrev_b32 v228, 3, v251
    v_and_b32 v229, 7, v251
    v_bfe_u32 v230, v228, 1, 1
    v_lshlrev_b32 v230, 2, v230
    v_xor_b32 v229, v229, v230
    v_lshlrev_b32 v229, 4, v229
    s_lshl_b32 s56, s40, 3
    v_add_u32 v228, s56, v228
    s_movk_i32 s56, 3072
    s_movk_i32 s57, 3584
    v_mad_u32_u24 v252, v228, s56, v229
    v_mad_u32_u24 v253, v228, s57, v229
    v_mov_b32 v233, v251
    v_mov_b32 v251, v231
    s_cmp_eq_u32 s43, 3
    s_nop 1
    s_cbranch_scc1 L_typeB_2
    s_lshl_b32 s59, s41, 2
    s_add_u32 s59, s59, s44
    s_mul_i32 s58, s59, 144
    s_lshl_b32 s57, s45, 1
    s_add_u32 s58, s58, s57
    s_mul_i32 s56, s42, 7
    s_lshl_b32 s47, s43, 10
    s_lshl_b32 s76, s42, 7
    s_add_u32 s47, s47, s76
    s_add_u32 s47, s47, 512
    s_lshl_b32 s51, s43, 5
    s_lshl_b32 s76, s42, 2
    s_add_u32 s51, s51, s76
    s_add_u32 s51, s51, 16
    s_add_u32 s51, s51, s57
    s_lshl_b32 s51, s51, 6
    s_add_u32 s51, s51, s59
    s_lshl_b32 s51, s51, 10
    s_lshl_b32 s76, s43, 1
    s_add_u32 s56, s56, s76
    s_add_u32 s76, s56, 0
    s_lshl_b32 s48, s76, 7
    s_lshl_b32 s76, s76, 2
    s_add_u32 s76, s76, s58
    s_lshl_b32 s76, s76, 10
    s_add_u32 s52, s76, 0x600000
    s_add_u32 s76, s56, 1
    s_lshl_b32 s49, s76, 7
    s_lshl_b32 s76, s76, 2
    s_add_u32 s76, s76, s58
    s_lshl_b32 s76, s76, 10
    s_add_u32 s53, s76, 0x600000
    s_cmp_eq_u32 s43, 0
    s_cselect_b32 s64, 0x3eb8aa3b, 1.0
    s_bfe_u32 s56, s2, 0x30003
    s_lshl_b32 s56, s56, 3
    s_add_u32 s56, s56, s40
    s_lshl_b32 s56, s56, 3
    v_and_b32 v236, 7, v233
    v_add_u32 v236, s56, v236
    v_lshrrev_b32 v237, 3, v233
    s_movk_i32 s56, 3072
    s_movk_i32 s57, 3584
    v_lshlrev_b32 v238, 10, v237
    v_mad_u32_u24 v238, v236, s56, v238
    v_lshlrev_b32 v239, 7, v237
    v_mad_u32_u24 v239, v236, s57, v239
    s_add_u32 s58, s47, 0
    s_add_u32 s59, s48, 0
    s_mov_b64 exec, 0xff
    buffer_load_dword v156, v238, s[8:11], s58 offen
    s_mov_b64 exec, -1
    s_nop 0
    buffer_load_dword v247, off, s[36:39], 0 sc0 sc1
    buffer_load_dword v155, off, s[32:35], s51
    buffer_load_dword v155, off, s[32:35], s52
    buffer_load_dword v155, off, s[32:35], s53
    s_lshl_b32 s56, s65, 16
    s_lshl_b32 s57, s66, 7
    s_add_u32 s56, s56, s57
    buffer_load_dword v155, off, s[28:31], s56
    buffer_load_dword v155, off, s[24:27], s57
    buffer_load_dword v155, off, s[20:23], s57
    v_mov_b32 v128, 0
    v_mov_b32 v129, 0
    v_mov_b32 v130, 0
    v_mov_b32 v131, 0
    v_mov_b32 v132, 0
    v_mov_b32 v133, 0
    v_mov_b32 v134, 0
    v_mov_b32 v135, 0
    s_waitcnt vmcnt(8)
    ds_read_b128 v[0:3], v160 offset:0
    ds_read_b128 v[4:7], v161 offset:0
    ds_read_b128 v[8:11], v162 offset:0
    ds_read_b128 v[12:15], v163 offset:0
    ds_read_b128 v[16:19], v160 offset:256
    ds_read_b128 v[20:23], v161 offset:256
    ds_read_b128 v[24:27], v162 offset:256
    ds_read_b128 v[28:31], v163 offset:256
    ds_read_b128 v[32:35], v160 offset:512
    ds_read_b128 v[36:39], v161 offset:512
    ds_read_b128 v[40:43], v162 offset:512
    ds_read_b128 v[44:47], v163 offset:512
    ds_read_b128 v[48:51], v160 offset:768
    ds_read_b128 v[52:55], v161 offset:768
    ds_read_b128 v[56:59], v162 offset:768
    ds_read_b128 v[60:63], v163 offset:768
    s_waitcnt lgkmcnt(14)
    v_dot2c_f32_bf16 v128, s60, v0
    v_dot2c_f32_bf16 v132, v0, v0
    v_dot2c_f32_bf16 v129, s60, v1
    v_dot2c_f32_bf16 v133, v1, v1
    v_dot2c_f32_bf16 v130, s60, v2
    v_dot2c_f32_bf16 v134, v2, v2
    v_dot2c_f32_bf16 v131, s60, v3
    v_dot2c_f32_bf16 v135, v3, v3
    v_dot2c_f32_bf16 v128, s60, v4
    v_dot2c_f32_bf16 v132, v4, v4
    v_dot2c_f32_bf16 v129, s60, v5
    v_dot2c_f32_bf16 v133, v5, v5
    v_dot2c_f32_bf16 v130, s60, v6
    v_dot2c_f32_bf16 v134, v6, v6
    v_dot2c_f32_bf16 v131, s60, v7
    v_dot2c_f32_bf16 v135, v7, v7
    s_waitcnt lgkmcnt(12)
    v_dot2c_f32_bf16 v128, s60, v8
    v_dot2c_f32_bf16 v132, v8, v8
    v_dot2c_f32_bf16 v129, s60, v9
    v_dot2c_f32_bf16 v133, v9, v9
    v_dot2c_f32_bf16 v130, s60, v10
    v_dot2c_f32_bf16 v134, v10, v10
    v_dot2c_f32_bf16 v131, s60, v11
    v_dot2c_f32_bf16 v135, v11, v11
    v_dot2c_f32_bf16 v128, s60, v12
    v_dot2c_f32_bf16 v132, v12, v12
    v_dot2c_f32_bf16 v129, s60, v13
    v_dot2c_f32_bf16 v133, v13, v13
    v_dot2c_f32_bf16 v130, s60, v14
    v_dot2c_f32_bf16 v134, v14, v14
    v_dot2c_f32_bf16 v131, s60, v15
    v_dot2c_f32_bf16 v135, v15, v15
    s_waitcnt lgkmcnt(10)
    v_dot2c_f32_bf16 v128, s60, v16
    v_dot2c_f32_bf16 v132, v16, v16
    v_dot2c_f32_bf16 v129, s60, v17
    v_dot2c_f32_bf16 v133, v17, v17
    v_dot2c_f32_bf16 v130, s60, v18
    v_dot2c_f32_bf16 v134, v18, v18
    v_dot2c_f32_bf16 v131, s60, v19
    v_dot2c_f32_bf16 v135, v19, v19
    v_dot2c_f32_bf16 v128, s60, v20
    v_dot2c_f32_bf16 v132, v20, v20
    v_dot2c_f32_bf16 v129, s60, v21
    v_dot2c_f32_bf16 v133, v21, v21
    v_dot2c_f32_bf16 v130, s60, v22
    v_dot2c_f32_bf16 v134, v22, v22
    v_dot2c_f32_bf16 v131, s60, v23
    v_dot2c_f32_bf16 v135, v23, v23
    s_waitcnt lgkmcnt(8)
    v_dot2c_f32_bf16 v128, s60, v24
    v_dot2c_f32_bf16 v132, v24, v24
    v_dot2c_f32_bf16 v129, s60, v25
    v_dot2c_f32_bf16 v133, v25, v25
    v_dot2c_f32_bf16 v130, s60, v26
    v_dot2c_f32_bf16 v134, v26, v26
    v_dot2c_f32_bf16 v131, s60, v27
    v_dot2c_f32_bf16 v135, v27, v27
    v_dot2c_f32_bf16 v128, s60, v28
    v_dot2c_f32_bf16 v132, v28, v28
    v_dot2c_f32_bf16 v129, s60, v29
    v_dot2c_f32_bf16 v133, v29, v29
    v_dot2c_f32_bf16 v130, s60, v30
    v_dot2c_f32_bf16 v134, v30, v30
    v_dot2c_f32_bf16 v131, s60, v31
    v_dot2c_f32_bf16 v135, v31, v31
    s_waitcnt lgkmcnt(6)
    v_dot2c_f32_bf16 v128, s60, v32
    v_dot2c_f32_bf16 v132, v32, v32
    v_dot2c_f32_bf16 v129, s60, v33
    v_dot2c_f32_bf16 v133, v33, v33
    v_dot2c_f32_bf16 v130, s60, v34
    v_dot2c_f32_bf16 v134, v34, v34
    v_dot2c_f32_bf16 v131, s60, v35
    v_dot2c_f32_bf16 v135, v35, v35
    v_dot2c_f32_bf16 v128, s60, v36
    v_dot2c_f32_bf16 v132, v36, v36
    v_dot2c_f32_bf16 v129, s60, v37
    v_dot2c_f32_bf16 v133, v37, v37
    v_dot2c_f32_bf16 v130, s60, v38
    v_dot2c_f32_bf16 v134, v38, v38
    v_dot2c_f32_bf16 v131, s60, v39
    v_dot2c_f32_bf16 v135, v39, v39
    s_waitcnt lgkmcnt(4)
    v_dot2c_f32_bf16 v128, s60, v40
    v_dot2c_f32_bf16 v132, v40, v40
    v_dot2c_f32_bf16 v129, s60, v41
    v_dot2c_f32_bf16 v133, v41, v41
    v_dot2c_f32_bf16 v130, s60, v42
    v_dot2c_f32_bf16 v134, v42, v42
    v_dot2c_f32_bf16 v131, s60, v43
    v_dot2c_f32_bf16 v135, v43, v43
    v_dot2c_f32_bf16 v128, s60, v44
    v_dot2c_f32_bf16 v132, v44, v44
    v_dot2c_f32_bf16 v129, s60, v45
    v_dot2c_f32_bf16 v133, v45, v45
    v_dot2c_f32_bf16 v130, s60, v46
    v_dot2c_f32_bf16 v134, v46, v46
    v_dot2c_f32_bf16 v131, s60, v47
    v_dot2c_f32_bf16 v135, v47, v47
    s_waitcnt lgkmcnt(2)
    v_dot2c_f32_bf16 v128, s60, v48
    v_dot2c_f32_bf16 v132, v48, v48
    v_dot2c_f32_bf16 v129, s60, v49
    v_dot2c_f32_bf16 v133, v49, v49
    v_dot2c_f32_bf16 v130, s60, v50
    v_dot2c_f32_bf16 v134, v50, v50
    v_dot2c_f32_bf16 v131, s60, v51
    v_dot2c_f32_bf16 v135, v51, v51
    v_dot2c_f32_bf16 v128, s60, v52
    v_dot2c_f32_bf16 v132, v52, v52
    v_dot2c_f32_bf16 v129, s60, v53
    v_dot2c_f32_bf16 v133, v53, v53
    v_dot2c_f32_bf16 v130, s60, v54
    v_dot2c_f32_bf16 v134, v54, v54
    v_dot2c_f32_bf16 v131, s60, v55
    v_dot2c_f32_bf16 v135, v55, v55
    s_waitcnt lgkmcnt(0)
    v_dot2c_f32_bf16 v128, s60, v56
    v_dot2c_f32_bf16 v132, v56, v56
    v_dot2c_f32_bf16 v129, s60, v57
    v_dot2c_f32_bf16 v133, v57, v57
    v_dot2c_f32_bf16 v130, s60, v58
    v_dot2c_f32_bf16 v134, v58, v58
    v_dot2c_f32_bf16 v131, s60, v59
    v_dot2c_f32_bf16 v135, v59, v59
    v_dot2c_f32_bf16 v128, s60, v60
    v_dot2c_f32_bf16 v132, v60, v60
    v_dot2c_f32_bf16 v129, s60, v61
    v_dot2c_f32_bf16 v133, v61, v61
    v_dot2c_f32_bf16 v130, s60, v62
    v_dot2c_f32_bf16 v134, v62, v62
    v_dot2c_f32_bf16 v131, s60, v63
    v_dot2c_f32_bf16 v135, v63, v63
    v_add_f32 v128, v128, v129
    s_nop 0
    v_add_f32 v130, v130, v131
    v_add_f32 v132, v132, v133
    v_add_f32 v134, v134, v135
    v_add_f32 v136, v128, v130
    v_add_f32 v137, v132, v134
    v_mov_b32 v128, v136
    v_mov_b32 v129, v137
    s_nop 0
    v_permlane16_swap_b32 v136, v128
    v_permlane16_swap_b32 v137, v129
    v_add_f32 v136, v136, v128
    v_add_f32 v137, v137, v129
    v_mov_b32 v128, v136
    v_mov_b32 v129, v137
    s_nop 0
    v_permlane32_swap_b32 v136, v128
    v_permlane32_swap_b32 v137, v129
    v_add_f32 v136, v136, v128
    v_add_f32 v137, v137, v129
    s_mov_b32 s56, 0x3b000000
    s_mov_b32 s57, 0x3727c5ac
    v_mul_f32 v136, s56, v136
    v_mul_f32 v137, s56, v137
    v_fma_f32 v137, -v136, v136, v137
    v_max_f32 v137, 0, v137
    v_cvt_pk_bf16_f32 v128, v136, v137
    v_lshlrev_b32 v136, 16, v128
    v_and_b32 v137, s61, v128
    v_add_f32 v137, s57, v137
    v_cvt_pk_bf16_f32 v128, v137, v137
    v_and_b32 v137, s61, v128
    v_sqrt_f32 v137, v137
    s_nop 0
    v_cvt_pk_bf16_f32 v128, v137, v137
    v_and_b32 v137, s61, v128
    v_rcp_f32 v137, v137
    s_nop 0
    v_mul_f32 v136, v136, v137
    v_sub_f32 v136, 0, v136
    v_lshlrev_b32 v224, 16, v0
    v_and_b32 v225, s61, v0
    v_lshlrev_b32 v226, 16, v1
    v_and_b32 v227, s61, v1
    v_lshlrev_b32 v228, 16, v2
    v_and_b32 v229, s61, v2
    v_lshlrev_b32 v230, 16, v3
    v_and_b32 v231, s61, v3
    s_nop 0
    v_pk_fma_f32 v[224:225], v[224:225], v[136:137], v[136:137] op_sel:[0,1,0] op_sel_hi:[1,1,0]
    v_pk_fma_f32 v[226:227], v[226:227], v[136:137], v[136:137] op_sel:[0,1,0] op_sel_hi:[1,1,0]
    v_pk_fma_f32 v[228:229], v[228:229], v[136:137], v[136:137] op_sel:[0,1,0] op_sel_hi:[1,1,0]
    v_pk_fma_f32 v[230:231], v[230:231], v[136:137], v[136:137] op_sel:[0,1,0] op_sel_hi:[1,1,0]
    v_cvt_pk_bf16_f32 v0, v224, v225
    v_cvt_pk_bf16_f32 v1, v226, v227
    v_cvt_pk_bf16_f32 v2, v228, v229
    v_cvt_pk_bf16_f32 v3, v230, v231
    ds_write_b128 v160, v[0:3] offset:0
    v_lshlrev_b32 v224, 16, v4
    v_and_b32 v225, s61, v4
    v_lshlrev_b32 v226, 16, v5
    v_and_b32 v227, s61, v5
    v_lshlrev_b32 v228, 16, v6
    v_and_b32 v229, s61, v6
    v_lshlrev_b32 v230, 16, v7
    v_and_b32 v231, s61, v7
    v_pk_fma_f32 v[224:225], v[224:225], v[136:137], v[136:137] op_sel:[0,1,0] op_sel_hi:[1,1,0]
    v_pk_fma_f32 v[226:227], v[226:227], v[136:137], v[136:137] op_sel:[0,1,0] op_sel_hi:[1,1,0]
    v_pk_fma_f32 v[228:229], v[228:229], v[136:137], v[136:137] op_sel:[0,1,0] op_sel_hi:[1,1,0]
    v_pk_fma_f32 v[230:231], v[230:231], v[136:137], v[136:137] op_sel:[0,1,0] op_sel_hi:[1,1,0]
    v_cvt_pk_bf16_f32 v4, v224, v225
    v_cvt_pk_bf16_f32 v5, v226, v227
    v_cvt_pk_bf16_f32 v6, v228, v229
    v_cvt_pk_bf16_f32 v7, v230, v231
    ds_write_b128 v161, v[4:7] offset:0
    v_lshlrev_b32 v224, 16, v8
    v_and_b32 v225, s61, v8
    v_lshlrev_b32 v226, 16, v9
    v_and_b32 v227, s61, v9
    v_lshlrev_b32 v228, 16, v10
    v_and_b32 v229, s61, v10
    v_lshlrev_b32 v230, 16, v11
    v_and_b32 v231, s61, v11
    v_pk_fma_f32 v[224:225], v[224:225], v[136:137], v[136:137] op_sel:[0,1,0] op_sel_hi:[1,1,0]
    v_pk_fma_f32 v[226:227], v[226:227], v[136:137], v[136:137] op_sel:[0,1,0] op_sel_hi:[1,1,0]
    v_pk_fma_f32 v[228:229], v[228:229], v[136:137], v[136:137] op_sel:[0,1,0] op_sel_hi:[1,1,0]
    v_pk_fma_f32 v[230:231], v[230:231], v[136:137], v[136:137] op_sel:[0,1,0] op_sel_hi:[1,1,0]
    v_cvt_pk_bf16_f32 v8, v224, v225
    v_cvt_pk_bf16_f32 v9, v226, v227
    v_cvt_pk_bf16_f32 v10, v228, v229
    v_cvt_pk_bf16_f32 v11, v230, v231
    ds_write_b128 v162, v[8:11] offset:0
    v_lshlrev_b32 v224, 16, v12
    v_and_b32 v225, s61, v12
    v_lshlrev_b32 v226, 16, v13
    v_and_b32 v227, s61, v13
    v_lshlrev_b32 v228, 16, v14
    v_and_b32 v229, s61, v14
    v_lshlrev_b32 v230, 16, v15
    v_and_b32 v231, s61, v15
    v_pk_fma_f32 v[224:225], v[224:225], v[136:137], v[136:137] op_sel:[0,1,0] op_sel_hi:[1,1,0]
    v_pk_fma_f32 v[226:227], v[226:227], v[136:137], v[136:137] op_sel:[0,1,0] op_sel_hi:[1,1,0]
    v_pk_fma_f32 v[228:229], v[228:229], v[136:137], v[136:137] op_sel:[0,1,0] op_sel_hi:[1,1,0]
    v_pk_fma_f32 v[230:231], v[230:231], v[136:137], v[136:137] op_sel:[0,1,0] op_sel_hi:[1,1,0]
    v_cvt_pk_bf16_f32 v12, v224, v225
    v_cvt_pk_bf16_f32 v13, v226, v227
    v_cvt_pk_bf16_f32 v14, v228, v229
    v_cvt_pk_bf16_f32 v15, v230, v231
    ds_write_b128 v163, v[12:15] offset:0
    v_lshlrev_b32 v224, 16, v16
    v_and_b32 v225, s61, v16
    v_lshlrev_b32 v226, 16, v17
    v_and_b32 v227, s61, v17
    v_lshlrev_b32 v228, 16, v18
    v_and_b32 v229, s61, v18
    v_lshlrev_b32 v230, 16, v19
    v_and_b32 v231, s61, v19
    v_pk_fma_f32 v[224:225], v[224:225], v[136:137], v[136:137] op_sel:[0,1,0] op_sel_hi:[1,1,0]
    v_pk_fma_f32 v[226:227], v[226:227], v[136:137], v[136:137] op_sel:[0,1,0] op_sel_hi:[1,1,0]
    v_pk_fma_f32 v[228:229], v[228:229], v[136:137], v[136:137] op_sel:[0,1,0] op_sel_hi:[1,1,0]
    v_pk_fma_f32 v[230:231], v[230:231], v[136:137], v[136:137] op_sel:[0,1,0] op_sel_hi:[1,1,0]
    v_cvt_pk_bf16_f32 v16, v224, v225
    v_cvt_pk_bf16_f32 v17, v226, v227
    v_cvt_pk_bf16_f32 v18, v228, v229
    v_cvt_pk_bf16_f32 v19, v230, v231
    ds_write_b128 v160, v[16:19] offset:256
    v_lshlrev_b32 v224, 16, v20
    v_and_b32 v225, s61, v20
    v_lshlrev_b32 v226, 16, v21
    v_and_b32 v227, s61, v21
    v_lshlrev_b32 v228, 16, v22
    v_and_b32 v229, s61, v22
    v_lshlrev_b32 v230, 16, v23
    v_and_b32 v231, s61, v23
    v_pk_fma_f32 v[224:225], v[224:225], v[136:137], v[136:137] op_sel:[0,1,0] op_sel_hi:[1,1,0]
    v_pk_fma_f32 v[226:227], v[226:227], v[136:137], v[136:137] op_sel:[0,1,0] op_sel_hi:[1,1,0]
    v_pk_fma_f32 v[228:229], v[228:229], v[136:137], v[136:137] op_sel:[0,1,0] op_sel_hi:[1,1,0]
    v_pk_fma_f32 v[230:231], v[230:231], v[136:137], v[136:137] op_sel:[0,1,0] op_sel_hi:[1,1,0]
    v_cvt_pk_bf16_f32 v20, v224, v225
    v_cvt_pk_bf16_f32 v21, v226, v227
    v_cvt_pk_bf16_f32 v22, v228, v229
    v_cvt_pk_bf16_f32 v23, v230, v231
    ds_write_b128 v161, v[20:23] offset:256
    v_lshlrev_b32 v224, 16, v24
    v_and_b32 v225, s61, v24
    v_lshlrev_b32 v226, 16, v25
    v_and_b32 v227, s61, v25
    v_lshlrev_b32 v228, 16, v26
    v_and_b32 v229, s61, v26
    v_lshlrev_b32 v230, 16, v27
    v_and_b32 v231, s61, v27
    v_pk_fma_f32 v[224:225], v[224:225], v[136:137], v[136:137] op_sel:[0,1,0] op_sel_hi:[1,1,0]
    v_pk_fma_f32 v[226:227], v[226:227], v[136:137], v[136:137] op_sel:[0,1,0] op_sel_hi:[1,1,0]
    v_pk_fma_f32 v[228:229], v[228:229], v[136:137], v[136:137] op_sel:[0,1,0] op_sel_hi:[1,1,0]
    v_pk_fma_f32 v[230:231], v[230:231], v[136:137], v[136:137] op_sel:[0,1,0] op_sel_hi:[1,1,0]
    v_cvt_pk_bf16_f32 v24, v224, v225
    v_cvt_pk_bf16_f32 v25, v226, v227
    v_cvt_pk_bf16_f32 v26, v228, v229
    v_cvt_pk_bf16_f32 v27, v230, v231
    ds_write_b128 v162, v[24:27] offset:256
    v_lshlrev_b32 v224, 16, v28
    v_and_b32 v225, s61, v28
    v_lshlrev_b32 v226, 16, v29
    v_and_b32 v227, s61, v29
    v_lshlrev_b32 v228, 16, v30
    v_and_b32 v229, s61, v30
    v_lshlrev_b32 v230, 16, v31
    v_and_b32 v231, s61, v31
    v_pk_fma_f32 v[224:225], v[224:225], v[136:137], v[136:137] op_sel:[0,1,0] op_sel_hi:[1,1,0]
    v_pk_fma_f32 v[226:227], v[226:227], v[136:137], v[136:137] op_sel:[0,1,0] op_sel_hi:[1,1,0]
    v_pk_fma_f32 v[228:229], v[228:229], v[136:137], v[136:137] op_sel:[0,1,0] op_sel_hi:[1,1,0]
    v_pk_fma_f32 v[230:231], v[230:231], v[136:137], v[136:137] op_sel:[0,1,0] op_sel_hi:[1,1,0]
    v_cvt_pk_bf16_f32 v28, v224, v225
    v_cvt_pk_bf16_f32 v29, v226, v227
    v_cvt_pk_bf16_f32 v30, v228, v229
    v_cvt_pk_bf16_f32 v31, v230, v231
    ds_write_b128 v163, v[28:31] offset:256
    v_lshlrev_b32 v224, 16, v32
    v_and_b32 v225, s61, v32
    v_lshlrev_b32 v226, 16, v33
    v_and_b32 v227, s61, v33
    v_lshlrev_b32 v228, 16, v34
    v_and_b32 v229, s61, v34
    v_lshlrev_b32 v230, 16, v35
    v_and_b32 v231, s61, v35
    v_pk_fma_f32 v[224:225], v[224:225], v[136:137], v[136:137] op_sel:[0,1,0] op_sel_hi:[1,1,0]
    v_pk_fma_f32 v[226:227], v[226:227], v[136:137], v[136:137] op_sel:[0,1,0] op_sel_hi:[1,1,0]
    v_pk_fma_f32 v[228:229], v[228:229], v[136:137], v[136:137] op_sel:[0,1,0] op_sel_hi:[1,1,0]
    v_pk_fma_f32 v[230:231], v[230:231], v[136:137], v[136:137] op_sel:[0,1,0] op_sel_hi:[1,1,0]
    v_cvt_pk_bf16_f32 v32, v224, v225
    v_cvt_pk_bf16_f32 v33, v226, v227
    v_cvt_pk_bf16_f32 v34, v228, v229
    v_cvt_pk_bf16_f32 v35, v230, v231
    ds_write_b128 v160, v[32:35] offset:512
    v_lshlrev_b32 v224, 16, v36
    v_and_b32 v225, s61, v36
    v_lshlrev_b32 v226, 16, v37
    v_and_b32 v227, s61, v37
    v_lshlrev_b32 v228, 16, v38
    v_and_b32 v229, s61, v38
    v_lshlrev_b32 v230, 16, v39
    v_and_b32 v231, s61, v39
    v_pk_fma_f32 v[224:225], v[224:225], v[136:137], v[136:137] op_sel:[0,1,0] op_sel_hi:[1,1,0]
    v_pk_fma_f32 v[226:227], v[226:227], v[136:137], v[136:137] op_sel:[0,1,0] op_sel_hi:[1,1,0]
    v_pk_fma_f32 v[228:229], v[228:229], v[136:137], v[136:137] op_sel:[0,1,0] op_sel_hi:[1,1,0]
    v_pk_fma_f32 v[230:231], v[230:231], v[136:137], v[136:137] op_sel:[0,1,0] op_sel_hi:[1,1,0]
    v_cvt_pk_bf16_f32 v36, v224, v225
    v_cvt_pk_bf16_f32 v37, v226, v227
    v_cvt_pk_bf16_f32 v38, v228, v229
    v_cvt_pk_bf16_f32 v39, v230, v231
    ds_write_b128 v161, v[36:39] offset:512
    v_lshlrev_b32 v224, 16, v40
    v_and_b32 v225, s61, v40
    v_lshlrev_b32 v226, 16, v41
    v_and_b32 v227, s61, v41
    v_lshlrev_b32 v228, 16, v42
    v_and_b32 v229, s61, v42
    v_lshlrev_b32 v230, 16, v43
    v_and_b32 v231, s61, v43
    v_pk_fma_f32 v[224:225], v[224:225], v[136:137], v[136:137] op_sel:[0,1,0] op_sel_hi:[1,1,0]
    v_pk_fma_f32 v[226:227], v[226:227], v[136:137], v[136:137] op_sel:[0,1,0] op_sel_hi:[1,1,0]
    v_pk_fma_f32 v[228:229], v[228:229], v[136:137], v[136:137] op_sel:[0,1,0] op_sel_hi:[1,1,0]
    v_pk_fma_f32 v[230:231], v[230:231], v[136:137], v[136:137] op_sel:[0,1,0] op_sel_hi:[1,1,0]
    v_cvt_pk_bf16_f32 v40, v224, v225
    v_cvt_pk_bf16_f32 v41, v226, v227
    v_cvt_pk_bf16_f32 v42, v228, v229
    v_cvt_pk_bf16_f32 v43, v230, v231
    ds_write_b128 v162, v[40:43] offset:512
    v_lshlrev_b32 v224, 16, v44
    v_and_b32 v225, s61, v44
    v_lshlrev_b32 v226, 16, v45
    v_and_b32 v227, s61, v45
    v_lshlrev_b32 v228, 16, v46
    v_and_b32 v229, s61, v46
    v_lshlrev_b32 v230, 16, v47
    v_and_b32 v231, s61, v47
    v_pk_fma_f32 v[224:225], v[224:225], v[136:137], v[136:137] op_sel:[0,1,0] op_sel_hi:[1,1,0]
    v_pk_fma_f32 v[226:227], v[226:227], v[136:137], v[136:137] op_sel:[0,1,0] op_sel_hi:[1,1,0]
    v_pk_fma_f32 v[228:229], v[228:229], v[136:137], v[136:137] op_sel:[0,1,0] op_sel_hi:[1,1,0]
    v_pk_fma_f32 v[230:231], v[230:231], v[136:137], v[136:137] op_sel:[0,1,0] op_sel_hi:[1,1,0]
    v_cvt_pk_bf16_f32 v44, v224, v225
    v_cvt_pk_bf16_f32 v45, v226, v227
    v_cvt_pk_bf16_f32 v46, v228, v229
    v_cvt_pk_bf16_f32 v47, v230, v231
    ds_write_b128 v163, v[44:47] offset:512
    v_lshlrev_b32 v224, 16, v48
    v_and_b32 v225, s61, v48
    v_lshlrev_b32 v226, 16, v49
    v_and_b32 v227, s61, v49
    v_lshlrev_b32 v228, 16, v50
    v_and_b32 v229, s61, v50
    v_lshlrev_b32 v230, 16, v51
    v_and_b32 v231, s61, v51
    v_pk_fma_f32 v[224:225], v[224:225], v[136:137], v[136:137] op_sel:[0,1,0] op_sel_hi:[1,1,0]
    v_pk_fma_f32 v[226:227], v[226:227], v[136:137], v[136:137] op_sel:[0,1,0] op_sel_hi:[1,1,0]
    v_pk_fma_f32 v[228:229], v[228:229], v[136:137], v[136:137] op_sel:[0,1,0] op_sel_hi:[1,1,0]
    v_pk_fma_f32 v[230:231], v[230:231], v[136:137], v[136:137] op_sel:[0,1,0] op_sel_hi:[1,1,0]
    v_cvt_pk_bf16_f32 v48, v224, v225
    v_cvt_pk_bf16_f32 v49, v226, v227
    v_cvt_pk_bf16_f32 v50, v228, v229
    v_cvt_pk_bf16_f32 v51, v230, v231
    ds_write_b128 v160, v[48:51] offset:768
    v_lshlrev_b32 v224, 16, v52
    v_and_b32 v225, s61, v52
    v_lshlrev_b32 v226, 16, v53
    v_and_b32 v227, s61, v53
    v_lshlrev_b32 v228, 16, v54
    v_and_b32 v229, s61, v54
    v_lshlrev_b32 v230, 16, v55
    v_and_b32 v231, s61, v55
    v_pk_fma_f32 v[224:225], v[224:225], v[136:137], v[136:137] op_sel:[0,1,0] op_sel_hi:[1,1,0]
    v_pk_fma_f32 v[226:227], v[226:227], v[136:137], v[136:137] op_sel:[0,1,0] op_sel_hi:[1,1,0]
    v_pk_fma_f32 v[228:229], v[228:229], v[136:137], v[136:137] op_sel:[0,1,0] op_sel_hi:[1,1,0]
    v_pk_fma_f32 v[230:231], v[230:231], v[136:137], v[136:137] op_sel:[0,1,0] op_sel_hi:[1,1,0]
    v_cvt_pk_bf16_f32 v52, v224, v225
    v_cvt_pk_bf16_f32 v53, v226, v227
    v_cvt_pk_bf16_f32 v54, v228, v229
    v_cvt_pk_bf16_f32 v55, v230, v231
    ds_write_b128 v161, v[52:55] offset:768
    v_lshlrev_b32 v224, 16, v56
    v_and_b32 v225, s61, v56
    v_lshlrev_b32 v226, 16, v57
    v_and_b32 v227, s61, v57
    v_lshlrev_b32 v228, 16, v58
    v_and_b32 v229, s61, v58
    v_lshlrev_b32 v230, 16, v59
    v_and_b32 v231, s61, v59
    v_pk_fma_f32 v[224:225], v[224:225], v[136:137], v[136:137] op_sel:[0,1,0] op_sel_hi:[1,1,0]
    v_pk_fma_f32 v[226:227], v[226:227], v[136:137], v[136:137] op_sel:[0,1,0] op_sel_hi:[1,1,0]
    v_pk_fma_f32 v[228:229], v[228:229], v[136:137], v[136:137] op_sel:[0,1,0] op_sel_hi:[1,1,0]
    v_pk_fma_f32 v[230:231], v[230:231], v[136:137], v[136:137] op_sel:[0,1,0] op_sel_hi:[1,1,0]
    v_cvt_pk_bf16_f32 v56, v224, v225
    v_cvt_pk_bf16_f32 v57, v226, v227
    v_cvt_pk_bf16_f32 v58, v228, v229
    v_cvt_pk_bf16_f32 v59, v230, v231
    ds_write_b128 v162, v[56:59] offset:768
    v_lshlrev_b32 v224, 16, v60
    v_and_b32 v225, s61, v60
    v_lshlrev_b32 v226, 16, v61
    v_and_b32 v227, s61, v61
    v_lshlrev_b32 v228, 16, v62
    v_and_b32 v229, s61, v62
    v_lshlrev_b32 v230, 16, v63
    v_and_b32 v231, s61, v63
    v_pk_fma_f32 v[224:225], v[224:225], v[136:137], v[136:137] op_sel:[0,1,0] op_sel_hi:[1,1,0]
    v_pk_fma_f32 v[226:227], v[226:227], v[136:137], v[136:137] op_sel:[0,1,0] op_sel_hi:[1,1,0]
    v_pk_fma_f32 v[228:229], v[228:229], v[136:137], v[136:137] op_sel:[0,1,0] op_sel_hi:[1,1,0]
    v_pk_fma_f32 v[230:231], v[230:231], v[136:137], v[136:137] op_sel:[0,1,0] op_sel_hi:[1,1,0]
    v_cvt_pk_bf16_f32 v60, v224, v225
    v_cvt_pk_bf16_f32 v61, v226, v227
    v_cvt_pk_bf16_f32 v62, v228, v229
    v_cvt_pk_bf16_f32 v63, v230, v231
    ds_write_b128 v163, v[60:63] offset:768
    s_add_u32 s56, s47, 0x0
    s_add_u32 m0, s46, 0x0
    s_nop 0
    buffer_load_dwordx4 v252, s[8:11], s56 offen lds
    s_add_u32 s56, s47, 0x30000
    s_add_u32 m0, s46, 0x2000
    s_nop 0
    buffer_load_dwordx4 v252, s[8:11], s56 offen lds
    s_add_u32 s56, s47, 0x60000
    s_add_u32 m0, s46, 0x4000
    s_nop 0
    buffer_load_dwordx4 v252, s[8:11], s56 offen lds
    s_add_u32 s56, s47, 0x90000
    s_add_u32 m0, s46, 0x6000
    s_nop 0
    buffer_load_dwordx4 v252, s[8:11], s56 offen lds
    s_bfe_u32 s56, s2, 0x30003
    s_lshl_b32 s56, s56, 3
    s_add_u32 s56, s56, s40
    s_lshl_b32 s56, s56, 3
    v_and_b32 v236, 7, v233
    v_add_u32 v236, s56, v236
    v_lshrrev_b32 v237, 3, v233
    s_movk_i32 s56, 3072
    s_movk_i32 s57, 3584
    v_lshlrev_b32 v238, 10, v237
    v_mad_u32_u24 v238, v236, s56, v238
    v_lshlrev_b32 v239, 7, v237
    v_mad_u32_u24 v239, v236, s57, v239
    s_add_u32 s58, s47, 0
    s_add_u32 s59, s48, 0
    s_mov_b64 exec, 0xffff
    buffer_load_dword v157, v239, s[12:15], s59 offen
    buffer_load_dword v158, v239, s[16:19], s59 offen
    s_mov_b64 exec, -1
    v_xor_b32 v165, 32, v164
    v_xor_b32 v166, 64, v164
    s_nop 0
    v_xor_b32 v167, 96, v164
    v_xor_b32 v168, 128, v164
    v_xor_b32 v169, 160, v164
    v_xor_b32 v170, 192, v164
    v_xor_b32 v171, 224, v164
    s_waitcnt lgkmcnt(0)
    s_barrier
    ds_read_b128 v[0:3], v164 offset:0
    ds_read_b128 v[4:7], v165 offset:0
    ds_read_b128 v[8:11], v166 offset:0
    ds_read_b128 v[12:15], v167 offset:0
    ds_read_b128 v[16:19], v168 offset:0
    ds_read_b128 v[20:23], v169 offset:0
    ds_read_b128 v[24:27], v170 offset:0
    ds_read_b128 v[28:31], v171 offset:0
    ds_read_b128 v[32:35], v164 offset:256
    ds_read_b128 v[36:39], v165 offset:256
    ds_read_b128 v[40:43], v166 offset:256
    ds_read_b128 v[44:47], v167 offset:256
    ds_read_b128 v[48:51], v168 offset:256
    ds_read_b128 v[52:55], v169 offset:256
    ds_read_b128 v[56:59], v170 offset:256
    ds_read_b128 v[60:63], v171 offset:256
    ds_read_b128 v[64:67], v164 offset:512
    ds_read_b128 v[68:71], v165 offset:512
    ds_read_b128 v[72:75], v166 offset:512
    ds_read_b128 v[76:79], v167 offset:512
    ds_read_b128 v[80:83], v168 offset:512
    ds_read_b128 v[84:87], v169 offset:512
    ds_read_b128 v[88:91], v170 offset:512
    ds_read_b128 v[92:95], v171 offset:512
    ds_read_b128 v[96:99], v164 offset:768
    ds_read_b128 v[100:103], v165 offset:768
    ds_read_b128 v[104:107], v166 offset:768
    ds_read_b128 v[108:111], v167 offset:768
    ds_read_b128 v[112:115], v168 offset:768
    ds_read_b128 v[116:119], v169 offset:768
    ds_read_b128 v[120:123], v170 offset:768
    ds_read_b128 v[124:127], v171 offset:768
    s_waitcnt lgkmcnt(0)
    s_waitcnt vmcnt(2)
    s_barrier
    s_add_u32 s56, s47, 0xc0000
    s_add_u32 m0, s46, 0x8000
    s_nop 0
    buffer_load_dwordx4 v252, s[8:11], s56 offen lds
    s_add_u32 s56, s47, 0xf0000
    s_add_u32 m0, s46, 0xa000
    s_nop 0
    buffer_load_dwordx4 v252, s[8:11], s56 offen lds
    s_add_u32 s56, s47, 0x120000
    s_add_u32 m0, s46, 0xc000
    s_nop 0
    buffer_load_dwordx4 v252, s[8:11], s56 offen lds
    s_add_u32 s56, s47, 0x150000
    s_add_u32 m0, s46, 0xe000
    s_nop 0
    buffer_load_dwordx4 v252, s[8:11], s56 offen lds
    s_mov_b32 s63, 0xbdd2d3e8
    v_mov_b32 v246, 0xc0135761
    s_cmp_eq_u32 s43, 2
    s_nop 1
    s_cbranch_scc1 L_Av_4
    ds_read_b64_tr_b16 v[192:193], v243 offset:0
    ds_read_b64_tr_b16 v[194:195], v243 offset:512
    ds_read_b64_tr_b16 v[196:197], v243 offset:2048
    ds_read_b64_tr_b16 v[198:199], v243 offset:2560
    ds_read_b64_tr_b16 v[200:201], v243 offset:4096
    ds_read_b64_tr_b16 v[202:203], v243 offset:4608
    ds_read_b64_tr_b16 v[204:205], v243 offset:6144
    ds_read_b64_tr_b16 v[206:207], v243 offset:6656
    ds_read_b64_tr_b16 v[208:209], v243 offset:8192
    ds_read_b64_tr_b16 v[210:211], v243 offset:8704
    ds_read_b64_tr_b16 v[212:213], v243 offset:10240
    ds_read_b64_tr_b16 v[214:215], v243 offset:10752
    ds_read_b64_tr_b16 v[216:217], v243 offset:12288
    ds_read_b64_tr_b16 v[218:219], v243 offset:12800
    s_waitcnt lgkmcnt(12)
    v_mfma_f32_32x32x16_bf16 v[160:175], v[192:195], v[0:3], 0
    s_cmp_lt_u32 s40, 4
    s_cbranch_scc1 L_pr_5
    s_setprio 1
L_pr_5:
    ds_read_b64_tr_b16 v[220:221], v243 offset:14336
    ds_read_b64_tr_b16 v[222:223], v243 offset:14848
    s_waitcnt lgkmcnt(12)
    v_mfma_f32_32x32x16_bf16 v[160:175], v[196:199], v[4:7], v[160:175]
    s_add_u32 s56, s48, 0x0
    s_add_u32 m0, s46, 0x10000
    s_nop 0
    buffer_load_dwordx4 v253, s[12:15], s56 offen lds
    ds_read_b64_tr_b16 v[192:193], v243 offset:16384
    ds_read_b64_tr_b16 v[194:195], v243 offset:16896
    s_waitcnt lgkmcnt(12)
    v_mfma_f32_32x32x16_bf16 v[160:175], v[200:203], v[8:11], v[160:175]
    ds_read_b64_tr_b16 v[196:197], v243 offset:18432
    ds_read_b64_tr_b16 v[198:199], v243 offset:18944
    s_waitcnt lgkmcnt(12)
    v_mfma_f32_32x32x16_bf16 v[160:175], v[204:207], v[12:15], v[160:175]
    s_add_u32 s56, s48, 0x0
    s_add_u32 m0, s46, 0x14000
    s_nop 0
    buffer_load_dwordx4 v253, s[16:19], s56 offen lds
    ds_read_b64_tr_b16 v[200:201], v243 offset:20480
    ds_read_b64_tr_b16 v[202:203], v243 offset:20992
    s_waitcnt lgkmcnt(12)
    v_mfma_f32_32x32x16_bf16 v[160:175], v[208:211], v[16:19], v[160:175]
    ds_read_b64_tr_b16 v[204:205], v243 offset:22528
    ds_read_b64_tr_b16 v[206:207], v243 offset:23040
    s_waitcnt lgkmcnt(12)
    v_mfma_f32_32x32x16_bf16 v[160:175], v[212:215], v[20:23], v[160:175]
    s_add_u32 s56, s48, 0x38000
    s_add_u32 m0, s46, 0x12000
    s_nop 0
    buffer_load_dwordx4 v253, s[12:15], s56 offen lds
    ds_read_b64_tr_b16 v[208:209], v243 offset:24576
    ds_read_b64_tr_b16 v[210:211], v243 offset:25088
    s_waitcnt lgkmcnt(12)
    v_mfma_f32_32x32x16_bf16 v[160:175], v[216:219], v[24:27], v[160:175]
    ds_read_b64_tr_b16 v[212:213], v243 offset:26624
    ds_read_b64_tr_b16 v[214:215], v243 offset:27136
    s_waitcnt lgkmcnt(12)
    v_mfma_f32_32x32x16_bf16 v[160:175], v[220:223], v[28:31], v[160:175]
    s_add_u32 s56, s48, 0x38000
    s_add_u32 m0, s46, 0x16000
    s_nop 0
    buffer_load_dwordx4 v253, s[16:19], s56 offen lds
    ds_read_b64_tr_b16 v[216:217], v243 offset:28672
    ds_read_b64_tr_b16 v[218:219], v243 offset:29184
    s_waitcnt lgkmcnt(12)
    v_mfma_f32_32x32x16_bf16 v[160:175], v[192:195], v[32:35], v[160:175]
    s_cmp_lt_u32 s40, 4
    s_cbranch_scc1 L_pr_6
    s_setprio 0
L_pr_6:
    ds_read_b64_tr_b16 v[220:221], v243 offset:30720
    ds_read_b64_tr_b16 v[222:223], v243 offset:31232
    s_waitcnt lgkmcnt(12)
    v_mfma_f32_32x32x16_bf16 v[160:175], v[196:199], v[36:39], v[160:175]
    s_add_u32 s56, s48, 0x70000
    s_add_u32 m0, s46, 0x18000
    s_nop 0
    buffer_load_dwordx4 v253, s[12:15], s56 offen lds
    s_waitcnt vmcnt(5)
    s_barrier
    ds_read_b64_tr_b16 v[192:193], v243 offset:32768
    ds_read_b64_tr_b16 v[194:195], v243 offset:33280
    s_waitcnt lgkmcnt(12)
    v_mfma_f32_32x32x16_bf16 v[160:175], v[200:203], v[40:43], v[160:175]
    ds_read_b64_tr_b16 v[196:197], v243 offset:34816
    ds_read_b64_tr_b16 v[198:199], v243 offset:35328
    s_waitcnt lgkmcnt(12)
    v_mfma_f32_32x32x16_bf16 v[160:175], v[204:207], v[44:47], v[160:175]
    s_add_u32 s56, s48, 0x70000
    s_add_u32 m0, s46, 0x1c000
    s_nop 0
    buffer_load_dwordx4 v253, s[16:19], s56 offen lds
    ds_read_b64_tr_b16 v[200:201], v243 offset:36864
    ds_read_b64_tr_b16 v[202:203], v243 offset:37376
    s_waitcnt lgkmcnt(12)
    v_mfma_f32_32x32x16_bf16 v[160:175], v[208:211], v[48:51], v[160:175]
    ds_read_b64_tr_b16 v[204:205], v243 offset:38912
    ds_read_b64_tr_b16 v[206:207], v243 offset:39424
    s_waitcnt lgkmcnt(12)
    v_mfma_f32_32x32x16_bf16 v[160:175], v[212:215], v[52:55], v[160:175]
    s_add_u32 s56, s48, 0xa8000
    s_add_u32 m0, s46, 0x1a000
    s_nop 0
    buffer_load_dwordx4 v253, s[12:15], s56 offen lds
    ds_read_b64_tr_b16 v[208:209], v243 offset:40960
    ds_read_b64_tr_b16 v[210:211], v243 offset:41472
    s_waitcnt lgkmcnt(12)
    v_mfma_f32_32x32x16_bf16 v[160:175], v[216:219], v[56:59], v[160:175]
    ds_read_b64_tr_b16 v[212:213], v243 offset:43008
    ds_read_b64_tr_b16 v[214:215], v243 offset:43520
    s_waitcnt lgkmcnt(12)
    v_mfma_f32_32x32x16_bf16 v[160:175], v[220:223], v[60:63], v[160:175]
    s_add_u32 s56, s48, 0xa8000
    s_add_u32 m0, s46, 0x1e000
    s_nop 0
    buffer_load_dwordx4 v253, s[16:19], s56 offen lds
    s_waitcnt vmcnt(4)
    s_barrier
    ds_read_b64_tr_b16 v[216:217], v243 offset:45056
    ds_read_b64_tr_b16 v[218:219], v243 offset:45568
    s_waitcnt lgkmcnt(12)
    v_mfma_f32_32x32x16_bf16 v[160:175], v[192:195], v[64:67], v[160:175]
    s_cmp_lt_u32 s40, 4
    s_cbranch_scc1 L_pr_7
    s_setprio 1
L_pr_7:
    ds_read_b64_tr_b16 v[220:221], v243 offset:47104
    ds_read_b64_tr_b16 v[222:223], v243 offset:47616
    s_waitcnt lgkmcnt(12)
    v_mfma_f32_32x32x16_bf16 v[160:175], v[196:199], v[68:71], v[160:175]
    s_add_u32 s56, s48, 0xe0000
    s_add_u32 m0, s46, 0x20000
    s_nop 0
    buffer_load_dwordx4 v253, s[12:15], s56 offen lds
    ds_read_b64_tr_b16 v[192:193], v243 offset:49152
    ds_read_b64_tr_b16 v[194:195], v243 offset:49664
    s_waitcnt lgkmcnt(12)
    v_mfma_f32_32x32x16_bf16 v[160:175], v[200:203], v[72:75], v[160:175]
    ds_read_b64_tr_b16 v[196:197], v243 offset:51200
    ds_read_b64_tr_b16 v[198:199], v243 offset:51712
    s_waitcnt lgkmcnt(12)
    v_mfma_f32_32x32x16_bf16 v[160:175], v[204:207], v[76:79], v[160:175]
    s_add_u32 s56, s48, 0xe0000
    s_add_u32 m0, s46, 0x24000
    s_nop 0
    buffer_load_dwordx4 v253, s[16:19], s56 offen lds
    ds_read_b64_tr_b16 v[200:201], v243 offset:53248
    ds_read_b64_tr_b16 v[202:203], v243 offset:53760
    s_waitcnt lgkmcnt(12)
    v_mfma_f32_32x32x16_bf16 v[160:175], v[208:211], v[80:83], v[160:175]
    ds_read_b64_tr_b16 v[204:205], v243 offset:55296
    ds_read_b64_tr_b16 v[206:207], v243 offset:55808
    s_waitcnt lgkmcnt(12)
    v_mfma_f32_32x32x16_bf16 v[160:175], v[212:215], v[84:87], v[160:175]
    s_add_u32 s56, s48, 0x118000
    s_add_u32 m0, s46, 0x22000
    s_nop 0
    buffer_load_dwordx4 v253, s[12:15], s56 offen lds
    ds_read_b64_tr_b16 v[208:209], v243 offset:57344
    ds_read_b64_tr_b16 v[210:211], v243 offset:57856
    s_waitcnt lgkmcnt(12)
    v_mfma_f32_32x32x16_bf16 v[160:175], v[216:219], v[88:91], v[160:175]
    ds_read_b64_tr_b16 v[212:213], v243 offset:59392
    ds_read_b64_tr_b16 v[214:215], v243 offset:59904
    s_waitcnt lgkmcnt(12)
    v_mfma_f32_32x32x16_bf16 v[160:175], v[220:223], v[92:95], v[160:175]
    s_add_u32 s56, s48, 0x118000
    s_add_u32 m0, s46, 0x26000
    s_nop 0
    buffer_load_dwordx4 v253, s[16:19], s56 offen lds
    ds_read_b64_tr_b16 v[216:217], v243 offset:61440
    ds_read_b64_tr_b16 v[218:219], v243 offset:61952
    s_waitcnt lgkmcnt(12)
    v_mfma_f32_32x32x16_bf16 v[160:175], v[192:195], v[96:99], v[160:175]
    s_cmp_lt_u32 s40, 4
    s_cbranch_scc1 L_pr_8
    s_setprio 0
L_pr_8:
    ds_read_b64_tr_b16 v[220:221], v243 offset:63488
    ds_read_b64_tr_b16 v[222:223], v243 offset:64000
    s_waitcnt lgkmcnt(12)
    v_mfma_f32_32x32x16_bf16 v[160:175], v[196:199], v[100:103], v[160:175]
    s_add_u32 s56, s48, 0x150000
    s_add_u32 m0, s46, 0x0
    s_nop 0
    buffer_load_dwordx4 v253, s[12:15], s56 offen lds
    ds_read_b64_tr_b16 v[192:193], v244 offset:0
    ds_read_b64_tr_b16 v[194:195], v244 offset:512
    s_waitcnt lgkmcnt(12)
    v_mfma_f32_32x32x16_bf16 v[160:175], v[200:203], v[104:107], v[160:175]
    ds_read_b64_tr_b16 v[196:197], v244 offset:16384
    ds_read_b64_tr_b16 v[198:199], v244 offset:16896
    s_waitcnt lgkmcnt(12)
    v_mfma_f32_32x32x16_bf16 v[160:175], v[204:207], v[108:111], v[160:175]
    s_add_u32 s56, s48, 0x150000
    s_add_u32 m0, s46, 0x4000
    s_nop 0
    buffer_load_dwordx4 v253, s[16:19], s56 offen lds
    ds_read_b64_tr_b16 v[200:201], v244 offset:2048
    ds_read_b64_tr_b16 v[202:203], v244 offset:2560
    s_waitcnt lgkmcnt(12)
    v_mfma_f32_32x32x16_bf16 v[160:175], v[208:211], v[112:115], v[160:175]
    ds_read_b64_tr_b16 v[204:205], v244 offset:18432
    ds_read_b64_tr_b16 v[206:207], v244 offset:18944
    s_waitcnt lgkmcnt(12)
    v_mfma_f32_32x32x16_bf16 v[160:175], v[212:215], v[116:119], v[160:175]
    s_add_u32 s56, s48, 0x188000
    s_add_u32 m0, s46, 0x2000
    s_nop 0
    buffer_load_dwordx4 v253, s[12:15], s56 offen lds
    ds_read_b64_tr_b16 v[208:209], v244 offset:4096
    ds_read_b64_tr_b16 v[210:211], v244 offset:4608
    s_waitcnt lgkmcnt(12)
    v_mfma_f32_32x32x16_bf16 v[160:175], v[216:219], v[120:123], v[160:175]
    ds_read_b64_tr_b16 v[212:213], v244 offset:20480
    ds_read_b64_tr_b16 v[214:215], v244 offset:20992
    s_waitcnt lgkmcnt(12)
    v_mfma_f32_32x32x16_bf16 v[160:175], v[220:223], v[124:127], v[160:175]
    s_add_u32 s56, s48, 0x188000
    s_add_u32 m0, s46, 0x6000
    s_nop 0
    buffer_load_dwordx4 v253, s[16:19], s56 offen lds
    s_waitcnt vmcnt(8)
    s_barrier
    ds_read_b64_tr_b16 v[216:217], v244 offset:6144
    ds_read_b64_tr_b16 v[218:219], v244 offset:6656
    s_waitcnt lgkmcnt(12)
    v_mfma_f32_32x32x16_bf16 v[128:143], v[192:195], v[0:3], 0
    s_cmp_lt_u32 s40, 4
    s_cbranch_scc1 L_pr_9
    s_setprio 1
L_pr_9:
    ds_read_b64_tr_b16 v[220:221], v244 offset:22528
    ds_read_b64_tr_b16 v[222:223], v244 offset:23040
    s_waitcnt lgkmcnt(12)
    v_mfma_f32_32x32x16_bf16 v[144:159], v[196:199], v[0:3], 0
    s_add_u32 s56, s49, 0x0
    s_add_u32 m0, s46, 0x8000
    s_nop 0
    buffer_load_dwordx4 v253, s[12:15], s56 offen lds
    ds_read_b64_tr_b16 v[192:193], v244 offset:8192
    ds_read_b64_tr_b16 v[194:195], v244 offset:8704
    s_waitcnt lgkmcnt(12)
    v_mfma_f32_32x32x16_bf16 v[128:143], v[200:203], v[4:7], v[128:143]
    v_mul_f32 v160, s64, v160
    v_mul_f32 v161, s64, v161
    v_mul_f32 v162, s64, v162
    v_mul_f32 v163, s64, v163
    ds_read_b64_tr_b16 v[196:197], v244 offset:24576
    ds_read_b64_tr_b16 v[198:199], v244 offset:25088
    s_waitcnt lgkmcnt(12)
    v_mfma_f32_32x32x16_bf16 v[144:159], v[204:207], v[4:7], v[144:159]
    v_mul_f32 v164, s64, v164
    v_mul_f32 v165, s64, v165
    v_mul_f32 v166, s64, v166
    v_mul_f32 v167, s64, v167
    ds_read_b64_tr_b16 v[200:201], v244 offset:10240
    ds_read_b64_tr_b16 v[202:203], v244 offset:10752
    s_waitcnt lgkmcnt(12)
    v_mfma_f32_32x32x16_bf16 v[128:143], v[208:211], v[8:11], v[128:143]
    v_mul_f32 v168, s64, v168
    v_mul_f32 v169, s64, v169
    v_mul_f32 v170, s64, v170
    v_mul_f32 v171, s64, v171
    ds_read_b64_tr_b16 v[204:205], v244 offset:26624
    ds_read_b64_tr_b16 v[206:207], v244 offset:27136
    s_waitcnt lgkmcnt(12)
    v_mfma_f32_32x32x16_bf16 v[144:159], v[212:215], v[8:11], v[144:159]
    s_add_u32 s56, s49, 0x0
    s_add_u32 m0, s46, 0xc000
    s_nop 0
    buffer_load_dwordx4 v253, s[16:19], s56 offen lds
    v_mul_f32 v172, s64, v172
    v_mul_f32 v173, s64, v173
    v_mul_f32 v174, s64, v174
    v_mul_f32 v175, s64, v175
    ds_read_b64_tr_b16 v[208:209], v244 offset:12288
    ds_read_b64_tr_b16 v[210:211], v244 offset:12800
    s_waitcnt lgkmcnt(12)
    s_nop 0
    v_mfma_f32_32x32x16_bf16 v[128:143], v[216:219], v[12:15], v[128:143]
    v_cvt_pk_bf16_f32 v224, v160, v161
    v_cvt_pk_bf16_f32 v225, v162, v163
    v_cvt_pk_bf16_f32 v226, v164, v165
    v_cvt_pk_bf16_f32 v227, v166, v167
    ds_read_b64_tr_b16 v[212:213], v244 offset:28672
    ds_read_b64_tr_b16 v[214:215], v244 offset:29184
    s_waitcnt lgkmcnt(12)
    s_nop 0
    v_mfma_f32_32x32x16_bf16 v[144:159], v[220:223], v[12:15], v[144:159]
    buffer_store_dwordx4 v[224:227], v250, s[32:35], s51 offen sc1
    v_cvt_pk_bf16_f32 v228, v168, v169
    v_cvt_pk_bf16_f32 v229, v170, v171
    v_cvt_pk_bf16_f32 v230, v172, v173
    ds_read_b64_tr_b16 v[216:217], v244 offset:14336
    ds_read_b64_tr_b16 v[218:219], v244 offset:14848
    s_waitcnt lgkmcnt(12)
    v_mfma_f32_32x32x16_bf16 v[128:143], v[192:195], v[16:19], v[128:143]
    s_cmp_lt_u32 s40, 4
    s_cbranch_scc1 L_pr_10
    s_setprio 0
L_pr_10:
    v_cvt_pk_bf16_f32 v231, v174, v175
    s_add_u32 s57, s51, 0x10000
    buffer_store_dwordx4 v[228:231], v250, s[32:35], s57 offen sc1
    ds_read_b64_tr_b16 v[220:221], v244 offset:30720
    ds_read_b64_tr_b16 v[222:223], v244 offset:31232
    s_waitcnt lgkmcnt(12)
    v_mfma_f32_32x32x16_bf16 v[144:159], v[196:199], v[16:19], v[144:159]
    s_add_u32 s56, s49, 0x38000
    s_add_u32 m0, s46, 0xa000
    s_nop 0
    buffer_load_dwordx4 v253, s[12:15], s56 offen lds
    ds_read_b64_tr_b16 v[192:193], v244 offset:32768
    ds_read_b64_tr_b16 v[194:195], v244 offset:33280
    s_waitcnt lgkmcnt(12)
    v_mfma_f32_32x32x16_bf16 v[128:143], v[200:203], v[20:23], v[128:143]
    ds_read_b64_tr_b16 v[196:197], v244 offset:49152
    ds_read_b64_tr_b16 v[198:199], v244 offset:49664
    s_waitcnt lgkmcnt(12)
    v_mfma_f32_32x32x16_bf16 v[144:159], v[204:207], v[20:23], v[144:159]
    ds_read_b64_tr_b16 v[200:201], v244 offset:34816
    ds_read_b64_tr_b16 v[202:203], v244 offset:35328
    s_waitcnt lgkmcnt(12)
    v_mfma_f32_32x32x16_bf16 v[128:143], v[208:211], v[24:27], v[128:143]
    ds_read_b64_tr_b16 v[204:205], v244 offset:51200
    ds_read_b64_tr_b16 v[206:207], v244 offset:51712
    s_waitcnt lgkmcnt(12)
    v_mfma_f32_32x32x16_bf16 v[144:159], v[212:215], v[24:27], v[144:159]
    s_add_u32 s56, s49, 0x38000
    s_add_u32 m0, s46, 0xe000
    s_nop 0
    buffer_load_dwordx4 v253, s[16:19], s56 offen lds
    ds_read_b64_tr_b16 v[208:209], v244 offset:36864
    ds_read_b64_tr_b16 v[210:211], v244 offset:37376
    s_waitcnt lgkmcnt(12)
    v_mfma_f32_32x32x16_bf16 v[128:143], v[216:219], v[28:31], v[128:143]
    ds_read_b64_tr_b16 v[212:213], v244 offset:53248
    ds_read_b64_tr_b16 v[214:215], v244 offset:53760
    s_waitcnt lgkmcnt(12)
    v_mfma_f32_32x32x16_bf16 v[144:159], v[220:223], v[28:31], v[144:159]
    s_waitcnt vmcnt(10)
    s_barrier
    v_lshlrev_b32 v254, 3, v250
    s_lshl_b32 s58, s2, 3
    s_add_u32 s58, s58, s40
    s_mul_i32 s59, s58, 896
    s_mov_b64 exec, 0x7f
    buffer_load_dword v255, v254, s[20:23], s59 offen
    s_lshl_b32 s59, s58, 8
    s_mov_b64 exec, 3
    buffer_load_dword v255, v254, s[24:27], s59 offen
    s_mov_b64 exec, -1
    ds_read_b64_tr_b16 v[216:217], v244 offset:38912
    ds_read_b64_tr_b16 v[218:219], v244 offset:39424
    s_waitcnt lgkmcnt(12)
    v_mfma_f32_32x32x16_bf16 v[128:143], v[192:195], v[32:35], v[128:143]
    s_cmp_lt_u32 s40, 4
    s_cbranch_scc1 L_pr_11
    s_setprio 1
L_pr_11:
    ds_read_b64_tr_b16 v[220:221], v244 offset:55296
    ds_read_b64_tr_b16 v[222:223], v244 offset:55808
    s_waitcnt lgkmcnt(12)
    v_mfma_f32_32x32x16_bf16 v[144:159], v[196:199], v[32:35], v[144:159]
    s_add_u32 s56, s49, 0x70000
    s_add_u32 m0, s46, 0x10000
    s_nop 0
    buffer_load_dwordx4 v253, s[12:15], s56 offen lds
    ds_read_b64_tr_b16 v[192:193], v244 offset:40960
    ds_read_b64_tr_b16 v[194:195], v244 offset:41472
    s_waitcnt lgkmcnt(12)
    v_mfma_f32_32x32x16_bf16 v[128:143], v[200:203], v[36:39], v[128:143]
    ds_read_b64_tr_b16 v[196:197], v244 offset:57344
    ds_read_b64_tr_b16 v[198:199], v244 offset:57856
    s_waitcnt lgkmcnt(12)
    v_mfma_f32_32x32x16_bf16 v[144:159], v[204:207], v[36:39], v[144:159]
    ds_read_b64_tr_b16 v[200:201], v244 offset:43008
    ds_read_b64_tr_b16 v[202:203], v244 offset:43520
    s_waitcnt lgkmcnt(12)
    v_mfma_f32_32x32x16_bf16 v[128:143], v[208:211], v[40:43], v[128:143]
    ds_read_b64_tr_b16 v[204:205], v244 offset:59392
    ds_read_b64_tr_b16 v[206:207], v244 offset:59904
    s_waitcnt lgkmcnt(12)
    v_mfma_f32_32x32x16_bf16 v[144:159], v[212:215], v[40:43], v[144:159]
    s_add_u32 s56, s49, 0x70000
    s_add_u32 m0, s46, 0x14000
    s_nop 0
    buffer_load_dwordx4 v253, s[16:19], s56 offen lds
    ds_read_b64_tr_b16 v[208:209], v244 offset:45056
    ds_read_b64_tr_b16 v[210:211], v244 offset:45568
    s_waitcnt lgkmcnt(12)
    v_mfma_f32_32x32x16_bf16 v[128:143], v[216:219], v[44:47], v[128:143]
    ds_read_b64_tr_b16 v[212:213], v244 offset:61440
    ds_read_b64_tr_b16 v[214:215], v244 offset:61952
    s_waitcnt lgkmcnt(12)
    v_mfma_f32_32x32x16_bf16 v[144:159], v[220:223], v[44:47], v[144:159]
    ds_read_b64_tr_b16 v[216:217], v244 offset:47104
    ds_read_b64_tr_b16 v[218:219], v244 offset:47616
    s_waitcnt lgkmcnt(12)
    v_mfma_f32_32x32x16_bf16 v[128:143], v[192:195], v[48:51], v[128:143]
    s_cmp_lt_u32 s40, 4
    s_cbranch_scc1 L_pr_12
    s_setprio 0
L_pr_12:
    ds_read_b64_tr_b16 v[220:221], v244 offset:63488
    ds_read_b64_tr_b16 v[222:223], v244 offset:64000
    s_waitcnt lgkmcnt(12)
    v_mfma_f32_32x32x16_bf16 v[144:159], v[196:199], v[48:51], v[144:159]
    s_add_u32 s56, s49, 0xa8000
    s_add_u32 m0, s46, 0x12000
    s_nop 0
    buffer_load_dwordx4 v253, s[12:15], s56 offen lds
    ds_read_b64_tr_b16 v[192:193], v245 offset:0
    ds_read_b64_tr_b16 v[194:195], v245 offset:512
    s_waitcnt lgkmcnt(12)
    v_mfma_f32_32x32x16_bf16 v[128:143], v[200:203], v[52:55], v[128:143]
    ds_read_b64_tr_b16 v[196:197], v245 offset:16384
    ds_read_b64_tr_b16 v[198:199], v245 offset:16896
    s_waitcnt lgkmcnt(12)
    v_mfma_f32_32x32x16_bf16 v[144:159], v[204:207], v[52:55], v[144:159]
    ds_read_b64_tr_b16 v[200:201], v245 offset:2048
    ds_read_b64_tr_b16 v[202:203], v245 offset:2560
    s_waitcnt lgkmcnt(12)
    v_mfma_f32_32x32x16_bf16 v[128:143], v[208:211], v[56:59], v[128:143]
    ds_read_b64_tr_b16 v[204:205], v245 offset:18432
    ds_read_b64_tr_b16 v[206:207], v245 offset:18944
    s_waitcnt lgkmcnt(12)
    v_mfma_f32_32x32x16_bf16 v[144:159], v[212:215], v[56:59], v[144:159]
    s_add_u32 s56, s49, 0xa8000
    s_add_u32 m0, s46, 0x16000
    s_nop 0
    buffer_load_dwordx4 v253, s[16:19], s56 offen lds
    ds_read_b64_tr_b16 v[208:209], v245 offset:4096
    ds_read_b64_tr_b16 v[210:211], v245 offset:4608
    s_waitcnt lgkmcnt(12)
    v_mfma_f32_32x32x16_bf16 v[128:143], v[216:219], v[60:63], v[128:143]
    ds_read_b64_tr_b16 v[212:213], v245 offset:20480
    ds_read_b64_tr_b16 v[214:215], v245 offset:20992
    s_waitcnt lgkmcnt(12)
    v_mfma_f32_32x32x16_bf16 v[144:159], v[220:223], v[60:63], v[144:159]
    s_waitcnt vmcnt(12)
    s_mov_b32 s55, 0
    s_nop 9
L_epr_13:
    v_readfirstlane_b32 s94, v247
    s_nop 0
    s_cmp_lg_u32 s94, 0
    s_nop 2
    s_cbranch_scc1 L_epd_14
    s_sleep 4
    buffer_load_dword v247, off, s[36:39], 0 sc0 sc1
    s_waitcnt vmcnt(0)
    s_add_u32 s55, s55, 1
    s_cmp_lt_u32 s55, 0x100000
    s_cbranch_scc1 L_epr_13
L_epd_14:
    s_waitcnt vmcnt(8)
    s_barrier
    s_cmp_lg_u32 s40, 0
    s_cbranch_scc1 L_nopub_15
    s_lshl_b32 s58, s41, 7
    s_add_u32 s58, s58, s95
    s_add_u32 s58, s58, 0x1000000
    v_mov_b32 v247, s94
    s_mov_b64 exec, 1
    buffer_store_dword v247, off, s[32:35], s58 sc0 sc1
    s_mov_b64 exec, -1
L_nopub_15:
    ds_read_b64_tr_b16 v[216:217], v245 offset:6144
    ds_read_b64_tr_b16 v[218:219], v245 offset:6656
    s_waitcnt lgkmcnt(12)
    v_mfma_f32_32x32x16_bf16 v[128:143], v[192:195], v[64:67], v[128:143]
    s_cmp_lt_u32 s40, 4
    s_cbranch_scc1 L_pr_16
    s_setprio 1
L_pr_16:
    ds_read_b64_tr_b16 v[220:221], v245 offset:22528
    ds_read_b64_tr_b16 v[222:223], v245 offset:23040
    s_waitcnt lgkmcnt(12)
    v_mfma_f32_32x32x16_bf16 v[144:159], v[196:199], v[64:67], v[144:159]
    s_add_u32 s56, s49, 0xe0000
    s_add_u32 m0, s46, 0x18000
    s_nop 0
    buffer_load_dwordx4 v253, s[12:15], s56 offen lds
    ds_read_b64_tr_b16 v[192:193], v245 offset:8192
    ds_read_b64_tr_b16 v[194:195], v245 offset:8704
    s_waitcnt lgkmcnt(12)
    v_mfma_f32_32x32x16_bf16 v[128:143], v[200:203], v[68:71], v[128:143]
    ds_read_b64_tr_b16 v[196:197], v245 offset:24576
    ds_read_b64_tr_b16 v[198:199], v245 offset:25088
    s_waitcnt lgkmcnt(12)
    v_mfma_f32_32x32x16_bf16 v[144:159], v[204:207], v[68:71], v[144:159]
    ds_read_b64_tr_b16 v[200:201], v245 offset:10240
    ds_read_b64_tr_b16 v[202:203], v245 offset:10752
    s_waitcnt lgkmcnt(12)
    v_mfma_f32_32x32x16_bf16 v[128:143], v[208:211], v[72:75], v[128:143]
    ds_read_b64_tr_b16 v[204:205], v245 offset:26624
    ds_read_b64_tr_b16 v[206:207], v245 offset:27136
    s_waitcnt lgkmcnt(12)
    v_mfma_f32_32x32x16_bf16 v[144:159], v[212:215], v[72:75], v[144:159]
    s_add_u32 s56, s49, 0xe0000
    s_add_u32 m0, s46, 0x1c000
    s_nop 0
    buffer_load_dwordx4 v253, s[16:19], s56 offen lds
    ds_read_b64_tr_b16 v[208:209], v245 offset:12288
    ds_read_b64_tr_b16 v[210:211], v245 offset:12800
    s_waitcnt lgkmcnt(12)
    v_mfma_f32_32x32x16_bf16 v[128:143], v[216:219], v[76:79], v[128:143]
    ds_read_b64_tr_b16 v[212:213], v245 offset:28672
    ds_read_b64_tr_b16 v[214:215], v245 offset:29184
    s_waitcnt lgkmcnt(12)
    v_mfma_f32_32x32x16_bf16 v[144:159], v[220:223], v[76:79], v[144:159]
    ds_read_b64_tr_b16 v[216:217], v245 offset:14336
    ds_read_b64_tr_b16 v[218:219], v245 offset:14848
    s_waitcnt lgkmcnt(12)
    v_mfma_f32_32x32x16_bf16 v[128:143], v[192:195], v[80:83], v[128:143]
    s_cmp_lt_u32 s40, 4
    s_cbranch_scc1 L_pr_17
    s_setprio 0
L_pr_17:
    ds_read_b64_tr_b16 v[220:221], v245 offset:30720
    ds_read_b64_tr_b16 v[222:223], v245 offset:31232
    s_waitcnt lgkmcnt(12)
    v_mfma_f32_32x32x16_bf16 v[144:159], v[196:199], v[80:83], v[144:159]
    s_add_u32 s56, s49, 0x118000
    s_add_u32 m0, s46, 0x1a000
    s_nop 0
    buffer_load_dwordx4 v253, s[12:15], s56 offen lds
    ds_read_b64_tr_b16 v[192:193], v243 offset:0
    ds_read_b64_tr_b16 v[194:195], v243 offset:512
    s_waitcnt lgkmcnt(12)
    v_mfma_f32_32x32x16_bf16 v[128:143], v[200:203], v[84:87], v[128:143]
    ds_read_b64_tr_b16 v[196:197], v243 offset:16384
    ds_read_b64_tr_b16 v[198:199], v243 offset:16896
    s_waitcnt lgkmcnt(12)
    v_mfma_f32_32x32x16_bf16 v[144:159], v[204:207], v[84:87], v[144:159]
    ds_read_b64_tr_b16 v[200:201], v243 offset:2048
    ds_read_b64_tr_b16 v[202:203], v243 offset:2560
    s_waitcnt lgkmcnt(12)
    v_mfma_f32_32x32x16_bf16 v[128:143], v[208:211], v[88:91], v[128:143]
    ds_read_b64_tr_b16 v[204:205], v243 offset:18432
    ds_read_b64_tr_b16 v[206:207], v243 offset:18944
    s_waitcnt lgkmcnt(12)
    v_mfma_f32_32x32x16_bf16 v[144:159], v[212:215], v[88:91], v[144:159]
    s_add_u32 s56, s49, 0x118000
    s_add_u32 m0, s46, 0x1e000
    s_nop 0
    buffer_load_dwordx4 v253, s[16:19], s56 offen lds
    ds_read_b64_tr_b16 v[208:209], v243 offset:4096
    ds_read_b64_tr_b16 v[210:211], v243 offset:4608
    s_waitcnt lgkmcnt(12)
    v_mfma_f32_32x32x16_bf16 v[128:143], v[216:219], v[92:95], v[128:143]
    ds_read_b64_tr_b16 v[212:213], v243 offset:20480
    ds_read_b64_tr_b16 v[214:215], v243 offset:20992
    s_waitcnt lgkmcnt(12)
    v_mfma_f32_32x32x16_bf16 v[144:159], v[220:223], v[92:95], v[144:159]
    s_waitcnt vmcnt(10)
    s_barrier
    ds_read_b64_tr_b16 v[216:217], v243 offset:6144
    ds_read_b64_tr_b16 v[218:219], v243 offset:6656
    s_waitcnt lgkmcnt(12)
    v_mfma_f32_32x32x16_bf16 v[128:143], v[192:195], v[96:99], v[128:143]
    s_cmp_lt_u32 s40, 4
    s_cbranch_scc1 L_pr_18
    s_setprio 1
L_pr_18:
    ds_read_b64_tr_b16 v[220:221], v243 offset:22528
    ds_read_b64_tr_b16 v[222:223], v243 offset:23040
    s_waitcnt lgkmcnt(12)
    v_mfma_f32_32x32x16_bf16 v[144:159], v[196:199], v[96:99], v[144:159]
    s_add_u32 s56, s49, 0x150000
    s_add_u32 m0, s46, 0x20000
    s_nop 0
    buffer_load_dwordx4 v253, s[12:15], s56 offen lds
    ds_read_b64_tr_b16 v[192:193], v243 offset:8192
    ds_read_b64_tr_b16 v[194:195], v243 offset:8704
    s_waitcnt lgkmcnt(12)
    v_mfma_f32_32x32x16_bf16 v[128:143], v[200:203], v[100:103], v[128:143]
    ds_read_b64_tr_b16 v[196:197], v243 offset:24576
    ds_read_b64_tr_b16 v[198:199], v243 offset:25088
    s_waitcnt lgkmcnt(12)
    v_mfma_f32_32x32x16_bf16 v[144:159], v[204:207], v[100:103], v[144:159]
    ds_read_b64_tr_b16 v[200:201], v243 offset:10240
    ds_read_b64_tr_b16 v[202:203], v243 offset:10752
    s_waitcnt lgkmcnt(12)
    v_mfma_f32_32x32x16_bf16 v[128:143], v[208:211], v[104:107], v[128:143]
    ds_read_b64_tr_b16 v[204:205], v243 offset:26624
    ds_read_b64_tr_b16 v[206:207], v243 offset:27136
    s_waitcnt lgkmcnt(12)
    v_mfma_f32_32x32x16_bf16 v[144:159], v[212:215], v[104:107], v[144:159]
    s_add_u32 s56, s49, 0x150000
    s_add_u32 m0, s46, 0x24000
    s_nop 0
    buffer_load_dwordx4 v253, s[16:19], s56 offen lds
    ds_read_b64_tr_b16 v[208:209], v243 offset:12288
    ds_read_b64_tr_b16 v[210:211], v243 offset:12800
    s_waitcnt lgkmcnt(12)
    v_mfma_f32_32x32x16_bf16 v[128:143], v[216:219], v[108:111], v[128:143]
    ds_read_b64_tr_b16 v[212:213], v243 offset:28672
    ds_read_b64_tr_b16 v[214:215], v243 offset:29184
    s_waitcnt lgkmcnt(12)
    v_mfma_f32_32x32x16_bf16 v[144:159], v[220:223], v[108:111], v[144:159]
    ds_read_b64_tr_b16 v[216:217], v243 offset:14336
    ds_read_b64_tr_b16 v[218:219], v243 offset:14848
    s_waitcnt lgkmcnt(12)
    v_mfma_f32_32x32x16_bf16 v[128:143], v[192:195], v[112:115], v[128:143]
    s_cmp_lt_u32 s40, 4
    s_cbranch_scc1 L_pr_19
    s_setprio 0
L_pr_19:
    ds_read_b64_tr_b16 v[220:221], v243 offset:30720
    ds_read_b64_tr_b16 v[222:223], v243 offset:31232
    s_waitcnt lgkmcnt(12)
    v_mfma_f32_32x32x16_bf16 v[144:159], v[196:199], v[112:115], v[144:159]
    s_add_u32 s56, s49, 0x188000
    s_add_u32 m0, s46, 0x22000
    s_nop 0
    buffer_load_dwordx4 v253, s[12:15], s56 offen lds
    ds_read_b64_tr_b16 v[192:193], v243 offset:32768
    ds_read_b64_tr_b16 v[194:195], v243 offset:33280
    s_waitcnt lgkmcnt(12)
    v_mfma_f32_32x32x16_bf16 v[128:143], v[200:203], v[116:119], v[128:143]
    ds_read_b64_tr_b16 v[196:197], v243 offset:49152
    ds_read_b64_tr_b16 v[198:199], v243 offset:49664
    s_waitcnt lgkmcnt(12)
    v_mfma_f32_32x32x16_bf16 v[144:159], v[204:207], v[116:119], v[144:159]
    ds_read_b64_tr_b16 v[200:201], v243 offset:34816
    ds_read_b64_tr_b16 v[202:203], v243 offset:35328
    s_waitcnt lgkmcnt(12)
    v_mfma_f32_32x32x16_bf16 v[128:143], v[208:211], v[120:123], v[128:143]
    ds_read_b64_tr_b16 v[204:205], v243 offset:51200
    ds_read_b64_tr_b16 v[206:207], v243 offset:51712
    s_waitcnt lgkmcnt(12)
    v_mfma_f32_32x32x16_bf16 v[144:159], v[212:215], v[120:123], v[144:159]
    s_add_u32 s56, s49, 0x188000
    s_add_u32 m0, s46, 0x26000
    s_nop 0
    buffer_load_dwordx4 v253, s[16:19], s56 offen lds
    ds_read_b64_tr_b16 v[208:209], v243 offset:36864
    ds_read_b64_tr_b16 v[210:211], v243 offset:37376
    s_waitcnt lgkmcnt(12)
    v_mfma_f32_32x32x16_bf16 v[128:143], v[216:219], v[124:127], v[128:143]
    ds_read_b64_tr_b16 v[212:213], v243 offset:53248
    ds_read_b64_tr_b16 v[214:215], v243 offset:53760
    s_waitcnt lgkmcnt(12)
    v_mfma_f32_32x32x16_bf16 v[144:159], v[220:223], v[124:127], v[144:159]
    s_waitcnt vmcnt(8)
    s_barrier
    s_and_b32 s67, s40, 3
    s_lshr_b32 s68, s40, 2
    v_lshrrev_b32 v254, 7, v250
    v_bfe_u32 v255, v250, 4, 3
    v_bfe_u32 v253, v254, 1, 1
    v_lshlrev_b32 v253, 2, v253
    v_xor_b32 v255, v255, v253
    v_lshlrev_b32 v255, 4, v255
    v_lshrrev_b32 v253, 2, v254
    v_and_b32 v254, 3, v254
    v_lshl_add_u32 v254, v253, 3, v254
    v_lshl_add_u32 v252, v254, 10, v255
    s_lshl_b32 s56, s66, 7
    s_lshl_b32 s57, s68, 5
    s_mul_i32 s58, s67, 448
    s_add_u32 s58, s58, s57
    s_lshl_b32 s58, s58, 10
    s_add_u32 s71, s58, s56
    s_lshl_b32 s58, s67, 7
    s_add_u32 s58, s58, s57
    s_lshl_b32 s58, s58, 10
    s_add_u32 s72, s58, s56
    s_lshl_b32 s58, s67, 13
    s_lshl_b32 s57, s68, 12
    s_add_u32 s73, s58, s57
    ds_read_b64_tr_b16 v[216:217], v243 offset:38912
    ds_read_b64_tr_b16 v[218:219], v243 offset:39424
    s_waitcnt lgkmcnt(12)
    v_mfma_f32_32x32x16_bf16 v[160:175], v[192:195], v[0:3], 0
    s_cmp_lt_u32 s40, 4
    s_cbranch_scc1 L_pr_20
    s_setprio 1
L_pr_20:
    ds_read_b64_tr_b16 v[220:221], v243 offset:55296
    ds_read_b64_tr_b16 v[222:223], v243 offset:55808
    s_waitcnt lgkmcnt(12)
    v_mfma_f32_32x32x16_bf16 v[176:191], v[196:199], v[0:3], 0
    s_add_u32 s56, s71, 0x0
    s_add_u32 m0, s73, 0x0
    s_nop 0
    buffer_load_dwordx4 v252, s[20:23], s56 offen lds
    ds_read_b64_tr_b16 v[192:193], v243 offset:40960
    ds_read_b64_tr_b16 v[194:195], v243 offset:41472
    s_waitcnt lgkmcnt(12)
    v_mfma_f32_32x32x16_bf16 v[160:175], v[200:203], v[4:7], v[160:175]
    v_mul_f32 v232, v128, v128
    v_mul_f32 v233, v129, v129
    v_mul_f32 v234, v130, v130
    v_mul_f32 v235, v131, v131
    ds_read_b64_tr_b16 v[196:197], v243 offset:57344
    ds_read_b64_tr_b16 v[198:199], v243 offset:57856
    s_waitcnt lgkmcnt(12)
    v_mfma_f32_32x32x16_bf16 v[176:191], v[204:207], v[4:7], v[176:191]
    v_fma_f32 v232, v232, s63, v246
    v_fma_f32 v233, v233, s63, v246
    v_fma_f32 v234, v234, s63, v246
    v_fma_f32 v235, v235, s63, v246
    ds_read_b64_tr_b16 v[200:201], v243 offset:43008
    ds_read_b64_tr_b16 v[202:203], v243 offset:43520
    s_waitcnt lgkmcnt(12)
    v_mfma_f32_32x32x16_bf16 v[160:175], v[208:211], v[8:11], v[160:175]
    v_mul_f32 v232, v232, v128
    v_mul_f32 v233, v233, v129
    v_mul_f32 v234, v234, v130
    v_mul_f32 v235, v235, v131
    ds_read_b64_tr_b16 v[204:205], v243 offset:59392
    ds_read_b64_tr_b16 v[206:207], v243 offset:59904
    s_waitcnt lgkmcnt(12)
    v_mfma_f32_32x32x16_bf16 v[176:191], v[212:215], v[8:11], v[176:191]
    s_add_u32 s56, s71, 0x1000
    s_add_u32 m0, s73, 0x400
    s_nop 0
    buffer_load_dwordx4 v252, s[20:23], s56 offen lds
    v_exp_f32 v232, v232
    v_exp_f32 v233, v233
    v_exp_f32 v234, v234
    v_exp_f32 v235, v235
    ds_read_b64_tr_b16 v[208:209], v243 offset:45056
    ds_read_b64_tr_b16 v[210:211], v243 offset:45568
    s_waitcnt lgkmcnt(12)
    v_mfma_f32_32x32x16_bf16 v[160:175], v[216:219], v[12:15], v[160:175]
    v_mul_f32 v128, v128, v144
    v_mul_f32 v129, v129, v145
    v_mul_f32 v130, v130, v146
    v_mul_f32 v131, v131, v147
    ds_read_b64_tr_b16 v[212:213], v243 offset:61440
    ds_read_b64_tr_b16 v[214:215], v243 offset:61952
    s_waitcnt lgkmcnt(12)
    v_mfma_f32_32x32x16_bf16 v[176:191], v[220:223], v[12:15], v[176:191]
    v_add_f32 v232, 1.0, v232
    v_add_f32 v233, 1.0, v233
    v_add_f32 v234, 1.0, v234
    v_add_f32 v235, 1.0, v235
    ds_read_b64_tr_b16 v[216:217], v243 offset:47104
    ds_read_b64_tr_b16 v[218:219], v243 offset:47616
    s_waitcnt lgkmcnt(12)
    v_mfma_f32_32x32x16_bf16 v[160:175], v[192:195], v[16:19], v[160:175]
    s_cmp_lt_u32 s40, 4
    s_cbranch_scc1 L_pr_21
    s_setprio 0
L_pr_21:
    v_rcp_f32 v232, v232
    v_rcp_f32 v233, v233
    v_rcp_f32 v234, v234
    v_rcp_f32 v235, v235
    ds_read_b64_tr_b16 v[220:221], v243 offset:63488
    ds_read_b64_tr_b16 v[222:223], v243 offset:64000
    s_waitcnt lgkmcnt(12)
    v_mfma_f32_32x32x16_bf16 v[176:191], v[196:199], v[16:19], v[176:191]
    s_add_u32 s56, s71, 0x4000
    s_add_u32 m0, s73, 0x800
    s_nop 0
    buffer_load_dwordx4 v252, s[20:23], s56 offen lds
    v_mul_f32 v128, v128, v232
    v_mul_f32 v129, v129, v233
    v_mul_f32 v130, v130, v234
    v_mul_f32 v131, v131, v235
    ds_read_b64_tr_b16 v[192:193], v244 offset:0
    ds_read_b64_tr_b16 v[194:195], v244 offset:512
    s_waitcnt lgkmcnt(12)
    v_mfma_f32_32x32x16_bf16 v[160:175], v[200:203], v[20:23], v[160:175]
    v_cvt_pk_bf16_f32 v224, v128, v129
    v_cvt_pk_bf16_f32 v225, v130, v131
    v_mul_f32 v236, v132, v132
    v_mul_f32 v237, v133, v133
    ds_read_b64_tr_b16 v[196:197], v244 offset:16384
    ds_read_b64_tr_b16 v[198:199], v244 offset:16896
    s_waitcnt lgkmcnt(12)
    v_mfma_f32_32x32x16_bf16 v[176:191], v[204:207], v[20:23], v[176:191]
    v_mul_f32 v238, v134, v134
    v_mul_f32 v239, v135, v135
    s_nop 0
    v_fma_f32 v236, v236, s63, v246
    v_fma_f32 v237, v237, s63, v246
    ds_read_b64_tr_b16 v[200:201], v244 offset:2048
    ds_read_b64_tr_b16 v[202:203], v244 offset:2560
    s_waitcnt lgkmcnt(12)
    v_mfma_f32_32x32x16_bf16 v[160:175], v[208:211], v[24:27], v[160:175]
    v_fma_f32 v238, v238, s63, v246
    v_fma_f32 v239, v239, s63, v246
    v_mul_f32 v236, v236, v132
    v_mul_f32 v237, v237, v133
    ds_read_b64_tr_b16 v[204:205], v244 offset:18432
    ds_read_b64_tr_b16 v[206:207], v244 offset:18944
    s_waitcnt lgkmcnt(12)
    v_mfma_f32_32x32x16_bf16 v[176:191], v[212:215], v[24:27], v[176:191]
    s_add_u32 s56, s71, 0x5000
    s_add_u32 m0, s73, 0xc00
    s_nop 0
    buffer_load_dwordx4 v252, s[20:23], s56 offen lds
    v_mul_f32 v238, v238, v134
    v_mul_f32 v239, v239, v135
    v_exp_f32 v236, v236
    v_exp_f32 v237, v237
    ds_read_b64_tr_b16 v[208:209], v244 offset:4096
    ds_read_b64_tr_b16 v[210:211], v244 offset:4608
    s_waitcnt lgkmcnt(12)
    v_mfma_f32_32x32x16_bf16 v[160:175], v[216:219], v[28:31], v[160:175]
    v_exp_f32 v238, v238
    v_exp_f32 v239, v239
    v_mul_f32 v132, v132, v148
    v_mul_f32 v133, v133, v149
    ds_read_b64_tr_b16 v[212:213], v244 offset:20480
    ds_read_b64_tr_b16 v[214:215], v244 offset:20992
    s_waitcnt lgkmcnt(12)
    v_mfma_f32_32x32x16_bf16 v[176:191], v[220:223], v[28:31], v[176:191]
    v_mul_f32 v134, v134, v150
    v_mul_f32 v135, v135, v151
    v_add_f32 v236, 1.0, v236
    v_add_f32 v237, 1.0, v237
    s_waitcnt vmcnt(8)
    s_barrier
    ds_read_b64_tr_b16 v[216:217], v244 offset:6144
    ds_read_b64_tr_b16 v[218:219], v244 offset:6656
    s_waitcnt lgkmcnt(12)
    v_mfma_f32_32x32x16_bf16 v[160:175], v[192:195], v[32:35], v[160:175]
    s_cmp_lt_u32 s40, 4
    s_cbranch_scc1 L_pr_22
    s_setprio 1
L_pr_22:
    v_add_f32 v238, 1.0, v238
    v_add_f32 v239, 1.0, v239
    v_rcp_f32 v236, v236
    v_rcp_f32 v237, v237
    ds_read_b64_tr_b16 v[220:221], v244 offset:22528
    ds_read_b64_tr_b16 v[222:223], v244 offset:23040
    s_waitcnt lgkmcnt(12)
    v_mfma_f32_32x32x16_bf16 v[176:191], v[196:199], v[32:35], v[176:191]
    s_add_u32 s56, s71, 0x10000
    s_add_u32 m0, s73, 0x8000
    s_nop 0
    buffer_load_dwordx4 v252, s[20:23], s56 offen lds
    v_rcp_f32 v238, v238
    v_rcp_f32 v239, v239
    v_mul_f32 v132, v132, v236
    v_mul_f32 v133, v133, v237
    ds_read_b64_tr_b16 v[192:193], v244 offset:8192
    ds_read_b64_tr_b16 v[194:195], v244 offset:8704
    s_waitcnt lgkmcnt(12)
    v_mfma_f32_32x32x16_bf16 v[160:175], v[200:203], v[36:39], v[160:175]
    v_mul_f32 v134, v134, v238
    v_mul_f32 v135, v135, v239
    v_cvt_pk_bf16_f32 v226, v132, v133
    v_cvt_pk_bf16_f32 v227, v134, v135
    ds_read_b64_tr_b16 v[196:197], v244 offset:24576
    ds_read_b64_tr_b16 v[198:199], v244 offset:25088
    s_waitcnt lgkmcnt(12)
    v_mfma_f32_32x32x16_bf16 v[176:191], v[204:207], v[36:39], v[176:191]
    buffer_store_dwordx4 v[224:227], v250, s[32:35], s52 offen offset:0 sc1
    v_mul_f32 v232, v136, v136
    v_mul_f32 v233, v137, v137
    v_mul_f32 v234, v138, v138
    ds_read_b64_tr_b16 v[200:201], v244 offset:10240
    ds_read_b64_tr_b16 v[202:203], v244 offset:10752
    s_waitcnt lgkmcnt(12)
    v_mfma_f32_32x32x16_bf16 v[160:175], v[208:211], v[40:43], v[160:175]
    v_mul_f32 v235, v139, v139
    v_fma_f32 v232, v232, s63, v246
    v_fma_f32 v233, v233, s63, v246
    v_fma_f32 v234, v234, s63, v246
    ds_read_b64_tr_b16 v[204:205], v244 offset:26624
    ds_read_b64_tr_b16 v[206:207], v244 offset:27136
    s_waitcnt lgkmcnt(12)
    v_mfma_f32_32x32x16_bf16 v[176:191], v[212:215], v[40:43], v[176:191]
    s_add_u32 s56, s71, 0x11000
    s_add_u32 m0, s73, 0x8400
    s_nop 0
    buffer_load_dwordx4 v252, s[20:23], s56 offen lds
    v_fma_f32 v235, v235, s63, v246
    v_mul_f32 v232, v232, v136
    v_mul_f32 v233, v233, v137
    v_mul_f32 v234, v234, v138
    ds_read_b64_tr_b16 v[208:209], v244 offset:12288
    ds_read_b64_tr_b16 v[210:211], v244 offset:12800
    s_waitcnt lgkmcnt(12)
    v_mfma_f32_32x32x16_bf16 v[160:175], v[216:219], v[44:47], v[160:175]
    v_mul_f32 v235, v235, v139
    v_exp_f32 v232, v232
    v_exp_f32 v233, v233
    v_exp_f32 v234, v234
    ds_read_b64_tr_b16 v[212:213], v244 offset:28672
    ds_read_b64_tr_b16 v[214:215], v244 offset:29184
    s_waitcnt lgkmcnt(12)
    v_mfma_f32_32x32x16_bf16 v[176:191], v[220:223], v[44:47], v[176:191]
    v_exp_f32 v235, v235
    v_mul_f32 v136, v136, v152
    v_mul_f32 v137, v137, v153
    v_mul_f32 v138, v138, v154
    ds_read_b64_tr_b16 v[216:217], v244 offset:14336
    ds_read_b64_tr_b16 v[218:219], v244 offset:14848
    s_waitcnt lgkmcnt(12)
    v_mfma_f32_32x32x16_bf16 v[160:175], v[192:195], v[48:51], v[160:175]
    s_cmp_lt_u32 s40, 4
    s_cbranch_scc1 L_pr_23
    s_setprio 0
L_pr_23:
    v_mul_f32 v139, v139, v155
    v_add_f32 v232, 1.0, v232
    v_add_f32 v233, 1.0, v233
    v_add_f32 v234, 1.0, v234
    ds_read_b64_tr_b16 v[220:221], v244 offset:30720
    ds_read_b64_tr_b16 v[222:223], v244 offset:31232
    s_waitcnt lgkmcnt(12)
    v_mfma_f32_32x32x16_bf16 v[176:191], v[196:199], v[48:51], v[176:191]
    s_add_u32 s56, s71, 0x14000
    s_add_u32 m0, s73, 0x8800
    s_nop 0
    buffer_load_dwordx4 v252, s[20:23], s56 offen lds
    v_add_f32 v235, 1.0, v235
    v_rcp_f32 v232, v232
    v_rcp_f32 v233, v233
    v_rcp_f32 v234, v234
    ds_read_b64_tr_b16 v[192:193], v244 offset:32768
    ds_read_b64_tr_b16 v[194:195], v244 offset:33280
    s_waitcnt lgkmcnt(12)
    v_mfma_f32_32x32x16_bf16 v[160:175], v[200:203], v[52:55], v[160:175]
    v_rcp_f32 v235, v235
    v_mul_f32 v136, v136, v232
    v_mul_f32 v137, v137, v233
    v_mul_f32 v138, v138, v234
    ds_read_b64_tr_b16 v[196:197], v244 offset:49152
    ds_read_b64_tr_b16 v[198:199], v244 offset:49664
    s_waitcnt lgkmcnt(12)
    v_mfma_f32_32x32x16_bf16 v[176:191], v[204:207], v[52:55], v[176:191]
    v_mul_f32 v139, v139, v235
    v_cvt_pk_bf16_f32 v228, v136, v137
    v_cvt_pk_bf16_f32 v229, v138, v139
    v_mul_f32 v236, v140, v140
    ds_read_b64_tr_b16 v[200:201], v244 offset:34816
    ds_read_b64_tr_b16 v[202:203], v244 offset:35328
    s_waitcnt lgkmcnt(12)
    v_mfma_f32_32x32x16_bf16 v[160:175], v[208:211], v[56:59], v[160:175]
    v_mul_f32 v237, v141, v141
    v_mul_f32 v238, v142, v142
    v_mul_f32 v239, v143, v143
    v_fma_f32 v236, v236, s63, v246
    ds_read_b64_tr_b16 v[204:205], v244 offset:51200
    ds_read_b64_tr_b16 v[206:207], v244 offset:51712
    s_waitcnt lgkmcnt(12)
    v_mfma_f32_32x32x16_bf16 v[176:191], v[212:215], v[56:59], v[176:191]
    s_add_u32 s56, s71, 0x15000
    s_add_u32 m0, s73, 0x8c00
    s_nop 0
    s_nop 0
    buffer_load_dwordx4 v252, s[20:23], s56 offen lds
    v_fma_f32 v237, v237, s63, v246
    v_fma_f32 v238, v238, s63, v246
    v_fma_f32 v239, v239, s63, v246
    v_mul_f32 v236, v236, v140
    ds_read_b64_tr_b16 v[208:209], v244 offset:36864
    ds_read_b64_tr_b16 v[210:211], v244 offset:37376
    s_waitcnt lgkmcnt(12)
    v_mfma_f32_32x32x16_bf16 v[160:175], v[216:219], v[60:63], v[160:175]
    v_mul_f32 v237, v237, v141
    v_mul_f32 v238, v238, v142
    v_mul_f32 v239, v239, v143
    v_exp_f32 v236, v236
    ds_read_b64_tr_b16 v[212:213], v244 offset:53248
    ds_read_b64_tr_b16 v[214:215], v244 offset:53760
    s_waitcnt lgkmcnt(12)
    v_mfma_f32_32x32x16_bf16 v[176:191], v[220:223], v[60:63], v[176:191]
    v_exp_f32 v237, v237
    v_exp_f32 v238, v238
    v_exp_f32 v239, v239
    v_mul_f32 v140, v140, v156
    s_waitcnt vmcnt(9)
    s_barrier
    ds_read_b64_tr_b16 v[216:217], v244 offset:38912
    ds_read_b64_tr_b16 v[218:219], v244 offset:39424
    s_waitcnt lgkmcnt(12)
    v_mfma_f32_32x32x16_bf16 v[160:175], v[192:195], v[64:67], v[160:175]
    s_cmp_lt_u32 s40, 4
    s_cbranch_scc1 L_pr_24
    s_setprio 1
L_pr_24:
    v_mul_f32 v141, v141, v157
    v_mul_f32 v142, v142, v158
    v_mul_f32 v143, v143, v159
    v_add_f32 v236, 1.0, v236
    ds_read_b64_tr_b16 v[220:221], v244 offset:55296
    ds_read_b64_tr_b16 v[222:223], v244 offset:55808
    s_waitcnt lgkmcnt(12)
    v_mfma_f32_32x32x16_bf16 v[176:191], v[196:199], v[64:67], v[176:191]
    s_add_u32 s56, s71, 0x20000
    s_add_u32 m0, s73, 0x10000
    s_nop 0
    buffer_load_dwordx4 v252, s[20:23], s56 offen lds
    v_add_f32 v237, 1.0, v237
    v_add_f32 v238, 1.0, v238
    v_add_f32 v239, 1.0, v239
    v_rcp_f32 v236, v236
    ds_read_b64_tr_b16 v[192:193], v244 offset:40960
    ds_read_b64_tr_b16 v[194:195], v244 offset:41472
    s_waitcnt lgkmcnt(12)
    v_mfma_f32_32x32x16_bf16 v[160:175], v[200:203], v[68:71], v[160:175]
    v_rcp_f32 v237, v237
    v_rcp_f32 v238, v238
    v_rcp_f32 v239, v239
    v_mul_f32 v140, v140, v236
    ds_read_b64_tr_b16 v[196:197], v244 offset:57344
    ds_read_b64_tr_b16 v[198:199], v244 offset:57856
    s_waitcnt lgkmcnt(12)
    v_mfma_f32_32x32x16_bf16 v[176:191], v[204:207], v[68:71], v[176:191]
    v_mul_f32 v141, v141, v237
    v_mul_f32 v142, v142, v238
    v_mul_f32 v143, v143, v239
    v_cvt_pk_bf16_f32 v230, v140, v141
    ds_read_b64_tr_b16 v[200:201], v244 offset:43008
    ds_read_b64_tr_b16 v[202:203], v244 offset:43520
    s_waitcnt lgkmcnt(12)
    s_nop 0
    v_mfma_f32_32x32x16_bf16 v[160:175], v[208:211], v[72:75], v[160:175]
    v_cvt_pk_bf16_f32 v231, v142, v143
    buffer_store_dwordx4 v[228:231], v250, s[32:35], s52 offen offset:1024 sc1
    ds_read_b64_tr_b16 v[204:205], v244 offset:59392
    ds_read_b64_tr_b16 v[206:207], v244 offset:59904
    s_waitcnt lgkmcnt(12)
    v_mfma_f32_32x32x16_bf16 v[176:191], v[212:215], v[72:75], v[176:191]
    s_add_u32 s56, s71, 0x21000
    s_add_u32 m0, s73, 0x10400
    s_nop 0
    buffer_load_dwordx4 v252, s[20:23], s56 offen lds
    ds_read_b64_tr_b16 v[208:209], v244 offset:45056
    ds_read_b64_tr_b16 v[210:211], v244 offset:45568
    s_waitcnt lgkmcnt(12)
    v_mfma_f32_32x32x16_bf16 v[160:175], v[216:219], v[76:79], v[160:175]
    ds_read_b64_tr_b16 v[212:213], v244 offset:61440
    ds_read_b64_tr_b16 v[214:215], v244 offset:61952
    s_waitcnt lgkmcnt(12)
    v_mfma_f32_32x32x16_bf16 v[176:191], v[220:223], v[76:79], v[176:191]
    ds_read_b64_tr_b16 v[216:217], v244 offset:47104
    ds_read_b64_tr_b16 v[218:219], v244 offset:47616
    s_waitcnt lgkmcnt(12)
    v_mfma_f32_32x32x16_bf16 v[160:175], v[192:195], v[80:83], v[160:175]
    s_cmp_lt_u32 s40, 4
    s_cbranch_scc1 L_pr_25
    s_setprio 0
L_pr_25:
    ds_read_b64_tr_b16 v[220:221], v244 offset:63488
    ds_read_b64_tr_b16 v[222:223], v244 offset:64000
    s_waitcnt lgkmcnt(12)
    v_mfma_f32_32x32x16_bf16 v[176:191], v[196:199], v[80:83], v[176:191]
    s_add_u32 s56, s71, 0x24000
    s_add_u32 m0, s73, 0x10800
    s_nop 0
    buffer_load_dwordx4 v252, s[20:23], s56 offen lds
    ds_read_b64_tr_b16 v[192:193], v245 offset:0
    ds_read_b64_tr_b16 v[194:195], v245 offset:512
    s_waitcnt lgkmcnt(12)
    v_mfma_f32_32x32x16_bf16 v[160:175], v[200:203], v[84:87], v[160:175]
    ds_read_b64_tr_b16 v[196:197], v245 offset:16384
    ds_read_b64_tr_b16 v[198:199], v245 offset:16896
    s_waitcnt lgkmcnt(12)
    v_mfma_f32_32x32x16_bf16 v[176:191], v[204:207], v[84:87], v[176:191]
    ds_read_b64_tr_b16 v[200:201], v245 offset:2048
    ds_read_b64_tr_b16 v[202:203], v245 offset:2560
    s_waitcnt lgkmcnt(12)
    v_mfma_f32_32x32x16_bf16 v[160:175], v[208:211], v[88:91], v[160:175]
    ds_read_b64_tr_b16 v[204:205], v245 offset:18432
    ds_read_b64_tr_b16 v[206:207], v245 offset:18944
    s_waitcnt lgkmcnt(12)
    v_mfma_f32_32x32x16_bf16 v[176:191], v[212:215], v[88:91], v[176:191]
    s_add_u32 s56, s71, 0x25000
    s_add_u32 m0, s73, 0x10c00
    s_nop 0
    buffer_load_dwordx4 v252, s[20:23], s56 offen lds
    ds_read_b64_tr_b16 v[208:209], v245 offset:4096
    ds_read_b64_tr_b16 v[210:211], v245 offset:4608
    s_waitcnt lgkmcnt(12)
    v_mfma_f32_32x32x16_bf16 v[160:175], v[216:219], v[92:95], v[160:175]
    ds_read_b64_tr_b16 v[212:213], v245 offset:20480
    ds_read_b64_tr_b16 v[214:215], v245 offset:20992
    s_waitcnt lgkmcnt(12)
    v_mfma_f32_32x32x16_bf16 v[176:191], v[220:223], v[92:95], v[176:191]
    s_waitcnt vmcnt(10)
    s_barrier
    v_lshrrev_b32 v255, 8, v250
    v_min_u32 v255, 2, v255
    v_sub_u32 v255, s41, v255
    v_max_i32 v255, 0, v255
    v_bfe_u32 v254, v250, 4, 4
    v_lshlrev_b32 v254, 2, v254
    v_lshl_add_u32 v254, v255, 7, v254
    v_add_u32 v254, 0x1000000, v254
    buffer_load_dword v255, v254, s[32:35], 0 offen sc0 sc1
    ds_read_b64_tr_b16 v[216:217], v245 offset:6144
    ds_read_b64_tr_b16 v[218:219], v245 offset:6656
    s_waitcnt lgkmcnt(12)
    v_mfma_f32_32x32x16_bf16 v[160:175], v[192:195], v[96:99], v[160:175]
    s_cmp_lt_u32 s40, 4
    s_cbranch_scc1 L_pr_26
    s_setprio 1
L_pr_26:
    ds_read_b64_tr_b16 v[220:221], v245 offset:22528
    ds_read_b64_tr_b16 v[222:223], v245 offset:23040
    s_waitcnt lgkmcnt(12)
    v_mfma_f32_32x32x16_bf16 v[176:191], v[196:199], v[96:99], v[176:191]
    s_add_u32 s56, s71, 0x30000
    s_add_u32 m0, s73, 0x18000
    s_nop 0
    buffer_load_dwordx4 v252, s[20:23], s56 offen lds
    ds_read_b64_tr_b16 v[192:193], v245 offset:8192
    ds_read_b64_tr_b16 v[194:195], v245 offset:8704
    s_waitcnt lgkmcnt(12)
    v_mfma_f32_32x32x16_bf16 v[160:175], v[200:203], v[100:103], v[160:175]
    ds_read_b64_tr_b16 v[196:197], v245 offset:24576
    ds_read_b64_tr_b16 v[198:199], v245 offset:25088
    s_waitcnt lgkmcnt(12)
    v_mfma_f32_32x32x16_bf16 v[176:191], v[204:207], v[100:103], v[176:191]
    ds_read_b64_tr_b16 v[200:201], v245 offset:10240
    ds_read_b64_tr_b16 v[202:203], v245 offset:10752
    s_waitcnt lgkmcnt(12)
    v_mfma_f32_32x32x16_bf16 v[160:175], v[208:211], v[104:107], v[160:175]
    ds_read_b64_tr_b16 v[204:205], v245 offset:26624
    ds_read_b64_tr_b16 v[206:207], v245 offset:27136
    s_waitcnt lgkmcnt(12)
    v_mfma_f32_32x32x16_bf16 v[176:191], v[212:215], v[104:107], v[176:191]
    s_add_u32 s56, s71, 0x31000
    s_add_u32 m0, s73, 0x18400
    s_nop 0
    buffer_load_dwordx4 v252, s[20:23], s56 offen lds
    ds_read_b64_tr_b16 v[208:209], v245 offset:12288
    ds_read_b64_tr_b16 v[210:211], v245 offset:12800
    s_waitcnt lgkmcnt(12)
    v_mfma_f32_32x32x16_bf16 v[160:175], v[216:219], v[108:111], v[160:175]
    ds_read_b64_tr_b16 v[212:213], v245 offset:28672
    ds_read_b64_tr_b16 v[214:215], v245 offset:29184
    s_waitcnt lgkmcnt(12)
    v_mfma_f32_32x32x16_bf16 v[176:191], v[220:223], v[108:111], v[176:191]
    ds_read_b64_tr_b16 v[216:217], v245 offset:14336
    ds_read_b64_tr_b16 v[218:219], v245 offset:14848
    s_waitcnt lgkmcnt(12)
    v_mfma_f32_32x32x16_bf16 v[160:175], v[192:195], v[112:115], v[160:175]
    s_cmp_lt_u32 s40, 4
    s_cbranch_scc1 L_pr_27
    s_setprio 0
L_pr_27:
    ds_read_b64_tr_b16 v[220:221], v245 offset:30720
    ds_read_b64_tr_b16 v[222:223], v245 offset:31232
    s_waitcnt lgkmcnt(12)
    v_mfma_f32_32x32x16_bf16 v[176:191], v[196:199], v[112:115], v[176:191]
    s_add_u32 s56, s71, 0x34000
    s_add_u32 m0, s73, 0x18800
    s_nop 0
    buffer_load_dwordx4 v252, s[20:23], s56 offen lds
    s_waitcnt lgkmcnt(10)
    v_mfma_f32_32x32x16_bf16 v[160:175], v[200:203], v[116:119], v[160:175]
    s_waitcnt lgkmcnt(8)
    v_mfma_f32_32x32x16_bf16 v[176:191], v[204:207], v[116:119], v[176:191]
    s_waitcnt lgkmcnt(6)
    v_mfma_f32_32x32x16_bf16 v[160:175], v[208:211], v[120:123], v[160:175]
    s_waitcnt lgkmcnt(4)
    v_mfma_f32_32x32x16_bf16 v[176:191], v[212:215], v[120:123], v[176:191]
    s_add_u32 s56, s71, 0x35000
    s_add_u32 m0, s73, 0x18c00
    s_nop 0
    buffer_load_dwordx4 v252, s[20:23], s56 offen lds
    s_waitcnt lgkmcnt(2)
    v_mfma_f32_32x32x16_bf16 v[160:175], v[216:219], v[124:127], v[160:175]
    s_waitcnt lgkmcnt(0)
    v_mfma_f32_32x32x16_bf16 v[176:191], v[220:223], v[124:127], v[176:191]
    s_waitcnt vmcnt(4)
    s_mov_b32 s55, 0
    s_nop 9
L_flr_28:
    v_cmp_ne_u32 vcc, s94, v255
    s_nop 4
    s_cbranch_vccz L_fld_29
    s_sleep 1
    buffer_load_dword v255, v254, s[32:35], 0 offen sc0 sc1
    s_waitcnt vmcnt(0)
    s_add_u32 s55, s55, 1
    s_cmp_lt_u32 s55, 0x100000
    s_cbranch_scc1 L_flr_28
L_fld_29:
    s_lshl_b32 s75, s42, 3
    s_lshl_b32 s56, s43, 1
    s_add_u32 s75, s75, s56
    s_add_u32 s75, s75, s45
    s_lshl_b32 s74, s41, 2
    s_add_u32 s74, s74, s44
    s_lshl_b32 s56, s75, 6
    s_add_u32 s57, s56, s74
    s_lshl_b32 s57, s57, 10
    buffer_load_dwordx4 v[140:143], v250, s[32:35], s57 offen sc1
    s_add_i32 s57, s74, 0
    s_max_i32 s57, s57, 0
    s_add_u32 s57, s57, s56
    s_lshl_b32 s57, s57, 10
    s_add_u32 s58, s57, 0x200000
    buffer_load_dwordx4 v[136:139], v250, s[32:35], s58 offen sc1
    s_add_u32 s84, s57, 0x400000
    s_add_i32 s57, s74, -1
    s_max_i32 s57, s57, 0
    s_add_u32 s57, s57, s56
    s_lshl_b32 s57, s57, 10
    s_add_u32 s58, s57, 0x200000
    buffer_load_dwordx4 v[132:135], v250, s[32:35], s58 offen sc1
    s_add_u32 s83, s57, 0x400000
    s_add_i32 s57, s74, -2
    s_max_i32 s57, s57, 0
    s_add_u32 s57, s57, s56
    s_lshl_b32 s57, s57, 10
    s_add_u32 s58, s57, 0x200000
    buffer_load_dwordx4 v[128:131], v250, s[32:35], s58 offen sc1
    s_add_u32 s82, s57, 0x400000
    s_add_i32 s57, s74, -3
    s_max_i32 s57, s57, 0
    s_add_u32 s57, s57, s56
    s_lshl_b32 s57, s57, 10
    s_add_u32 s58, s57, 0x200000
    buffer_load_dwordx4 v[124:127], v250, s[32:35], s58 offen sc1
    s_add_u32 s81, s57, 0x400000
    s_add_i32 s57, s74, -4
    s_max_i32 s57, s57, 0
    s_add_u32 s57, s57, s56
    s_lshl_b32 s57, s57, 10
    s_add_u32 s58, s57, 0x200000
    buffer_load_dwordx4 v[120:123], v250, s[32:35], s58 offen sc1
    s_add_u32 s80, s57, 0x400000
    s_add_i32 s57, s74, -5
    s_max_i32 s57, s57, 0
    s_add_u32 s57, s57, s56
    s_lshl_b32 s57, s57, 10
    s_add_u32 s58, s57, 0x200000
    buffer_load_dwordx4 v[116:119], v250, s[32:35], s58 offen sc1
    s_add_u32 s79, s57, 0x400000
    s_add_i32 s57, s74, -6
    s_max_i32 s57, s57, 0
    s_add_u32 s57, s57, s56
    s_lshl_b32 s57, s57, 10
    s_add_u32 s58, s57, 0x200000
    buffer_load_dwordx4 v[112:115], v250, s[32:35], s58 offen sc1
    s_add_u32 s78, s57, 0x400000
    s_add_i32 s57, s74, -7
    s_max_i32 s57, s57, 0
    s_add_u32 s57, s57, s56
    s_lshl_b32 s57, s57, 10
    s_add_u32 s58, s57, 0x200000
    buffer_load_dwordx4 v[108:111], v250, s[32:35], s58 offen sc1
    s_add_u32 s77, s57, 0x400000
    s_add_i32 s57, s74, -8
    s_max_i32 s57, s57, 0
    s_add_u32 s57, s57, s56
    s_lshl_b32 s57, s57, 10
    s_add_u32 s58, s57, 0x200000
    buffer_load_dwordx4 v[104:107], v250, s[32:35], s58 offen sc1
    s_add_u32 s76, s57, 0x400000
    v_mul_f32 v232, v160, v160
    v_mul_f32 v233, v161, v161
    v_mul_f32 v234, v162, v162
    v_mul_f32 v235, v163, v163
    s_nop 0
    v_fma_f32 v232, v232, s63, v246
    v_fma_f32 v233, v233, s63, v246
    v_fma_f32 v234, v234, s63, v246
    v_fma_f32 v235, v235, s63, v246
    v_mul_f32 v232, v232, v160
    v_mul_f32 v233, v233, v161
    v_mul_f32 v234, v234, v162
    v_mul_f32 v235, v235, v163
    v_exp_f32 v232, v232
    v_exp_f32 v233, v233
    v_exp_f32 v234, v234
    v_exp_f32 v235, v235
    v_mul_f32 v160, v160, v176
    v_mul_f32 v161, v161, v177
    v_mul_f32 v162, v162, v178
    v_mul_f32 v163, v163, v179
    v_add_f32 v232, 1.0, v232
    v_add_f32 v233, 1.0, v233
    v_add_f32 v234, 1.0, v234
    v_add_f32 v235, 1.0, v235
    v_rcp_f32 v232, v232
    v_rcp_f32 v233, v233
    v_rcp_f32 v234, v234
    v_rcp_f32 v235, v235
    v_mul_f32 v160, v160, v232
    v_mul_f32 v161, v161, v233
    v_mul_f32 v162, v162, v234
    v_mul_f32 v163, v163, v235
    v_cvt_pk_bf16_f32 v224, v160, v161
    v_cvt_pk_bf16_f32 v225, v162, v163
    v_mul_f32 v236, v164, v164
    v_mul_f32 v237, v165, v165
    v_mul_f32 v238, v166, v166
    v_mul_f32 v239, v167, v167
    v_fma_f32 v236, v236, s63, v246
    v_fma_f32 v237, v237, s63, v246
    v_fma_f32 v238, v238, s63, v246
    v_fma_f32 v239, v239, s63, v246
    v_mul_f32 v236, v236, v164
    v_mul_f32 v237, v237, v165
    v_mul_f32 v238, v238, v166
    v_mul_f32 v239, v239, v167
    v_exp_f32 v236, v236
    v_exp_f32 v237, v237
    v_exp_f32 v238, v238
    v_exp_f32 v239, v239
    v_mul_f32 v164, v164, v180
    v_mul_f32 v165, v165, v181
    v_mul_f32 v166, v166, v182
    v_mul_f32 v167, v167, v183
    v_add_f32 v236, 1.0, v236
    v_add_f32 v237, 1.0, v237
    v_add_f32 v238, 1.0, v238
    v_add_f32 v239, 1.0, v239
    v_rcp_f32 v236, v236
    v_rcp_f32 v237, v237
    v_rcp_f32 v238, v238
    v_rcp_f32 v239, v239
    v_mul_f32 v164, v164, v236
    v_mul_f32 v165, v165, v237
    v_mul_f32 v166, v166, v238
    v_mul_f32 v167, v167, v239
    v_cvt_pk_bf16_f32 v226, v164, v165
    v_cvt_pk_bf16_f32 v227, v166, v167
    buffer_store_dwordx4 v[224:227], v250, s[32:35], s53 offen offset:0 sc1
    v_mul_f32 v232, v168, v168
    v_mul_f32 v233, v169, v169
    v_mul_f32 v234, v170, v170
    v_mul_f32 v235, v171, v171
    v_fma_f32 v232, v232, s63, v246
    v_fma_f32 v233, v233, s63, v246
    v_fma_f32 v234, v234, s63, v246
    v_fma_f32 v235, v235, s63, v246
    v_mul_f32 v232, v232, v168
    v_mul_f32 v233, v233, v169
    v_mul_f32 v234, v234, v170
    v_mul_f32 v235, v235, v171
    v_exp_f32 v232, v232
    v_exp_f32 v233, v233
    v_exp_f32 v234, v234
    v_exp_f32 v235, v235
    v_mul_f32 v168, v168, v184
    v_mul_f32 v169, v169, v185
    v_mul_f32 v170, v170, v186
    v_mul_f32 v171, v171, v187
    v_add_f32 v232, 1.0, v232
    v_add_f32 v233, 1.0, v233
    v_add_f32 v234, 1.0, v234
    v_add_f32 v235, 1.0, v235
    v_rcp_f32 v232, v232
    v_rcp_f32 v233, v233
    v_rcp_f32 v234, v234
    v_rcp_f32 v235, v235
    v_mul_f32 v168, v168, v232
    v_mul_f32 v169, v169, v233
    v_mul_f32 v170, v170, v234
    v_mul_f32 v171, v171, v235
    v_cvt_pk_bf16_f32 v228, v168, v169
    v_cvt_pk_bf16_f32 v229, v170, v171
    v_mul_f32 v236, v172, v172
    v_mul_f32 v237, v173, v173
    v_mul_f32 v238, v174, v174
    v_mul_f32 v239, v175, v175
    v_fma_f32 v236, v236, s63, v246
    v_fma_f32 v237, v237, s63, v246
    v_fma_f32 v238, v238, s63, v246
    v_fma_f32 v239, v239, s63, v246
    v_mul_f32 v236, v236, v172
    v_mul_f32 v237, v237, v173
    v_mul_f32 v238, v238, v174
    v_mul_f32 v239, v239, v175
    v_exp_f32 v236, v236
    v_exp_f32 v237, v237
    v_exp_f32 v238, v238
    v_exp_f32 v239, v239
    v_mul_f32 v172, v172, v188
    v_mul_f32 v173, v173, v189
    v_mul_f32 v174, v174, v190
    v_mul_f32 v175, v175, v191
    v_add_f32 v236, 1.0, v236
    v_add_f32 v237, 1.0, v237
    v_add_f32 v238, 1.0, v238
    v_add_f32 v239, 1.0, v239
    v_rcp_f32 v236, v236
    v_rcp_f32 v237, v237
    v_rcp_f32 v238, v238
    v_rcp_f32 v239, v239
    v_mul_f32 v172, v172, v236
    v_mul_f32 v173, v173, v237
    v_mul_f32 v174, v174, v238
    v_mul_f32 v175, v175, v239
    v_cvt_pk_bf16_f32 v230, v172, v173
    v_cvt_pk_bf16_f32 v231, v174, v175
    buffer_store_dwordx4 v[228:231], v250, s[32:35], s53 offen offset:1024 sc1
    v_mov_b32 v192, s60
    v_mov_b32 v193, s60
    v_mov_b32 v194, s60
    v_mov_b32 v195, s60
    v_mov_b32 v196, s60
    v_mov_b32 v197, s60
    v_mov_b32 v198, s60
    v_mov_b32 v199, s60
    s_mov_b32 exec_lo, 0x0000ffff
    s_mov_b32 exec_hi, 0x0000ffff
    buffer_load_dwordx4 v[192:195], v250, s[32:35], s76 offen sc1
    s_mov_b32 exec_lo, 0xffff0000
    s_mov_b32 exec_hi, 0xffff0000
    buffer_load_dwordx4 v[196:199], v250, s[32:35], s76 offen sc1
    s_mov_b64 exec, -1
    v_mov_b32 v200, s60
    v_mov_b32 v201, s60
    v_mov_b32 v202, s60
    v_mov_b32 v203, s60
    v_mov_b32 v204, s60
    v_mov_b32 v205, s60
    v_mov_b32 v206, s60
    v_mov_b32 v207, s60
    s_nop 0
    s_mov_b32 exec_lo, 0x0000ffff
    s_mov_b32 exec_hi, 0x0000ffff
    buffer_load_dwordx4 v[200:203], v250, s[32:35], s77 offen sc1
    s_mov_b32 exec_lo, 0xffff0000
    s_mov_b32 exec_hi, 0xffff0000
    buffer_load_dwordx4 v[204:207], v250, s[32:35], s77 offen sc1
    s_mov_b64 exec, -1
    v_mov_b32 v208, s60
    v_mov_b32 v209, s60
    v_mov_b32 v210, s60
    v_mov_b32 v211, s60
    v_mov_b32 v212, s60
    v_mov_b32 v213, s60
    v_mov_b32 v214, s60
    v_mov_b32 v215, s60
    s_nop 0
    s_mov_b32 exec_lo, 0x0000ffff
    s_mov_b32 exec_hi, 0x0000ffff
    buffer_load_dwordx4 v[208:211], v250, s[32:35], s78 offen sc1
    s_mov_b32 exec_lo, 0xffff0000
    s_mov_b32 exec_hi, 0xffff0000
    buffer_load_dwordx4 v[212:215], v250, s[32:35], s78 offen sc1
    s_mov_b64 exec, -1
    v_mov_b32 v32, s60
    v_mov_b32 v33, s60
    v_mov_b32 v34, s60
    v_mov_b32 v35, s60
    v_mov_b32 v36, s60
    v_mov_b32 v37, s60
    v_mov_b32 v38, s60
    v_mov_b32 v39, s60
    s_nop 0
    s_mov_b32 exec_lo, 0x0000ffff
    s_mov_b32 exec_hi, 0x0000ffff
    buffer_load_dwordx4 v[32:35], v250, s[32:35], s79 offen sc1
    s_mov_b32 exec_lo, 0xffff0000
    s_mov_b32 exec_hi, 0xffff0000
    buffer_load_dwordx4 v[36:39], v250, s[32:35], s79 offen sc1
    s_mov_b64 exec, -1
    v_mov_b32 v40, s60
    v_mov_b32 v41, s60
    v_mov_b32 v42, s60
    v_mov_b32 v43, s60
    v_mov_b32 v44, s60
    v_mov_b32 v45, s60
    v_mov_b32 v46, s60
    v_mov_b32 v47, s60
    s_nop 0
    s_mov_b32 exec_lo, 0x0000ffff
    s_mov_b32 exec_hi, 0x0000ffff
    buffer_load_dwordx4 v[40:43], v250, s[32:35], s80 offen sc1
    s_mov_b32 exec_lo, 0xffff0000
    s_mov_b32 exec_hi, 0xffff0000
    buffer_load_dwordx4 v[44:47], v250, s[32:35], s80 offen sc1
    s_mov_b64 exec, -1
    v_mov_b32 v48, s60
    v_mov_b32 v49, s60
    v_mov_b32 v50, s60
    v_mov_b32 v51, s60
    v_mov_b32 v52, s60
    v_mov_b32 v53, s60
    v_mov_b32 v54, s60
    v_mov_b32 v55, s60
    s_nop 0
    s_mov_b32 exec_lo, 0x0000ffff
    s_mov_b32 exec_hi, 0x0000ffff
    buffer_load_dwordx4 v[48:51], v250, s[32:35], s81 offen sc1
    s_mov_b32 exec_lo, 0xffff0000
    s_mov_b32 exec_hi, 0xffff0000
    buffer_load_dwordx4 v[52:55], v250, s[32:35], s81 offen sc1
    s_mov_b64 exec, -1
    v_mov_b32 v56, s60
    v_mov_b32 v57, s60
    v_mov_b32 v58, s60
    v_mov_b32 v59, s60
    v_mov_b32 v60, s60
    v_mov_b32 v61, s60
    v_mov_b32 v62, s60
    v_mov_b32 v63, s60
    s_nop 0
    s_mov_b32 exec_lo, 0x0000ffff
    s_mov_b32 exec_hi, 0x0000ffff
    buffer_load_dwordx4 v[56:59], v250, s[32:35], s82 offen sc1
    s_mov_b32 exec_lo, 0xffff0000
    s_mov_b32 exec_hi, 0xffff0000
    buffer_load_dwordx4 v[60:63], v250, s[32:35], s82 offen sc1
    s_mov_b64 exec, -1
    v_mov_b32 v64, s60
    v_mov_b32 v65, s60
    v_mov_b32 v66, s60
    v_mov_b32 v67, s60
    v_mov_b32 v68, s60
    v_mov_b32 v69, s60
    v_mov_b32 v70, s60
    v_mov_b32 v71, s60
    s_nop 0
    s_mov_b32 exec_lo, 0x0000ffff
    s_mov_b32 exec_hi, 0x0000ffff
    buffer_load_dwordx4 v[64:67], v250, s[32:35], s83 offen sc1
    s_mov_b32 exec_lo, 0xffff0000
    s_mov_b32 exec_hi, 0xffff0000
    buffer_load_dwordx4 v[68:71], v250, s[32:35], s83 offen sc1
    s_mov_b64 exec, -1
    v_mov_b32 v72, s60
    v_mov_b32 v73, s60
    v_mov_b32 v74, s60
    v_mov_b32 v75, s60
    v_mov_b32 v76, s60
    v_mov_b32 v77, s60
    v_mov_b32 v78, s60
    v_mov_b32 v79, s60
    s_nop 0
    s_mov_b32 exec_lo, 0x0000ffff
    s_mov_b32 exec_hi, 0x0000ffff
    buffer_load_dwordx4 v[72:75], v250, s[32:35], s84 offen sc1
    s_mov_b32 exec_lo, 0xffff0000
    s_mov_b32 exec_hi, 0xffff0000
    buffer_load_dwordx4 v[76:79], v250, s[32:35], s84 offen sc1
    s_mov_b64 exec, -1
    s_branch L_p1join_3
L_Av_4:
    ds_read_b64_tr_b16 v[192:193], v243 offset:0
    ds_read_b64_tr_b16 v[194:195], v243 offset:512
    ds_read_b64_tr_b16 v[196:197], v243 offset:2048
    ds_read_b64_tr_b16 v[198:199], v243 offset:2560
    ds_read_b64_tr_b16 v[200:201], v243 offset:4096
    ds_read_b64_tr_b16 v[202:203], v243 offset:4608
    ds_read_b64_tr_b16 v[204:205], v243 offset:6144
    ds_read_b64_tr_b16 v[206:207], v243 offset:6656
    ds_read_b64_tr_b16 v[208:209], v243 offset:8192
    ds_read_b64_tr_b16 v[210:211], v243 offset:8704
    ds_read_b64_tr_b16 v[212:213], v243 offset:10240
    ds_read_b64_tr_b16 v[214:215], v243 offset:10752
    ds_read_b64_tr_b16 v[216:217], v243 offset:12288
    ds_read_b64_tr_b16 v[218:219], v243 offset:12800
    s_waitcnt lgkmcnt(12)
    v_mfma_f32_32x32x16_bf16 v[160:175], v[0:3], v[192:195], 0
    s_cmp_lt_u32 s40, 4
    s_cbranch_scc1 L_pr_30
    s_setprio 1
L_pr_30:
    ds_read_b64_tr_b16 v[220:221], v243 offset:14336
    ds_read_b64_tr_b16 v[222:223], v243 offset:14848
    s_waitcnt lgkmcnt(12)
    v_mfma_f32_32x32x16_bf16 v[160:175], v[4:7], v[196:199], v[160:175]
    s_add_u32 s56, s48, 0x0
    s_add_u32 m0, s46, 0x10000
    s_nop 0
    buffer_load_dwordx4 v253, s[12:15], s56 offen lds
    ds_read_b64_tr_b16 v[192:193], v243 offset:16384
    ds_read_b64_tr_b16 v[194:195], v243 offset:16896
    s_waitcnt lgkmcnt(12)
    v_mfma_f32_32x32x16_bf16 v[160:175], v[8:11], v[200:203], v[160:175]
    ds_read_b64_tr_b16 v[196:197], v243 offset:18432
    ds_read_b64_tr_b16 v[198:199], v243 offset:18944
    s_waitcnt lgkmcnt(12)
    v_mfma_f32_32x32x16_bf16 v[160:175], v[12:15], v[204:207], v[160:175]
    s_add_u32 s56, s48, 0x0
    s_add_u32 m0, s46, 0x14000
    s_nop 0
    buffer_load_dwordx4 v253, s[16:19], s56 offen lds
    ds_read_b64_tr_b16 v[200:201], v243 offset:20480
    ds_read_b64_tr_b16 v[202:203], v243 offset:20992
    s_waitcnt lgkmcnt(12)
    v_mfma_f32_32x32x16_bf16 v[160:175], v[16:19], v[208:211], v[160:175]
    ds_read_b64_tr_b16 v[204:205], v243 offset:22528
    ds_read_b64_tr_b16 v[206:207], v243 offset:23040
    s_waitcnt lgkmcnt(12)
    v_mfma_f32_32x32x16_bf16 v[160:175], v[20:23], v[212:215], v[160:175]
    s_add_u32 s56, s48, 0x38000
    s_add_u32 m0, s46, 0x12000
    s_nop 0
    buffer_load_dwordx4 v253, s[12:15], s56 offen lds
    ds_read_b64_tr_b16 v[208:209], v243 offset:24576
    ds_read_b64_tr_b16 v[210:211], v243 offset:25088
    s_waitcnt lgkmcnt(12)
    v_mfma_f32_32x32x16_bf16 v[160:175], v[24:27], v[216:219], v[160:175]
    ds_read_b64_tr_b16 v[212:213], v243 offset:26624
    ds_read_b64_tr_b16 v[214:215], v243 offset:27136
    s_waitcnt lgkmcnt(12)
    v_mfma_f32_32x32x16_bf16 v[160:175], v[28:31], v[220:223], v[160:175]
    s_add_u32 s56, s48, 0x38000
    s_add_u32 m0, s46, 0x16000
    s_nop 0
    buffer_load_dwordx4 v253, s[16:19], s56 offen lds
    ds_read_b64_tr_b16 v[216:217], v243 offset:28672
    ds_read_b64_tr_b16 v[218:219], v243 offset:29184
    s_waitcnt lgkmcnt(12)
    v_mfma_f32_32x32x16_bf16 v[160:175], v[32:35], v[192:195], v[160:175]
    s_cmp_lt_u32 s40, 4
    s_cbranch_scc1 L_pr_31
    s_setprio 0
L_pr_31:
    ds_read_b64_tr_b16 v[220:221], v243 offset:30720
    ds_read_b64_tr_b16 v[222:223], v243 offset:31232
    s_waitcnt lgkmcnt(12)
    v_mfma_f32_32x32x16_bf16 v[160:175], v[36:39], v[196:199], v[160:175]
    s_add_u32 s56, s48, 0x70000
    s_add_u32 m0, s46, 0x18000
    s_nop 0
    buffer_load_dwordx4 v253, s[12:15], s56 offen lds
    s_waitcnt vmcnt(5)
    s_barrier
    ds_read_b64_tr_b16 v[192:193], v243 offset:32768
    ds_read_b64_tr_b16 v[194:195], v243 offset:33280
    s_waitcnt lgkmcnt(12)
    v_mfma_f32_32x32x16_bf16 v[160:175], v[40:43], v[200:203], v[160:175]
    ds_read_b64_tr_b16 v[196:197], v243 offset:34816
    ds_read_b64_tr_b16 v[198:199], v243 offset:35328
    s_waitcnt lgkmcnt(12)
    v_mfma_f32_32x32x16_bf16 v[160:175], v[44:47], v[204:207], v[160:175]
    s_add_u32 s56, s48, 0x70000
    s_add_u32 m0, s46, 0x1c000
    s_nop 0
    buffer_load_dwordx4 v253, s[16:19], s56 offen lds
    ds_read_b64_tr_b16 v[200:201], v243 offset:36864
    ds_read_b64_tr_b16 v[202:203], v243 offset:37376
    s_waitcnt lgkmcnt(12)
    v_mfma_f32_32x32x16_bf16 v[160:175], v[48:51], v[208:211], v[160:175]
    ds_read_b64_tr_b16 v[204:205], v243 offset:38912
    ds_read_b64_tr_b16 v[206:207], v243 offset:39424
    s_waitcnt lgkmcnt(12)
    v_mfma_f32_32x32x16_bf16 v[160:175], v[52:55], v[212:215], v[160:175]
    s_add_u32 s56, s48, 0xa8000
    s_add_u32 m0, s46, 0x1a000
    s_nop 0
    buffer_load_dwordx4 v253, s[12:15], s56 offen lds
    ds_read_b64_tr_b16 v[208:209], v243 offset:40960
    ds_read_b64_tr_b16 v[210:211], v243 offset:41472
    s_waitcnt lgkmcnt(12)
    v_mfma_f32_32x32x16_bf16 v[160:175], v[56:59], v[216:219], v[160:175]
    ds_read_b64_tr_b16 v[212:213], v243 offset:43008
    ds_read_b64_tr_b16 v[214:215], v243 offset:43520
    s_waitcnt lgkmcnt(12)
    v_mfma_f32_32x32x16_bf16 v[160:175], v[60:63], v[220:223], v[160:175]
    s_add_u32 s56, s48, 0xa8000
    s_add_u32 m0, s46, 0x1e000
    s_nop 0
    buffer_load_dwordx4 v253, s[16:19], s56 offen lds
    s_waitcnt vmcnt(4)
    s_barrier
    ds_read_b64_tr_b16 v[216:217], v243 offset:45056
    ds_read_b64_tr_b16 v[218:219], v243 offset:45568
    s_waitcnt lgkmcnt(12)
    v_mfma_f32_32x32x16_bf16 v[160:175], v[64:67], v[192:195], v[160:175]
    s_cmp_lt_u32 s40, 4
    s_cbranch_scc1 L_pr_32
    s_setprio 1
L_pr_32:
    ds_read_b64_tr_b16 v[220:221], v243 offset:47104
    ds_read_b64_tr_b16 v[222:223], v243 offset:47616
    s_waitcnt lgkmcnt(12)
    v_mfma_f32_32x32x16_bf16 v[160:175], v[68:71], v[196:199], v[160:175]
    s_add_u32 s56, s48, 0xe0000
    s_add_u32 m0, s46, 0x20000
    s_nop 0
    buffer_load_dwordx4 v253, s[12:15], s56 offen lds
    ds_read_b64_tr_b16 v[192:193], v243 offset:49152
    ds_read_b64_tr_b16 v[194:195], v243 offset:49664
    s_waitcnt lgkmcnt(12)
    v_mfma_f32_32x32x16_bf16 v[160:175], v[72:75], v[200:203], v[160:175]
    ds_read_b64_tr_b16 v[196:197], v243 offset:51200
    ds_read_b64_tr_b16 v[198:199], v243 offset:51712
    s_waitcnt lgkmcnt(12)
    v_mfma_f32_32x32x16_bf16 v[160:175], v[76:79], v[204:207], v[160:175]
    s_add_u32 s56, s48, 0xe0000
    s_add_u32 m0, s46, 0x24000
    s_nop 0
    buffer_load_dwordx4 v253, s[16:19], s56 offen lds
    ds_read_b64_tr_b16 v[200:201], v243 offset:53248
    ds_read_b64_tr_b16 v[202:203], v243 offset:53760
    s_waitcnt lgkmcnt(12)
    v_mfma_f32_32x32x16_bf16 v[160:175], v[80:83], v[208:211], v[160:175]
    ds_read_b64_tr_b16 v[204:205], v243 offset:55296
    ds_read_b64_tr_b16 v[206:207], v243 offset:55808
    s_waitcnt lgkmcnt(12)
    v_mfma_f32_32x32x16_bf16 v[160:175], v[84:87], v[212:215], v[160:175]
    s_add_u32 s56, s48, 0x118000
    s_add_u32 m0, s46, 0x22000
    s_nop 0
    buffer_load_dwordx4 v253, s[12:15], s56 offen lds
    ds_read_b64_tr_b16 v[208:209], v243 offset:57344
    ds_read_b64_tr_b16 v[210:211], v243 offset:57856
    s_waitcnt lgkmcnt(12)
    v_mfma_f32_32x32x16_bf16 v[160:175], v[88:91], v[216:219], v[160:175]
    ds_read_b64_tr_b16 v[212:213], v243 offset:59392
    ds_read_b64_tr_b16 v[214:215], v243 offset:59904
    s_waitcnt lgkmcnt(12)
    v_mfma_f32_32x32x16_bf16 v[160:175], v[92:95], v[220:223], v[160:175]
    s_add_u32 s56, s48, 0x118000
    s_add_u32 m0, s46, 0x26000
    s_nop 0
    buffer_load_dwordx4 v253, s[16:19], s56 offen lds
    ds_read_b64_tr_b16 v[216:217], v243 offset:61440
    ds_read_b64_tr_b16 v[218:219], v243 offset:61952
    s_waitcnt lgkmcnt(12)
    v_mfma_f32_32x32x16_bf16 v[160:175], v[96:99], v[192:195], v[160:175]
    s_cmp_lt_u32 s40, 4
    s_cbranch_scc1 L_pr_33
    s_setprio 0
L_pr_33:
    ds_read_b64_tr_b16 v[220:221], v243 offset:63488
    ds_read_b64_tr_b16 v[222:223], v243 offset:64000
    s_waitcnt lgkmcnt(12)
    v_mfma_f32_32x32x16_bf16 v[160:175], v[100:103], v[196:199], v[160:175]
    s_add_u32 s56, s48, 0x150000
    s_add_u32 m0, s46, 0x0
    s_nop 0
    buffer_load_dwordx4 v253, s[12:15], s56 offen lds
    ds_read_b64_tr_b16 v[192:193], v244 offset:0
    ds_read_b64_tr_b16 v[194:195], v244 offset:512
    s_waitcnt lgkmcnt(12)
    v_mfma_f32_32x32x16_bf16 v[160:175], v[104:107], v[200:203], v[160:175]
    ds_read_b64_tr_b16 v[196:197], v244 offset:16384
    ds_read_b64_tr_b16 v[198:199], v244 offset:16896
    s_waitcnt lgkmcnt(12)
    v_mfma_f32_32x32x16_bf16 v[160:175], v[108:111], v[204:207], v[160:175]
    s_add_u32 s56, s48, 0x150000
    s_add_u32 m0, s46, 0x4000
    s_nop 0
    buffer_load_dwordx4 v253, s[16:19], s56 offen lds
    ds_read_b64_tr_b16 v[200:201], v244 offset:2048
    ds_read_b64_tr_b16 v[202:203], v244 offset:2560
    s_waitcnt lgkmcnt(12)
    v_mfma_f32_32x32x16_bf16 v[160:175], v[112:115], v[208:211], v[160:175]
    ds_read_b64_tr_b16 v[204:205], v244 offset:18432
    ds_read_b64_tr_b16 v[206:207], v244 offset:18944
    s_waitcnt lgkmcnt(12)
    v_mfma_f32_32x32x16_bf16 v[160:175], v[116:119], v[212:215], v[160:175]
    s_add_u32 s56, s48, 0x188000
    s_add_u32 m0, s46, 0x2000
    s_nop 0
    buffer_load_dwordx4 v253, s[12:15], s56 offen lds
    ds_read_b64_tr_b16 v[208:209], v244 offset:4096
    ds_read_b64_tr_b16 v[210:211], v244 offset:4608
    s_waitcnt lgkmcnt(12)
    v_mfma_f32_32x32x16_bf16 v[160:175], v[120:123], v[216:219], v[160:175]
    ds_read_b64_tr_b16 v[212:213], v244 offset:20480
    ds_read_b64_tr_b16 v[214:215], v244 offset:20992
    s_waitcnt lgkmcnt(12)
    v_mfma_f32_32x32x16_bf16 v[160:175], v[124:127], v[220:223], v[160:175]
    s_add_u32 s56, s48, 0x188000
    s_add_u32 m0, s46, 0x6000
    s_nop 0
    buffer_load_dwordx4 v253, s[16:19], s56 offen lds
    s_waitcnt vmcnt(8)
    s_barrier
    ds_read_b64_tr_b16 v[216:217], v244 offset:6144
    ds_read_b64_tr_b16 v[218:219], v244 offset:6656
    s_waitcnt lgkmcnt(12)
    v_mfma_f32_32x32x16_bf16 v[128:143], v[192:195], v[0:3], 0
    s_cmp_lt_u32 s40, 4
    s_cbranch_scc1 L_pr_34
    s_setprio 1
L_pr_34:
    ds_read_b64_tr_b16 v[220:221], v244 offset:22528
    ds_read_b64_tr_b16 v[222:223], v244 offset:23040
    s_waitcnt lgkmcnt(12)
    v_mfma_f32_32x32x16_bf16 v[144:159], v[196:199], v[0:3], 0
    s_add_u32 s56, s49, 0x0
    s_add_u32 m0, s46, 0x8000
    s_nop 0
    buffer_load_dwordx4 v253, s[12:15], s56 offen lds
    ds_read_b64_tr_b16 v[192:193], v244 offset:8192
    ds_read_b64_tr_b16 v[194:195], v244 offset:8704
    s_waitcnt lgkmcnt(12)
    s_nop 0
    v_mfma_f32_32x32x16_bf16 v[128:143], v[200:203], v[4:7], v[128:143]
    v_cvt_pk_bf16_f32 v224, v160, v161
    v_cvt_pk_bf16_f32 v225, v162, v163
    v_cvt_pk_bf16_f32 v226, v164, v165
    v_cvt_pk_bf16_f32 v227, v166, v167
    ds_read_b64_tr_b16 v[196:197], v244 offset:24576
    ds_read_b64_tr_b16 v[198:199], v244 offset:25088
    s_waitcnt lgkmcnt(12)
    s_nop 0
    v_mfma_f32_32x32x16_bf16 v[144:159], v[204:207], v[4:7], v[144:159]
    buffer_store_dwordx4 v[224:227], v251, s[32:35], s51 offen offset:0 sc1
    v_cvt_pk_bf16_f32 v228, v168, v169
    v_cvt_pk_bf16_f32 v229, v170, v171
    v_cvt_pk_bf16_f32 v230, v172, v173
    ds_read_b64_tr_b16 v[200:201], v244 offset:10240
    ds_read_b64_tr_b16 v[202:203], v244 offset:10752
    s_waitcnt lgkmcnt(12)
    s_nop 0
    v_mfma_f32_32x32x16_bf16 v[128:143], v[208:211], v[8:11], v[128:143]
    v_cvt_pk_bf16_f32 v231, v174, v175
    buffer_store_dwordx4 v[228:231], v251, s[32:35], s51 offen offset:256 sc1
    ds_read_b64_tr_b16 v[204:205], v244 offset:26624
    ds_read_b64_tr_b16 v[206:207], v244 offset:27136
    s_waitcnt lgkmcnt(12)
    v_mfma_f32_32x32x16_bf16 v[144:159], v[212:215], v[8:11], v[144:159]
    s_add_u32 s56, s49, 0x0
    s_add_u32 m0, s46, 0xc000
    s_nop 0
    buffer_load_dwordx4 v253, s[16:19], s56 offen lds
    ds_read_b64_tr_b16 v[208:209], v244 offset:12288
    ds_read_b64_tr_b16 v[210:211], v244 offset:12800
    s_waitcnt lgkmcnt(12)
    v_mfma_f32_32x32x16_bf16 v[128:143], v[216:219], v[12:15], v[128:143]
    ds_read_b64_tr_b16 v[212:213], v244 offset:28672
    ds_read_b64_tr_b16 v[214:215], v244 offset:29184
    s_waitcnt lgkmcnt(12)
    v_mfma_f32_32x32x16_bf16 v[144:159], v[220:223], v[12:15], v[144:159]
    ds_read_b64_tr_b16 v[216:217], v244 offset:14336
    ds_read_b64_tr_b16 v[218:219], v244 offset:14848
    s_waitcnt lgkmcnt(12)
    v_mfma_f32_32x32x16_bf16 v[128:143], v[192:195], v[16:19], v[128:143]
    s_cmp_lt_u32 s40, 4
    s_cbranch_scc1 L_pr_35
    s_setprio 0
L_pr_35:
    ds_read_b64_tr_b16 v[220:221], v244 offset:30720
    ds_read_b64_tr_b16 v[222:223], v244 offset:31232
    s_waitcnt lgkmcnt(12)
    v_mfma_f32_32x32x16_bf16 v[144:159], v[196:199], v[16:19], v[144:159]
    s_add_u32 s56, s49, 0x38000
    s_add_u32 m0, s46, 0xa000
    s_nop 0
    buffer_load_dwordx4 v253, s[12:15], s56 offen lds
    ds_read_b64_tr_b16 v[192:193], v244 offset:32768
    ds_read_b64_tr_b16 v[194:195], v244 offset:33280
    s_waitcnt lgkmcnt(12)
    v_mfma_f32_32x32x16_bf16 v[128:143], v[200:203], v[20:23], v[128:143]
    ds_read_b64_tr_b16 v[196:197], v244 offset:49152
    ds_read_b64_tr_b16 v[198:199], v244 offset:49664
    s_waitcnt lgkmcnt(12)
    v_mfma_f32_32x32x16_bf16 v[144:159], v[204:207], v[20:23], v[144:159]
    ds_read_b64_tr_b16 v[200:201], v244 offset:34816
    ds_read_b64_tr_b16 v[202:203], v244 offset:35328
    s_waitcnt lgkmcnt(12)
    v_mfma_f32_32x32x16_bf16 v[128:143], v[208:211], v[24:27], v[128:143]
    ds_read_b64_tr_b16 v[204:205], v244 offset:51200
    ds_read_b64_tr_b16 v[206:207], v244 offset:51712
    s_waitcnt lgkmcnt(12)
    v_mfma_f32_32x32x16_bf16 v[144:159], v[212:215], v[24:27], v[144:159]
    s_add_u32 s56, s49, 0x38000
    s_add_u32 m0, s46, 0xe000
    s_nop 0
    buffer_load_dwordx4 v253, s[16:19], s56 offen lds
    ds_read_b64_tr_b16 v[208:209], v244 offset:36864
    ds_read_b64_tr_b16 v[210:211], v244 offset:37376
    s_waitcnt lgkmcnt(12)
    v_mfma_f32_32x32x16_bf16 v[128:143], v[216:219], v[28:31], v[128:143]
    ds_read_b64_tr_b16 v[212:213], v244 offset:53248
    ds_read_b64_tr_b16 v[214:215], v244 offset:53760
    s_waitcnt lgkmcnt(12)
    v_mfma_f32_32x32x16_bf16 v[144:159], v[220:223], v[28:31], v[144:159]
    s_waitcnt vmcnt(10)
    s_barrier
    v_lshlrev_b32 v254, 3, v250
    s_lshl_b32 s58, s2, 3
    s_add_u32 s58, s58, s40
    s_mul_i32 s59, s58, 896
    s_mov_b64 exec, 0x7f
    buffer_load_dword v255, v254, s[20:23], s59 offen
    s_lshl_b32 s59, s58, 8
    s_mov_b64 exec, 3
    buffer_load_dword v255, v254, s[24:27], s59 offen
    s_mov_b64 exec, -1
    ds_read_b64_tr_b16 v[216:217], v244 offset:38912
    ds_read_b64_tr_b16 v[218:219], v244 offset:39424
    s_waitcnt lgkmcnt(12)
    v_mfma_f32_32x32x16_bf16 v[128:143], v[192:195], v[32:35], v[128:143]
    s_cmp_lt_u32 s40, 4
    s_cbranch_scc1 L_pr_36
    s_setprio 1
L_pr_36:
    ds_read_b64_tr_b16 v[220:221], v244 offset:55296
    ds_read_b64_tr_b16 v[222:223], v244 offset:55808
    s_waitcnt lgkmcnt(12)
    v_mfma_f32_32x32x16_bf16 v[144:159], v[196:199], v[32:35], v[144:159]
    s_add_u32 s56, s49, 0x70000
    s_add_u32 m0, s46, 0x10000
    s_nop 0
    buffer_load_dwordx4 v253, s[12:15], s56 offen lds
    ds_read_b64_tr_b16 v[192:193], v244 offset:40960
    ds_read_b64_tr_b16 v[194:195], v244 offset:41472
    s_waitcnt lgkmcnt(12)
    v_mfma_f32_32x32x16_bf16 v[128:143], v[200:203], v[36:39], v[128:143]
    ds_read_b64_tr_b16 v[196:197], v244 offset:57344
    ds_read_b64_tr_b16 v[198:199], v244 offset:57856
    s_waitcnt lgkmcnt(12)
    v_mfma_f32_32x32x16_bf16 v[144:159], v[204:207], v[36:39], v[144:159]
    ds_read_b64_tr_b16 v[200:201], v244 offset:43008
    ds_read_b64_tr_b16 v[202:203], v244 offset:43520
    s_waitcnt lgkmcnt(12)
    v_mfma_f32_32x32x16_bf16 v[128:143], v[208:211], v[40:43], v[128:143]
    ds_read_b64_tr_b16 v[204:205], v244 offset:59392
    ds_read_b64_tr_b16 v[206:207], v244 offset:59904
    s_waitcnt lgkmcnt(12)
    v_mfma_f32_32x32x16_bf16 v[144:159], v[212:215], v[40:43], v[144:159]
    s_add_u32 s56, s49, 0x70000
    s_add_u32 m0, s46, 0x14000
    s_nop 0
    buffer_load_dwordx4 v253, s[16:19], s56 offen lds
    ds_read_b64_tr_b16 v[208:209], v244 offset:45056
    ds_read_b64_tr_b16 v[210:211], v244 offset:45568
    s_waitcnt lgkmcnt(12)
    v_mfma_f32_32x32x16_bf16 v[128:143], v[216:219], v[44:47], v[128:143]
    ds_read_b64_tr_b16 v[212:213], v244 offset:61440
    ds_read_b64_tr_b16 v[214:215], v244 offset:61952
    s_waitcnt lgkmcnt(12)
    v_mfma_f32_32x32x16_bf16 v[144:159], v[220:223], v[44:47], v[144:159]
    ds_read_b64_tr_b16 v[216:217], v244 offset:47104
    ds_read_b64_tr_b16 v[218:219], v244 offset:47616
    s_waitcnt lgkmcnt(12)
    v_mfma_f32_32x32x16_bf16 v[128:143], v[192:195], v[48:51], v[128:143]
    s_cmp_lt_u32 s40, 4
    s_cbranch_scc1 L_pr_37
    s_setprio 0
L_pr_37:
    ds_read_b64_tr_b16 v[220:221], v244 offset:63488
    ds_read_b64_tr_b16 v[222:223], v244 offset:64000
    s_waitcnt lgkmcnt(12)
    v_mfma_f32_32x32x16_bf16 v[144:159], v[196:199], v[48:51], v[144:159]
    s_add_u32 s56, s49, 0xa8000
    s_add_u32 m0, s46, 0x12000
    s_nop 0
    buffer_load_dwordx4 v253, s[12:15], s56 offen lds
    ds_read_b64_tr_b16 v[192:193], v245 offset:0
    ds_read_b64_tr_b16 v[194:195], v245 offset:512
    s_waitcnt lgkmcnt(12)
    v_mfma_f32_32x32x16_bf16 v[128:143], v[200:203], v[52:55], v[128:143]
    ds_read_b64_tr_b16 v[196:197], v245 offset:16384
    ds_read_b64_tr_b16 v[198:199], v245 offset:16896
    s_waitcnt lgkmcnt(12)
    v_mfma_f32_32x32x16_bf16 v[144:159], v[204:207], v[52:55], v[144:159]
    ds_read_b64_tr_b16 v[200:201], v245 offset:2048
    ds_read_b64_tr_b16 v[202:203], v245 offset:2560
    s_waitcnt lgkmcnt(12)
    v_mfma_f32_32x32x16_bf16 v[128:143], v[208:211], v[56:59], v[128:143]
    ds_read_b64_tr_b16 v[204:205], v245 offset:18432
    ds_read_b64_tr_b16 v[206:207], v245 offset:18944
    s_waitcnt lgkmcnt(12)
    v_mfma_f32_32x32x16_bf16 v[144:159], v[212:215], v[56:59], v[144:159]
    s_add_u32 s56, s49, 0xa8000
    s_add_u32 m0, s46, 0x16000
    s_nop 0
    buffer_load_dwordx4 v253, s[16:19], s56 offen lds
    ds_read_b64_tr_b16 v[208:209], v245 offset:4096
    ds_read_b64_tr_b16 v[210:211], v245 offset:4608
    s_waitcnt lgkmcnt(12)
    v_mfma_f32_32x32x16_bf16 v[128:143], v[216:219], v[60:63], v[128:143]
    ds_read_b64_tr_b16 v[212:213], v245 offset:20480
    ds_read_b64_tr_b16 v[214:215], v245 offset:20992
    s_waitcnt lgkmcnt(12)
    v_mfma_f32_32x32x16_bf16 v[144:159], v[220:223], v[60:63], v[144:159]
    s_waitcnt vmcnt(12)
    s_mov_b32 s55, 0
    s_nop 9
L_epr_38:
    v_readfirstlane_b32 s94, v247
    s_nop 0
    s_cmp_lg_u32 s94, 0
    s_nop 2
    s_cbranch_scc1 L_epd_39
    s_sleep 4
    buffer_load_dword v247, off, s[36:39], 0 sc0 sc1
    s_waitcnt vmcnt(0)
    s_add_u32 s55, s55, 1
    s_cmp_lt_u32 s55, 0x100000
    s_cbranch_scc1 L_epr_38
L_epd_39:
    s_waitcnt vmcnt(9)
    s_barrier
    s_cmp_lg_u32 s40, 0
    s_cbranch_scc1 L_nopub_40
    s_lshl_b32 s58, s41, 7
    s_add_u32 s58, s58, s95
    s_add_u32 s58, s58, 0x1000000
    v_mov_b32 v247, s94
    s_mov_b64 exec, 1
    buffer_store_dword v247, off, s[32:35], s58 sc0 sc1
    s_mov_b64 exec, -1
L_nopub_40:
    ds_read_b64_tr_b16 v[216:217], v245 offset:6144
    ds_read_b64_tr_b16 v[218:219], v245 offset:6656
    s_waitcnt lgkmcnt(12)
    v_mfma_f32_32x32x16_bf16 v[128:143], v[192:195], v[64:67], v[128:143]
    s_cmp_lt_u32 s40, 4
    s_cbranch_scc1 L_pr_41
    s_setprio 1
L_pr_41:
    ds_read_b64_tr_b16 v[220:221], v245 offset:22528
    ds_read_b64_tr_b16 v[222:223], v245 offset:23040
    s_waitcnt lgkmcnt(12)
    v_mfma_f32_32x32x16_bf16 v[144:159], v[196:199], v[64:67], v[144:159]
    s_add_u32 s56, s49, 0xe0000
    s_add_u32 m0, s46, 0x18000
    s_nop 0
    buffer_load_dwordx4 v253, s[12:15], s56 offen lds
    ds_read_b64_tr_b16 v[192:193], v245 offset:8192
    ds_read_b64_tr_b16 v[194:195], v245 offset:8704
    s_waitcnt lgkmcnt(12)
    v_mfma_f32_32x32x16_bf16 v[128:143], v[200:203], v[68:71], v[128:143]
    ds_read_b64_tr_b16 v[196:197], v245 offset:24576
    ds_read_b64_tr_b16 v[198:199], v245 offset:25088
    s_waitcnt lgkmcnt(12)
    v_mfma_f32_32x32x16_bf16 v[144:159], v[204:207], v[68:71], v[144:159]
    ds_read_b64_tr_b16 v[200:201], v245 offset:10240
    ds_read_b64_tr_b16 v[202:203], v245 offset:10752
    s_waitcnt lgkmcnt(12)
    v_mfma_f32_32x32x16_bf16 v[128:143], v[208:211], v[72:75], v[128:143]
    ds_read_b64_tr_b16 v[204:205], v245 offset:26624
    ds_read_b64_tr_b16 v[206:207], v245 offset:27136
    s_waitcnt lgkmcnt(12)
    v_mfma_f32_32x32x16_bf16 v[144:159], v[212:215], v[72:75], v[144:159]
    s_add_u32 s56, s49, 0xe0000
    s_add_u32 m0, s46, 0x1c000
    s_nop 0
    buffer_load_dwordx4 v253, s[16:19], s56 offen lds
    ds_read_b64_tr_b16 v[208:209], v245 offset:12288
    ds_read_b64_tr_b16 v[210:211], v245 offset:12800
    s_waitcnt lgkmcnt(12)
    v_mfma_f32_32x32x16_bf16 v[128:143], v[216:219], v[76:79], v[128:143]
    ds_read_b64_tr_b16 v[212:213], v245 offset:28672
    ds_read_b64_tr_b16 v[214:215], v245 offset:29184
    s_waitcnt lgkmcnt(12)
    v_mfma_f32_32x32x16_bf16 v[144:159], v[220:223], v[76:79], v[144:159]
    ds_read_b64_tr_b16 v[216:217], v245 offset:14336
    ds_read_b64_tr_b16 v[218:219], v245 offset:14848
    s_waitcnt lgkmcnt(12)
    v_mfma_f32_32x32x16_bf16 v[128:143], v[192:195], v[80:83], v[128:143]
    s_cmp_lt_u32 s40, 4
    s_cbranch_scc1 L_pr_42
    s_setprio 0
L_pr_42:
    ds_read_b64_tr_b16 v[220:221], v245 offset:30720
    ds_read_b64_tr_b16 v[222:223], v245 offset:31232
    s_waitcnt lgkmcnt(12)
    v_mfma_f32_32x32x16_bf16 v[144:159], v[196:199], v[80:83], v[144:159]
    s_add_u32 s56, s49, 0x118000
    s_add_u32 m0, s46, 0x1a000
    s_nop 0
    buffer_load_dwordx4 v253, s[12:15], s56 offen lds
    ds_read_b64_tr_b16 v[192:193], v243 offset:0
    ds_read_b64_tr_b16 v[194:195], v243 offset:512
    s_waitcnt lgkmcnt(12)
    v_mfma_f32_32x32x16_bf16 v[128:143], v[200:203], v[84:87], v[128:143]
    ds_read_b64_tr_b16 v[196:197], v243 offset:16384
    ds_read_b64_tr_b16 v[198:199], v243 offset:16896
    s_waitcnt lgkmcnt(12)
    v_mfma_f32_32x32x16_bf16 v[144:159], v[204:207], v[84:87], v[144:159]
    ds_read_b64_tr_b16 v[200:201], v243 offset:2048
    ds_read_b64_tr_b16 v[202:203], v243 offset:2560
    s_waitcnt lgkmcnt(12)
    v_mfma_f32_32x32x16_bf16 v[128:143], v[208:211], v[88:91], v[128:143]
    ds_read_b64_tr_b16 v[204:205], v243 offset:18432
    ds_read_b64_tr_b16 v[206:207], v243 offset:18944
    s_waitcnt lgkmcnt(12)
    v_mfma_f32_32x32x16_bf16 v[144:159], v[212:215], v[88:91], v[144:159]
    s_add_u32 s56, s49, 0x118000
    s_add_u32 m0, s46, 0x1e000
    s_nop 0
    buffer_load_dwordx4 v253, s[16:19], s56 offen lds
    ds_read_b64_tr_b16 v[208:209], v243 offset:4096
    ds_read_b64_tr_b16 v[210:211], v243 offset:4608
    s_waitcnt lgkmcnt(12)
    v_mfma_f32_32x32x16_bf16 v[128:143], v[216:219], v[92:95], v[128:143]
    ds_read_b64_tr_b16 v[212:213], v243 offset:20480
    ds_read_b64_tr_b16 v[214:215], v243 offset:20992
    s_waitcnt lgkmcnt(12)
    v_mfma_f32_32x32x16_bf16 v[144:159], v[220:223], v[92:95], v[144:159]
    s_waitcnt vmcnt(10)
    s_barrier
    ds_read_b64_tr_b16 v[216:217], v243 offset:6144
    ds_read_b64_tr_b16 v[218:219], v243 offset:6656
    s_waitcnt lgkmcnt(12)
    v_mfma_f32_32x32x16_bf16 v[128:143], v[192:195], v[96:99], v[128:143]
    s_cmp_lt_u32 s40, 4
    s_cbranch_scc1 L_pr_43
    s_setprio 1
L_pr_43:
    ds_read_b64_tr_b16 v[220:221], v243 offset:22528
    ds_read_b64_tr_b16 v[222:223], v243 offset:23040
    s_waitcnt lgkmcnt(12)
    v_mfma_f32_32x32x16_bf16 v[144:159], v[196:199], v[96:99], v[144:159]
    s_add_u32 s56, s49, 0x150000
    s_add_u32 m0, s46, 0x20000
    s_nop 0
    buffer_load_dwordx4 v253, s[12:15], s56 offen lds
    ds_read_b64_tr_b16 v[192:193], v243 offset:8192
    ds_read_b64_tr_b16 v[194:195], v243 offset:8704
    s_waitcnt lgkmcnt(12)
    v_mfma_f32_32x32x16_bf16 v[128:143], v[200:203], v[100:103], v[128:143]
    ds_read_b64_tr_b16 v[196:197], v243 offset:24576
    ds_read_b64_tr_b16 v[198:199], v243 offset:25088
    s_waitcnt lgkmcnt(12)
    v_mfma_f32_32x32x16_bf16 v[144:159], v[204:207], v[100:103], v[144:159]
    ds_read_b64_tr_b16 v[200:201], v243 offset:10240
    ds_read_b64_tr_b16 v[202:203], v243 offset:10752
    s_waitcnt lgkmcnt(12)
    v_mfma_f32_32x32x16_bf16 v[128:143], v[208:211], v[104:107], v[128:143]
    ds_read_b64_tr_b16 v[204:205], v243 offset:26624
    ds_read_b64_tr_b16 v[206:207], v243 offset:27136
    s_waitcnt lgkmcnt(12)
    v_mfma_f32_32x32x16_bf16 v[144:159], v[212:215], v[104:107], v[144:159]
    s_add_u32 s56, s49, 0x150000
    s_add_u32 m0, s46, 0x24000
    s_nop 0
    buffer_load_dwordx4 v253, s[16:19], s56 offen lds
    ds_read_b64_tr_b16 v[208:209], v243 offset:12288
    ds_read_b64_tr_b16 v[210:211], v243 offset:12800
    s_waitcnt lgkmcnt(12)
    v_mfma_f32_32x32x16_bf16 v[128:143], v[216:219], v[108:111], v[128:143]
    ds_read_b64_tr_b16 v[212:213], v243 offset:28672
    ds_read_b64_tr_b16 v[214:215], v243 offset:29184
    s_waitcnt lgkmcnt(12)
    v_mfma_f32_32x32x16_bf16 v[144:159], v[220:223], v[108:111], v[144:159]
    ds_read_b64_tr_b16 v[216:217], v243 offset:14336
    ds_read_b64_tr_b16 v[218:219], v243 offset:14848
    s_waitcnt lgkmcnt(12)
    v_mfma_f32_32x32x16_bf16 v[128:143], v[192:195], v[112:115], v[128:143]
    s_cmp_lt_u32 s40, 4
    s_cbranch_scc1 L_pr_44
    s_setprio 0
L_pr_44:
    ds_read_b64_tr_b16 v[220:221], v243 offset:30720
    ds_read_b64_tr_b16 v[222:223], v243 offset:31232
    s_waitcnt lgkmcnt(12)
    v_mfma_f32_32x32x16_bf16 v[144:159], v[196:199], v[112:115], v[144:159]
    s_add_u32 s56, s49, 0x188000
    s_add_u32 m0, s46, 0x22000
    s_nop 0
    buffer_load_dwordx4 v253, s[12:15], s56 offen lds
    ds_read_b64_tr_b16 v[192:193], v243 offset:32768
    ds_read_b64_tr_b16 v[194:195], v243 offset:33280
    s_waitcnt lgkmcnt(12)
    v_mfma_f32_32x32x16_bf16 v[128:143], v[200:203], v[116:119], v[128:143]
    ds_read_b64_tr_b16 v[196:197], v243 offset:49152
    ds_read_b64_tr_b16 v[198:199], v243 offset:49664
    s_waitcnt lgkmcnt(12)
    v_mfma_f32_32x32x16_bf16 v[144:159], v[204:207], v[116:119], v[144:159]
    ds_read_b64_tr_b16 v[200:201], v243 offset:34816
    ds_read_b64_tr_b16 v[202:203], v243 offset:35328
    s_waitcnt lgkmcnt(12)
    v_mfma_f32_32x32x16_bf16 v[128:143], v[208:211], v[120:123], v[128:143]
    ds_read_b64_tr_b16 v[204:205], v243 offset:51200
    ds_read_b64_tr_b16 v[206:207], v243 offset:51712
    s_waitcnt lgkmcnt(12)
    v_mfma_f32_32x32x16_bf16 v[144:159], v[212:215], v[120:123], v[144:159]
    s_add_u32 s56, s49, 0x188000
    s_add_u32 m0, s46, 0x26000
    s_nop 0
    buffer_load_dwordx4 v253, s[16:19], s56 offen lds
    ds_read_b64_tr_b16 v[208:209], v243 offset:36864
    ds_read_b64_tr_b16 v[210:211], v243 offset:37376
    s_waitcnt lgkmcnt(12)
    v_mfma_f32_32x32x16_bf16 v[128:143], v[216:219], v[124:127], v[128:143]
    ds_read_b64_tr_b16 v[212:213], v243 offset:53248
    ds_read_b64_tr_b16 v[214:215], v243 offset:53760
    s_waitcnt lgkmcnt(12)
    v_mfma_f32_32x32x16_bf16 v[144:159], v[220:223], v[124:127], v[144:159]
    s_waitcnt vmcnt(8)
    s_barrier
    s_and_b32 s67, s40, 3
    s_lshr_b32 s68, s40, 2
    v_lshrrev_b32 v254, 7, v250
    v_bfe_u32 v255, v250, 4, 3
    v_bfe_u32 v253, v254, 1, 1
    v_lshlrev_b32 v253, 2, v253
    v_xor_b32 v255, v255, v253
    v_lshlrev_b32 v255, 4, v255
    v_lshrrev_b32 v253, 2, v254
    v_and_b32 v254, 3, v254
    v_lshl_add_u32 v254, v253, 3, v254
    v_lshl_add_u32 v252, v254, 10, v255
    s_lshl_b32 s56, s66, 7
    s_lshl_b32 s57, s68, 5
    s_mul_i32 s58, s67, 448
    s_add_u32 s58, s58, s57
    s_lshl_b32 s58, s58, 10
    s_add_u32 s71, s58, s56
    s_lshl_b32 s58, s67, 7
    s_add_u32 s58, s58, s57
    s_lshl_b32 s58, s58, 10
    s_add_u32 s72, s58, s56
    s_lshl_b32 s58, s67, 13
    s_lshl_b32 s57, s68, 12
    s_add_u32 s73, s58, s57
    ds_read_b64_tr_b16 v[216:217], v243 offset:38912
    ds_read_b64_tr_b16 v[218:219], v243 offset:39424
    s_waitcnt lgkmcnt(12)
    v_mfma_f32_32x32x16_bf16 v[160:175], v[192:195], v[0:3], 0
    s_cmp_lt_u32 s40, 4
    s_cbranch_scc1 L_pr_45
    s_setprio 1
L_pr_45:
    ds_read_b64_tr_b16 v[220:221], v243 offset:55296
    ds_read_b64_tr_b16 v[222:223], v243 offset:55808
    s_waitcnt lgkmcnt(12)
    v_mfma_f32_32x32x16_bf16 v[176:191], v[196:199], v[0:3], 0
    s_add_u32 s56, s71, 0x0
    s_add_u32 m0, s73, 0x0
    s_nop 0
    buffer_load_dwordx4 v252, s[20:23], s56 offen lds
    ds_read_b64_tr_b16 v[192:193], v243 offset:40960
    ds_read_b64_tr_b16 v[194:195], v243 offset:41472
    s_waitcnt lgkmcnt(12)
    v_mfma_f32_32x32x16_bf16 v[160:175], v[200:203], v[4:7], v[160:175]
    v_mul_f32 v232, v128, v128
    v_mul_f32 v233, v129, v129
    v_mul_f32 v234, v130, v130
    v_mul_f32 v235, v131, v131
    ds_read_b64_tr_b16 v[196:197], v243 offset:57344
    ds_read_b64_tr_b16 v[198:199], v243 offset:57856
    s_waitcnt lgkmcnt(12)
    s_nop 0
    v_mfma_f32_32x32x16_bf16 v[176:191], v[204:207], v[4:7], v[176:191]
    v_fma_f32 v232, v232, s63, v246
    v_fma_f32 v233, v233, s63, v246
    v_fma_f32 v234, v234, s63, v246
    v_fma_f32 v235, v235, s63, v246
    ds_read_b64_tr_b16 v[200:201], v243 offset:43008
    ds_read_b64_tr_b16 v[202:203], v243 offset:43520
    s_waitcnt lgkmcnt(12)
    v_mfma_f32_32x32x16_bf16 v[160:175], v[208:211], v[8:11], v[160:175]
    v_mul_f32 v232, v232, v128
    v_mul_f32 v233, v233, v129
    v_mul_f32 v234, v234, v130
    v_mul_f32 v235, v235, v131
    ds_read_b64_tr_b16 v[204:205], v243 offset:59392
    ds_read_b64_tr_b16 v[206:207], v243 offset:59904
    s_waitcnt lgkmcnt(12)
    v_mfma_f32_32x32x16_bf16 v[176:191], v[212:215], v[8:11], v[176:191]
    s_add_u32 s56, s71, 0x1000
    s_add_u32 m0, s73, 0x400
    s_nop 0
    buffer_load_dwordx4 v252, s[20:23], s56 offen lds
    v_exp_f32 v232, v232
    v_exp_f32 v233, v233
    v_exp_f32 v234, v234
    v_exp_f32 v235, v235
    ds_read_b64_tr_b16 v[208:209], v243 offset:45056
    ds_read_b64_tr_b16 v[210:211], v243 offset:45568
    s_waitcnt lgkmcnt(12)
    v_mfma_f32_32x32x16_bf16 v[160:175], v[216:219], v[12:15], v[160:175]
    v_mul_f32 v128, v128, v144
    v_mul_f32 v129, v129, v145
    v_mul_f32 v130, v130, v146
    v_mul_f32 v131, v131, v147
    ds_read_b64_tr_b16 v[212:213], v243 offset:61440
    ds_read_b64_tr_b16 v[214:215], v243 offset:61952
    s_waitcnt lgkmcnt(12)
    v_mfma_f32_32x32x16_bf16 v[176:191], v[220:223], v[12:15], v[176:191]
    v_add_f32 v232, 1.0, v232
    v_add_f32 v233, 1.0, v233
    v_add_f32 v234, 1.0, v234
    v_add_f32 v235, 1.0, v235
    ds_read_b64_tr_b16 v[216:217], v243 offset:47104
    ds_read_b64_tr_b16 v[218:219], v243 offset:47616
    s_waitcnt lgkmcnt(12)
    v_mfma_f32_32x32x16_bf16 v[160:175], v[192:195], v[16:19], v[160:175]
    s_cmp_lt_u32 s40, 4
    s_cbranch_scc1 L_pr_46
    s_setprio 0
L_pr_46:
    v_rcp_f32 v232, v232
    v_rcp_f32 v233, v233
    v_rcp_f32 v234, v234
    v_rcp_f32 v235, v235
    ds_read_b64_tr_b16 v[220:221], v243 offset:63488
    ds_read_b64_tr_b16 v[222:223], v243 offset:64000
    s_waitcnt lgkmcnt(12)
    v_mfma_f32_32x32x16_bf16 v[176:191], v[196:199], v[16:19], v[176:191]
    s_add_u32 s56, s71, 0x4000
    s_add_u32 m0, s73, 0x800
    s_nop 0
    buffer_load_dwordx4 v252, s[20:23], s56 offen lds
    v_mul_f32 v128, v128, v232
    v_mul_f32 v129, v129, v233
    v_mul_f32 v130, v130, v234
    v_mul_f32 v131, v131, v235
    ds_read_b64_tr_b16 v[192:193], v244 offset:0
    ds_read_b64_tr_b16 v[194:195], v244 offset:512
    s_waitcnt lgkmcnt(12)
    v_mfma_f32_32x32x16_bf16 v[160:175], v[200:203], v[20:23], v[160:175]
    v_cvt_pk_bf16_f32 v224, v128, v129
    v_cvt_pk_bf16_f32 v225, v130, v131
    v_mul_f32 v236, v132, v132
    v_mul_f32 v237, v133, v133
    ds_read_b64_tr_b16 v[196:197], v244 offset:16384
    ds_read_b64_tr_b16 v[198:199], v244 offset:16896
    s_waitcnt lgkmcnt(12)
    v_mfma_f32_32x32x16_bf16 v[176:191], v[204:207], v[20:23], v[176:191]
    v_mul_f32 v238, v134, v134
    v_mul_f32 v239, v135, v135
    s_nop 0
    v_fma_f32 v236, v236, s63, v246
    v_fma_f32 v237, v237, s63, v246
    ds_read_b64_tr_b16 v[200:201], v244 offset:2048
    ds_read_b64_tr_b16 v[202:203], v244 offset:2560
    s_waitcnt lgkmcnt(12)
    v_mfma_f32_32x32x16_bf16 v[160:175], v[208:211], v[24:27], v[160:175]
    v_fma_f32 v238, v238, s63, v246
    v_fma_f32 v239, v239, s63, v246
    v_mul_f32 v236, v236, v132
    v_mul_f32 v237, v237, v133
    ds_read_b64_tr_b16 v[204:205], v244 offset:18432
    ds_read_b64_tr_b16 v[206:207], v244 offset:18944
    s_waitcnt lgkmcnt(12)
    v_mfma_f32_32x32x16_bf16 v[176:191], v[212:215], v[24:27], v[176:191]
    s_add_u32 s56, s71, 0x5000
    s_add_u32 m0, s73, 0xc00
    s_nop 0
    buffer_load_dwordx4 v252, s[20:23], s56 offen lds
    v_mul_f32 v238, v238, v134
    v_mul_f32 v239, v239, v135
    v_exp_f32 v236, v236
    v_exp_f32 v237, v237
    ds_read_b64_tr_b16 v[208:209], v244 offset:4096
    ds_read_b64_tr_b16 v[210:211], v244 offset:4608
    s_waitcnt lgkmcnt(12)
    v_mfma_f32_32x32x16_bf16 v[160:175], v[216:219], v[28:31], v[160:175]
    v_exp_f32 v238, v238
    v_exp_f32 v239, v239
    v_mul_f32 v132, v132, v148
    v_mul_f32 v133, v133, v149
    ds_read_b64_tr_b16 v[212:213], v244 offset:20480
    ds_read_b64_tr_b16 v[214:215], v244 offset:20992
    s_waitcnt lgkmcnt(12)
    v_mfma_f32_32x32x16_bf16 v[176:191], v[220:223], v[28:31], v[176:191]
    v_mul_f32 v134, v134, v150
    v_mul_f32 v135, v135, v151
    v_add_f32 v236, 1.0, v236
    v_add_f32 v237, 1.0, v237
    s_waitcnt vmcnt(8)
    s_barrier
    ds_read_b64_tr_b16 v[216:217], v244 offset:6144
    ds_read_b64_tr_b16 v[218:219], v244 offset:6656
    s_waitcnt lgkmcnt(12)
    v_mfma_f32_32x32x16_bf16 v[160:175], v[192:195], v[32:35], v[160:175]
    s_cmp_lt_u32 s40, 4
    s_cbranch_scc1 L_pr_47
    s_setprio 1
L_pr_47:
    v_add_f32 v238, 1.0, v238
    v_add_f32 v239, 1.0, v239
    v_rcp_f32 v236, v236
    v_rcp_f32 v237, v237
    ds_read_b64_tr_b16 v[220:221], v244 offset:22528
    ds_read_b64_tr_b16 v[222:223], v244 offset:23040
    s_waitcnt lgkmcnt(12)
    v_mfma_f32_32x32x16_bf16 v[176:191], v[196:199], v[32:35], v[176:191]
    s_add_u32 s56, s71, 0x10000
    s_add_u32 m0, s73, 0x8000
    s_nop 0
    buffer_load_dwordx4 v252, s[20:23], s56 offen lds
    v_rcp_f32 v238, v238
    v_rcp_f32 v239, v239
    v_mul_f32 v132, v132, v236
    v_mul_f32 v133, v133, v237
    ds_read_b64_tr_b16 v[192:193], v244 offset:8192
    ds_read_b64_tr_b16 v[194:195], v244 offset:8704
    s_waitcnt lgkmcnt(12)
    v_mfma_f32_32x32x16_bf16 v[160:175], v[200:203], v[36:39], v[160:175]
    v_mul_f32 v134, v134, v238
    v_mul_f32 v135, v135, v239
    v_cvt_pk_bf16_f32 v226, v132, v133
    v_cvt_pk_bf16_f32 v227, v134, v135
    ds_read_b64_tr_b16 v[196:197], v244 offset:24576
    ds_read_b64_tr_b16 v[198:199], v244 offset:25088
    s_waitcnt lgkmcnt(12)
    v_mfma_f32_32x32x16_bf16 v[176:191], v[204:207], v[36:39], v[176:191]
    buffer_store_dwordx4 v[224:227], v250, s[32:35], s52 offen offset:0 sc1
    v_mul_f32 v232, v136, v136
    v_mul_f32 v233, v137, v137
    v_mul_f32 v234, v138, v138
    ds_read_b64_tr_b16 v[200:201], v244 offset:10240
    ds_read_b64_tr_b16 v[202:203], v244 offset:10752
    s_waitcnt lgkmcnt(12)
    v_mfma_f32_32x32x16_bf16 v[160:175], v[208:211], v[40:43], v[160:175]
    v_mul_f32 v235, v139, v139
    v_fma_f32 v232, v232, s63, v246
    v_fma_f32 v233, v233, s63, v246
    v_fma_f32 v234, v234, s63, v246
    ds_read_b64_tr_b16 v[204:205], v244 offset:26624
    ds_read_b64_tr_b16 v[206:207], v244 offset:27136
    s_waitcnt lgkmcnt(12)
    v_mfma_f32_32x32x16_bf16 v[176:191], v[212:215], v[40:43], v[176:191]
    s_add_u32 s56, s71, 0x11000
    s_add_u32 m0, s73, 0x8400
    s_nop 0
    buffer_load_dwordx4 v252, s[20:23], s56 offen lds
    v_fma_f32 v235, v235, s63, v246
    v_mul_f32 v232, v232, v136
    v_mul_f32 v233, v233, v137
    v_mul_f32 v234, v234, v138
    ds_read_b64_tr_b16 v[208:209], v244 offset:12288
    ds_read_b64_tr_b16 v[210:211], v244 offset:12800
    s_waitcnt lgkmcnt(12)
    v_mfma_f32_32x32x16_bf16 v[160:175], v[216:219], v[44:47], v[160:175]
    v_mul_f32 v235, v235, v139
    v_exp_f32 v232, v232
    v_exp_f32 v233, v233
    v_exp_f32 v234, v234
    ds_read_b64_tr_b16 v[212:213], v244 offset:28672
    ds_read_b64_tr_b16 v[214:215], v244 offset:29184
    s_waitcnt lgkmcnt(12)
    v_mfma_f32_32x32x16_bf16 v[176:191], v[220:223], v[44:47], v[176:191]
    v_exp_f32 v235, v235
    v_mul_f32 v136, v136, v152
    v_mul_f32 v137, v137, v153
    v_mul_f32 v138, v138, v154
    ds_read_b64_tr_b16 v[216:217], v244 offset:14336
    ds_read_b64_tr_b16 v[218:219], v244 offset:14848
    s_waitcnt lgkmcnt(12)
    v_mfma_f32_32x32x16_bf16 v[160:175], v[192:195], v[48:51], v[160:175]
    s_cmp_lt_u32 s40, 4
    s_cbranch_scc1 L_pr_48
    s_setprio 0
L_pr_48:
    v_mul_f32 v139, v139, v155
    v_add_f32 v232, 1.0, v232
    v_add_f32 v233, 1.0, v233
    v_add_f32 v234, 1.0, v234
    ds_read_b64_tr_b16 v[220:221], v244 offset:30720
    ds_read_b64_tr_b16 v[222:223], v244 offset:31232
    s_waitcnt lgkmcnt(12)
    v_mfma_f32_32x32x16_bf16 v[176:191], v[196:199], v[48:51], v[176:191]
    s_add_u32 s56, s71, 0x14000
    s_add_u32 m0, s73, 0x8800
    s_nop 0
    buffer_load_dwordx4 v252, s[20:23], s56 offen lds
    v_add_f32 v235, 1.0, v235
    v_rcp_f32 v232, v232
    v_rcp_f32 v233, v233
    v_rcp_f32 v234, v234
    ds_read_b64_tr_b16 v[192:193], v244 offset:32768
    ds_read_b64_tr_b16 v[194:195], v244 offset:33280
    s_waitcnt lgkmcnt(12)
    v_mfma_f32_32x32x16_bf16 v[160:175], v[200:203], v[52:55], v[160:175]
    v_rcp_f32 v235, v235
    v_mul_f32 v136, v136, v232
    v_mul_f32 v137, v137, v233
    v_mul_f32 v138, v138, v234
    ds_read_b64_tr_b16 v[196:197], v244 offset:49152
    ds_read_b64_tr_b16 v[198:199], v244 offset:49664
    s_waitcnt lgkmcnt(12)
    v_mfma_f32_32x32x16_bf16 v[176:191], v[204:207], v[52:55], v[176:191]
    v_mul_f32 v139, v139, v235
    v_cvt_pk_bf16_f32 v228, v136, v137
    v_cvt_pk_bf16_f32 v229, v138, v139
    v_mul_f32 v236, v140, v140
    ds_read_b64_tr_b16 v[200:201], v244 offset:34816
    ds_read_b64_tr_b16 v[202:203], v244 offset:35328
    s_waitcnt lgkmcnt(12)
    v_mfma_f32_32x32x16_bf16 v[160:175], v[208:211], v[56:59], v[160:175]
    v_mul_f32 v237, v141, v141
    v_mul_f32 v238, v142, v142
    v_mul_f32 v239, v143, v143
    v_fma_f32 v236, v236, s63, v246
    ds_read_b64_tr_b16 v[204:205], v244 offset:51200
    ds_read_b64_tr_b16 v[206:207], v244 offset:51712
    s_waitcnt lgkmcnt(12)
    v_mfma_f32_32x32x16_bf16 v[176:191], v[212:215], v[56:59], v[176:191]
    s_add_u32 s56, s71, 0x15000
    s_add_u32 m0, s73, 0x8c00
    s_nop 0
    s_nop 0
    buffer_load_dwordx4 v252, s[20:23], s56 offen lds
    v_fma_f32 v237, v237, s63, v246
    v_fma_f32 v238, v238, s63, v246
    v_fma_f32 v239, v239, s63, v246
    v_mul_f32 v236, v236, v140
    ds_read_b64_tr_b16 v[208:209], v244 offset:36864
    ds_read_b64_tr_b16 v[210:211], v244 offset:37376
    s_waitcnt lgkmcnt(12)
    v_mfma_f32_32x32x16_bf16 v[160:175], v[216:219], v[60:63], v[160:175]
    v_mul_f32 v237, v237, v141
    v_mul_f32 v238, v238, v142
    v_mul_f32 v239, v239, v143
    v_exp_f32 v236, v236
    ds_read_b64_tr_b16 v[212:213], v244 offset:53248
    ds_read_b64_tr_b16 v[214:215], v244 offset:53760
    s_waitcnt lgkmcnt(12)
    v_mfma_f32_32x32x16_bf16 v[176:191], v[220:223], v[60:63], v[176:191]
    v_exp_f32 v237, v237
    v_exp_f32 v238, v238
    v_exp_f32 v239, v239
    v_mul_f32 v140, v140, v156
    s_waitcnt vmcnt(9)
    s_barrier
    ds_read_b64_tr_b16 v[216:217], v244 offset:38912
    ds_read_b64_tr_b16 v[218:219], v244 offset:39424
    s_waitcnt lgkmcnt(12)
    v_mfma_f32_32x32x16_bf16 v[160:175], v[192:195], v[64:67], v[160:175]
    s_cmp_lt_u32 s40, 4
    s_cbranch_scc1 L_pr_49
    s_setprio 1
L_pr_49:
    v_mul_f32 v141, v141, v157
    v_mul_f32 v142, v142, v158
    v_mul_f32 v143, v143, v159
    v_add_f32 v236, 1.0, v236
    ds_read_b64_tr_b16 v[220:221], v244 offset:55296
    ds_read_b64_tr_b16 v[222:223], v244 offset:55808
    s_waitcnt lgkmcnt(12)
    v_mfma_f32_32x32x16_bf16 v[176:191], v[196:199], v[64:67], v[176:191]
    s_add_u32 s56, s71, 0x20000
    s_add_u32 m0, s73, 0x10000
    s_nop 0
    buffer_load_dwordx4 v252, s[20:23], s56 offen lds
    v_add_f32 v237, 1.0, v237
    v_add_f32 v238, 1.0, v238
    v_add_f32 v239, 1.0, v239
    v_rcp_f32 v236, v236
    ds_read_b64_tr_b16 v[192:193], v244 offset:40960
    ds_read_b64_tr_b16 v[194:195], v244 offset:41472
    s_waitcnt lgkmcnt(12)
    v_mfma_f32_32x32x16_bf16 v[160:175], v[200:203], v[68:71], v[160:175]
    v_rcp_f32 v237, v237
    v_rcp_f32 v238, v238
    v_rcp_f32 v239, v239
    v_mul_f32 v140, v140, v236
    ds_read_b64_tr_b16 v[196:197], v244 offset:57344
    ds_read_b64_tr_b16 v[198:199], v244 offset:57856
    s_waitcnt lgkmcnt(12)
    v_mfma_f32_32x32x16_bf16 v[176:191], v[204:207], v[68:71], v[176:191]
    v_mul_f32 v141, v141, v237
    v_mul_f32 v142, v142, v238
    v_mul_f32 v143, v143, v239
    v_cvt_pk_bf16_f32 v230, v140, v141
    ds_read_b64_tr_b16 v[200:201], v244 offset:43008
    ds_read_b64_tr_b16 v[202:203], v244 offset:43520
    s_waitcnt lgkmcnt(12)
    s_nop 0
    v_mfma_f32_32x32x16_bf16 v[160:175], v[208:211], v[72:75], v[160:175]
    v_cvt_pk_bf16_f32 v231, v142, v143
    buffer_store_dwordx4 v[228:231], v250, s[32:35], s52 offen offset:1024 sc1
    ds_read_b64_tr_b16 v[204:205], v244 offset:59392
    ds_read_b64_tr_b16 v[206:207], v244 offset:59904
    s_waitcnt lgkmcnt(12)
    v_mfma_f32_32x32x16_bf16 v[176:191], v[212:215], v[72:75], v[176:191]
    s_add_u32 s56, s71, 0x21000
    s_add_u32 m0, s73, 0x10400
    s_nop 0
    buffer_load_dwordx4 v252, s[20:23], s56 offen lds
    ds_read_b64_tr_b16 v[208:209], v244 offset:45056
    ds_read_b64_tr_b16 v[210:211], v244 offset:45568
    s_waitcnt lgkmcnt(12)
    v_mfma_f32_32x32x16_bf16 v[160:175], v[216:219], v[76:79], v[160:175]
    ds_read_b64_tr_b16 v[212:213], v244 offset:61440
    ds_read_b64_tr_b16 v[214:215], v244 offset:61952
    s_waitcnt lgkmcnt(12)
    v_mfma_f32_32x32x16_bf16 v[176:191], v[220:223], v[76:79], v[176:191]
    ds_read_b64_tr_b16 v[216:217], v244 offset:47104
    ds_read_b64_tr_b16 v[218:219], v244 offset:47616
    s_waitcnt lgkmcnt(12)
    v_mfma_f32_32x32x16_bf16 v[160:175], v[192:195], v[80:83], v[160:175]
    s_cmp_lt_u32 s40, 4
    s_cbranch_scc1 L_pr_50
    s_setprio 0
L_pr_50:
    ds_read_b64_tr_b16 v[220:221], v244 offset:63488
    ds_read_b64_tr_b16 v[222:223], v244 offset:64000
    s_waitcnt lgkmcnt(12)
    v_mfma_f32_32x32x16_bf16 v[176:191], v[196:199], v[80:83], v[176:191]
    s_add_u32 s56, s71, 0x24000
    s_add_u32 m0, s73, 0x10800
    s_nop 0
    buffer_load_dwordx4 v252, s[20:23], s56 offen lds
    ds_read_b64_tr_b16 v[192:193], v245 offset:0
    ds_read_b64_tr_b16 v[194:195], v245 offset:512
    s_waitcnt lgkmcnt(12)
    v_mfma_f32_32x32x16_bf16 v[160:175], v[200:203], v[84:87], v[160:175]
    ds_read_b64_tr_b16 v[196:197], v245 offset:16384
    ds_read_b64_tr_b16 v[198:199], v245 offset:16896
    s_waitcnt lgkmcnt(12)
    v_mfma_f32_32x32x16_bf16 v[176:191], v[204:207], v[84:87], v[176:191]
    ds_read_b64_tr_b16 v[200:201], v245 offset:2048
    ds_read_b64_tr_b16 v[202:203], v245 offset:2560
    s_waitcnt lgkmcnt(12)
    v_mfma_f32_32x32x16_bf16 v[160:175], v[208:211], v[88:91], v[160:175]
    ds_read_b64_tr_b16 v[204:205], v245 offset:18432
    ds_read_b64_tr_b16 v[206:207], v245 offset:18944
    s_waitcnt lgkmcnt(12)
    v_mfma_f32_32x32x16_bf16 v[176:191], v[212:215], v[88:91], v[176:191]
    s_add_u32 s56, s71, 0x25000
    s_add_u32 m0, s73, 0x10c00
    s_nop 0
    buffer_load_dwordx4 v252, s[20:23], s56 offen lds
    ds_read_b64_tr_b16 v[208:209], v245 offset:4096
    ds_read_b64_tr_b16 v[210:211], v245 offset:4608
    s_waitcnt lgkmcnt(12)
    v_mfma_f32_32x32x16_bf16 v[160:175], v[216:219], v[92:95], v[160:175]
    ds_read_b64_tr_b16 v[212:213], v245 offset:20480
    ds_read_b64_tr_b16 v[214:215], v245 offset:20992
    s_waitcnt lgkmcnt(12)
    v_mfma_f32_32x32x16_bf16 v[176:191], v[220:223], v[92:95], v[176:191]
    s_waitcnt vmcnt(10)
    s_barrier
    v_lshrrev_b32 v255, 8, v250
    v_min_u32 v255, 2, v255
    v_sub_u32 v255, s41, v255
    v_max_i32 v255, 0, v255
    v_bfe_u32 v254, v250, 4, 4
    v_lshlrev_b32 v254, 2, v254
    v_lshl_add_u32 v254, v255, 7, v254
    v_add_u32 v254, 0x1000000, v254
    buffer_load_dword v255, v254, s[32:35], 0 offen sc0 sc1
    ds_read_b64_tr_b16 v[216:217], v245 offset:6144
    ds_read_b64_tr_b16 v[218:219], v245 offset:6656
    s_waitcnt lgkmcnt(12)
    v_mfma_f32_32x32x16_bf16 v[160:175], v[192:195], v[96:99], v[160:175]
    s_cmp_lt_u32 s40, 4
    s_cbranch_scc1 L_pr_51
    s_setprio 1
L_pr_51:
    ds_read_b64_tr_b16 v[220:221], v245 offset:22528
    ds_read_b64_tr_b16 v[222:223], v245 offset:23040
    s_waitcnt lgkmcnt(12)
    v_mfma_f32_32x32x16_bf16 v[176:191], v[196:199], v[96:99], v[176:191]
    s_add_u32 s56, s71, 0x30000
    s_add_u32 m0, s73, 0x18000
    s_nop 0
    buffer_load_dwordx4 v252, s[20:23], s56 offen lds
    ds_read_b64_tr_b16 v[192:193], v245 offset:8192
    ds_read_b64_tr_b16 v[194:195], v245 offset:8704
    s_waitcnt lgkmcnt(12)
    v_mfma_f32_32x32x16_bf16 v[160:175], v[200:203], v[100:103], v[160:175]
    ds_read_b64_tr_b16 v[196:197], v245 offset:24576
    ds_read_b64_tr_b16 v[198:199], v245 offset:25088
    s_waitcnt lgkmcnt(12)
    v_mfma_f32_32x32x16_bf16 v[176:191], v[204:207], v[100:103], v[176:191]
    ds_read_b64_tr_b16 v[200:201], v245 offset:10240
    ds_read_b64_tr_b16 v[202:203], v245 offset:10752
    s_waitcnt lgkmcnt(12)
    v_mfma_f32_32x32x16_bf16 v[160:175], v[208:211], v[104:107], v[160:175]
    ds_read_b64_tr_b16 v[204:205], v245 offset:26624
    ds_read_b64_tr_b16 v[206:207], v245 offset:27136
    s_waitcnt lgkmcnt(12)
    v_mfma_f32_32x32x16_bf16 v[176:191], v[212:215], v[104:107], v[176:191]
    s_add_u32 s56, s71, 0x31000
    s_add_u32 m0, s73, 0x18400
    s_nop 0
    buffer_load_dwordx4 v252, s[20:23], s56 offen lds
    ds_read_b64_tr_b16 v[208:209], v245 offset:12288
    ds_read_b64_tr_b16 v[210:211], v245 offset:12800
    s_waitcnt lgkmcnt(12)
    v_mfma_f32_32x32x16_bf16 v[160:175], v[216:219], v[108:111], v[160:175]
    ds_read_b64_tr_b16 v[212:213], v245 offset:28672
    ds_read_b64_tr_b16 v[214:215], v245 offset:29184
    s_waitcnt lgkmcnt(12)
    v_mfma_f32_32x32x16_bf16 v[176:191], v[220:223], v[108:111], v[176:191]
    ds_read_b64_tr_b16 v[216:217], v245 offset:14336
    ds_read_b64_tr_b16 v[218:219], v245 offset:14848
    s_waitcnt lgkmcnt(12)
    v_mfma_f32_32x32x16_bf16 v[160:175], v[192:195], v[112:115], v[160:175]
    s_cmp_lt_u32 s40, 4
    s_cbranch_scc1 L_pr_52
    s_setprio 0
L_pr_52:
    ds_read_b64_tr_b16 v[220:221], v245 offset:30720
    ds_read_b64_tr_b16 v[222:223], v245 offset:31232
    s_waitcnt lgkmcnt(12)
    v_mfma_f32_32x32x16_bf16 v[176:191], v[196:199], v[112:115], v[176:191]
    s_add_u32 s56, s71, 0x34000
    s_add_u32 m0, s73, 0x18800
    s_nop 0
    buffer_load_dwordx4 v252, s[20:23], s56 offen lds
    s_waitcnt lgkmcnt(10)
    v_mfma_f32_32x32x16_bf16 v[160:175], v[200:203], v[116:119], v[160:175]
    s_waitcnt lgkmcnt(8)
    v_mfma_f32_32x32x16_bf16 v[176:191], v[204:207], v[116:119], v[176:191]
    s_waitcnt lgkmcnt(6)
    v_mfma_f32_32x32x16_bf16 v[160:175], v[208:211], v[120:123], v[160:175]
    s_waitcnt lgkmcnt(4)
    v_mfma_f32_32x32x16_bf16 v[176:191], v[212:215], v[120:123], v[176:191]
    s_add_u32 s56, s71, 0x35000
    s_add_u32 m0, s73, 0x18c00
    s_nop 0
    buffer_load_dwordx4 v252, s[20:23], s56 offen lds
    s_waitcnt lgkmcnt(2)
    v_mfma_f32_32x32x16_bf16 v[160:175], v[216:219], v[124:127], v[160:175]
    s_waitcnt lgkmcnt(0)
    v_mfma_f32_32x32x16_bf16 v[176:191], v[220:223], v[124:127], v[176:191]
    s_waitcnt vmcnt(4)
    s_mov_b32 s55, 0
    s_nop 9
L_flr_53:
    v_cmp_ne_u32 vcc, s94, v255
    s_nop 4
    s_cbranch_vccz L_fld_54
    s_sleep 1
    buffer_load_dword v255, v254, s[32:35], 0 offen sc0 sc1
    s_waitcnt vmcnt(0)
    s_add_u32 s55, s55, 1
    s_cmp_lt_u32 s55, 0x100000
    s_cbranch_scc1 L_flr_53
L_fld_54:
    s_lshl_b32 s75, s42, 3
    s_lshl_b32 s56, s43, 1
    s_add_u32 s75, s75, s56
    s_add_u32 s75, s75, s45
    s_lshl_b32 s74, s41, 2
    s_add_u32 s74, s74, s44
    s_lshl_b32 s56, s75, 6
    s_add_u32 s57, s56, s74
    s_lshl_b32 s57, s57, 10
    buffer_load_dwordx4 v[140:143], v250, s[32:35], s57 offen sc1
    s_add_i32 s57, s74, 0
    s_max_i32 s57, s57, 0
    s_add_u32 s57, s57, s56
    s_lshl_b32 s57, s57, 10
    s_add_u32 s58, s57, 0x200000
    buffer_load_dwordx4 v[136:139], v250, s[32:35], s58 offen sc1
    s_add_u32 s84, s57, 0x400000
    s_add_i32 s57, s74, -1
    s_max_i32 s57, s57, 0
    s_add_u32 s57, s57, s56
    s_lshl_b32 s57, s57, 10
    s_add_u32 s58, s57, 0x200000
    buffer_load_dwordx4 v[132:135], v250, s[32:35], s58 offen sc1
    s_add_u32 s83, s57, 0x400000
    s_add_i32 s57, s74, -2
    s_max_i32 s57, s57, 0
    s_add_u32 s57, s57, s56
    s_lshl_b32 s57, s57, 10
    s_add_u32 s58, s57, 0x200000
    buffer_load_dwordx4 v[128:131], v250, s[32:35], s58 offen sc1
    s_add_u32 s82, s57, 0x400000
    s_add_i32 s57, s74, -3
    s_max_i32 s57, s57, 0
    s_add_u32 s57, s57, s56
    s_lshl_b32 s57, s57, 10
    s_add_u32 s58, s57, 0x200000
    buffer_load_dwordx4 v[124:127], v250, s[32:35], s58 offen sc1
    s_add_u32 s81, s57, 0x400000
    s_add_i32 s57, s74, -4
    s_max_i32 s57, s57, 0
    s_add_u32 s57, s57, s56
    s_lshl_b32 s57, s57, 10
    s_add_u32 s58, s57, 0x200000
    buffer_load_dwordx4 v[120:123], v250, s[32:35], s58 offen sc1
    s_add_u32 s80, s57, 0x400000
    s_add_i32 s57, s74, -5
    s_max_i32 s57, s57, 0
    s_add_u32 s57, s57, s56
    s_lshl_b32 s57, s57, 10
    s_add_u32 s58, s57, 0x200000
    buffer_load_dwordx4 v[116:119], v250, s[32:35], s58 offen sc1
    s_add_u32 s79, s57, 0x400000
    s_add_i32 s57, s74, -6
    s_max_i32 s57, s57, 0
    s_add_u32 s57, s57, s56
    s_lshl_b32 s57, s57, 10
    s_add_u32 s58, s57, 0x200000
    buffer_load_dwordx4 v[112:115], v250, s[32:35], s58 offen sc1
    s_add_u32 s78, s57, 0x400000
    s_add_i32 s57, s74, -7
    s_max_i32 s57, s57, 0
    s_add_u32 s57, s57, s56
    s_lshl_b32 s57, s57, 10
    s_add_u32 s58, s57, 0x200000
    buffer_load_dwordx4 v[108:111], v250, s[32:35], s58 offen sc1
    s_add_u32 s77, s57, 0x400000
    s_add_i32 s57, s74, -8
    s_max_i32 s57, s57, 0
    s_add_u32 s57, s57, s56
    s_lshl_b32 s57, s57, 10
    s_add_u32 s58, s57, 0x200000
    buffer_load_dwordx4 v[104:107], v250, s[32:35], s58 offen sc1
    s_add_u32 s76, s57, 0x400000
    v_mul_f32 v232, v160, v160
    v_mul_f32 v233, v161, v161
    v_mul_f32 v234, v162, v162
    v_mul_f32 v235, v163, v163
    s_nop 0
    v_fma_f32 v232, v232, s63, v246
    v_fma_f32 v233, v233, s63, v246
    v_fma_f32 v234, v234, s63, v246
    v_fma_f32 v235, v235, s63, v246
    v_mul_f32 v232, v232, v160
    v_mul_f32 v233, v233, v161
    v_mul_f32 v234, v234, v162
    v_mul_f32 v235, v235, v163
    v_exp_f32 v232, v232
    v_exp_f32 v233, v233
    v_exp_f32 v234, v234
    v_exp_f32 v235, v235
    v_mul_f32 v160, v160, v176
    v_mul_f32 v161, v161, v177
    v_mul_f32 v162, v162, v178
    v_mul_f32 v163, v163, v179
    v_add_f32 v232, 1.0, v232
    v_add_f32 v233, 1.0, v233
    v_add_f32 v234, 1.0, v234
    v_add_f32 v235, 1.0, v235
    v_rcp_f32 v232, v232
    v_rcp_f32 v233, v233
    v_rcp_f32 v234, v234
    v_rcp_f32 v235, v235
    v_mul_f32 v160, v160, v232
    v_mul_f32 v161, v161, v233
    v_mul_f32 v162, v162, v234
    v_mul_f32 v163, v163, v235
    v_cvt_pk_bf16_f32 v224, v160, v161
    v_cvt_pk_bf16_f32 v225, v162, v163
    v_mul_f32 v236, v164, v164
    v_mul_f32 v237, v165, v165
    v_mul_f32 v238, v166, v166
    v_mul_f32 v239, v167, v167
    v_fma_f32 v236, v236, s63, v246
    v_fma_f32 v237, v237, s63, v246
    v_fma_f32 v238, v238, s63, v246
    v_fma_f32 v239, v239, s63, v246
    v_mul_f32 v236, v236, v164
    v_mul_f32 v237, v237, v165
    v_mul_f32 v238, v238, v166
    v_mul_f32 v239, v239, v167
    v_exp_f32 v236, v236
    v_exp_f32 v237, v237
    v_exp_f32 v238, v238
    v_exp_f32 v239, v239
    v_mul_f32 v164, v164, v180
    v_mul_f32 v165, v165, v181
    v_mul_f32 v166, v166, v182
    v_mul_f32 v167, v167, v183
    v_add_f32 v236, 1.0, v236
    v_add_f32 v237, 1.0, v237
    v_add_f32 v238, 1.0, v238
    v_add_f32 v239, 1.0, v239
    v_rcp_f32 v236, v236
    v_rcp_f32 v237, v237
    v_rcp_f32 v238, v238
    v_rcp_f32 v239, v239
    v_mul_f32 v164, v164, v236
    v_mul_f32 v165, v165, v237
    v_mul_f32 v166, v166, v238
    v_mul_f32 v167, v167, v239
    v_cvt_pk_bf16_f32 v226, v164, v165
    v_cvt_pk_bf16_f32 v227, v166, v167
    buffer_store_dwordx4 v[224:227], v250, s[32:35], s53 offen offset:0 sc1
    v_mul_f32 v232, v168, v168
    v_mul_f32 v233, v169, v169
    v_mul_f32 v234, v170, v170
    v_mul_f32 v235, v171, v171
    v_fma_f32 v232, v232, s63, v246
    v_fma_f32 v233, v233, s63, v246
    v_fma_f32 v234, v234, s63, v246
    v_fma_f32 v235, v235, s63, v246
    v_mul_f32 v232, v232, v168
    v_mul_f32 v233, v233, v169
    v_mul_f32 v234, v234, v170
    v_mul_f32 v235, v235, v171
    v_exp_f32 v232, v232
    v_exp_f32 v233, v233
    v_exp_f32 v234, v234
    v_exp_f32 v235, v235
    v_mul_f32 v168, v168, v184
    v_mul_f32 v169, v169, v185
    v_mul_f32 v170, v170, v186
    v_mul_f32 v171, v171, v187
    v_add_f32 v232, 1.0, v232
    v_add_f32 v233, 1.0, v233
    v_add_f32 v234, 1.0, v234
    v_add_f32 v235, 1.0, v235
    v_rcp_f32 v232, v232
    v_rcp_f32 v233, v233
    v_rcp_f32 v234, v234
    v_rcp_f32 v235, v235
    v_mul_f32 v168, v168, v232
    v_mul_f32 v169, v169, v233
    v_mul_f32 v170, v170, v234
    v_mul_f32 v171, v171, v235
    v_cvt_pk_bf16_f32 v228, v168, v169
    v_cvt_pk_bf16_f32 v229, v170, v171
    v_mul_f32 v236, v172, v172
    v_mul_f32 v237, v173, v173
    v_mul_f32 v238, v174, v174
    v_mul_f32 v239, v175, v175
    v_fma_f32 v236, v236, s63, v246
    v_fma_f32 v237, v237, s63, v246
    v_fma_f32 v238, v238, s63, v246
    v_fma_f32 v239, v239, s63, v246
    v_mul_f32 v236, v236, v172
    v_mul_f32 v237, v237, v173
    v_mul_f32 v238, v238, v174
    v_mul_f32 v239, v239, v175
    v_exp_f32 v236, v236
    v_exp_f32 v237, v237
    v_exp_f32 v238, v238
    v_exp_f32 v239, v239
    v_mul_f32 v172, v172, v188
    v_mul_f32 v173, v173, v189
    v_mul_f32 v174, v174, v190
    v_mul_f32 v175, v175, v191
    v_add_f32 v236, 1.0, v236
    v_add_f32 v237, 1.0, v237
    v_add_f32 v238, 1.0, v238
    v_add_f32 v239, 1.0, v239
    v_rcp_f32 v236, v236
    v_rcp_f32 v237, v237
    v_rcp_f32 v238, v238
    v_rcp_f32 v239, v239
    v_mul_f32 v172, v172, v236
    v_mul_f32 v173, v173, v237
    v_mul_f32 v174, v174, v238
    v_mul_f32 v175, v175, v239
    v_cvt_pk_bf16_f32 v230, v172, v173
    v_cvt_pk_bf16_f32 v231, v174, v175
    buffer_store_dwordx4 v[228:231], v250, s[32:35], s53 offen offset:1024 sc1
    v_mov_b32 v192, s60
    v_mov_b32 v193, s60
    v_mov_b32 v194, s60
    v_mov_b32 v195, s60
    v_mov_b32 v196, s60
    v_mov_b32 v197, s60
    v_mov_b32 v198, s60
    v_mov_b32 v199, s60
    s_mov_b32 exec_lo, 0x0000ffff
    s_mov_b32 exec_hi, 0x0000ffff
    buffer_load_dwordx4 v[192:195], v250, s[32:35], s76 offen sc1
    s_mov_b32 exec_lo, 0xffff0000
    s_mov_b32 exec_hi, 0xffff0000
    buffer_load_dwordx4 v[196:199], v250, s[32:35], s76 offen sc1
    s_mov_b64 exec, -1
    v_mov_b32 v200, s60
    v_mov_b32 v201, s60
    v_mov_b32 v202, s60
    v_mov_b32 v203, s60
    v_mov_b32 v204, s60
    v_mov_b32 v205, s60
    v_mov_b32 v206, s60
    v_mov_b32 v207, s60
    s_nop 0
    s_mov_b32 exec_lo, 0x0000ffff
    s_mov_b32 exec_hi, 0x0000ffff
    buffer_load_dwordx4 v[200:203], v250, s[32:35], s77 offen sc1
    s_mov_b32 exec_lo, 0xffff0000
    s_mov_b32 exec_hi, 0xffff0000
    buffer_load_dwordx4 v[204:207], v250, s[32:35], s77 offen sc1
    s_mov_b64 exec, -1
    v_mov_b32 v208, s60
    v_mov_b32 v209, s60
    v_mov_b32 v210, s60
    v_mov_b32 v211, s60
    v_mov_b32 v212, s60
    v_mov_b32 v213, s60
    v_mov_b32 v214, s60
    v_mov_b32 v215, s60
    s_nop 0
    s_mov_b32 exec_lo, 0x0000ffff
    s_mov_b32 exec_hi, 0x0000ffff
    buffer_load_dwordx4 v[208:211], v250, s[32:35], s78 offen sc1
    s_mov_b32 exec_lo, 0xffff0000
    s_mov_b32 exec_hi, 0xffff0000
    buffer_load_dwordx4 v[212:215], v250, s[32:35], s78 offen sc1
    s_mov_b64 exec, -1
    v_mov_b32 v32, s60
    v_mov_b32 v33, s60
    v_mov_b32 v34, s60
    v_mov_b32 v35, s60
    v_mov_b32 v36, s60
    v_mov_b32 v37, s60
    v_mov_b32 v38, s60
    v_mov_b32 v39, s60
    s_nop 0
    s_mov_b32 exec_lo, 0x0000ffff
    s_mov_b32 exec_hi, 0x0000ffff
    buffer_load_dwordx4 v[32:35], v250, s[32:35], s79 offen sc1
    s_mov_b32 exec_lo, 0xffff0000
    s_mov_b32 exec_hi, 0xffff0000
    buffer_load_dwordx4 v[36:39], v250, s[32:35], s79 offen sc1
    s_mov_b64 exec, -1
    v_mov_b32 v40, s60
    v_mov_b32 v41, s60
    v_mov_b32 v42, s60
    v_mov_b32 v43, s60
    v_mov_b32 v44, s60
    v_mov_b32 v45, s60
    v_mov_b32 v46, s60
    v_mov_b32 v47, s60
    s_nop 0
    s_mov_b32 exec_lo, 0x0000ffff
    s_mov_b32 exec_hi, 0x0000ffff
    buffer_load_dwordx4 v[40:43], v250, s[32:35], s80 offen sc1
    s_mov_b32 exec_lo, 0xffff0000
    s_mov_b32 exec_hi, 0xffff0000
    buffer_load_dwordx4 v[44:47], v250, s[32:35], s80 offen sc1
    s_mov_b64 exec, -1
    v_mov_b32 v48, s60
    v_mov_b32 v49, s60
    v_mov_b32 v50, s60
    v_mov_b32 v51, s60
    v_mov_b32 v52, s60
    v_mov_b32 v53, s60
    v_mov_b32 v54, s60
    v_mov_b32 v55, s60
    s_nop 0
    s_mov_b32 exec_lo, 0x0000ffff
    s_mov_b32 exec_hi, 0x0000ffff
    buffer_load_dwordx4 v[48:51], v250, s[32:35], s81 offen sc1
    s_mov_b32 exec_lo, 0xffff0000
    s_mov_b32 exec_hi, 0xffff0000
    buffer_load_dwordx4 v[52:55], v250, s[32:35], s81 offen sc1
    s_mov_b64 exec, -1
    v_mov_b32 v56, s60
    v_mov_b32 v57, s60
    v_mov_b32 v58, s60
    v_mov_b32 v59, s60
    v_mov_b32 v60, s60
    v_mov_b32 v61, s60
    v_mov_b32 v62, s60
    v_mov_b32 v63, s60
    s_nop 0
    s_mov_b32 exec_lo, 0x0000ffff
    s_mov_b32 exec_hi, 0x0000ffff
    buffer_load_dwordx4 v[56:59], v250, s[32:35], s82 offen sc1
    s_mov_b32 exec_lo, 0xffff0000
    s_mov_b32 exec_hi, 0xffff0000
    buffer_load_dwordx4 v[60:63], v250, s[32:35], s82 offen sc1
    s_mov_b64 exec, -1
    v_mov_b32 v64, s60
    v_mov_b32 v65, s60
    v_mov_b32 v66, s60
    v_mov_b32 v67, s60
    v_mov_b32 v68, s60
    v_mov_b32 v69, s60
    v_mov_b32 v70, s60
    v_mov_b32 v71, s60
    s_nop 0
    s_mov_b32 exec_lo, 0x0000ffff
    s_mov_b32 exec_hi, 0x0000ffff
    buffer_load_dwordx4 v[64:67], v250, s[32:35], s83 offen sc1
    s_mov_b32 exec_lo, 0xffff0000
    s_mov_b32 exec_hi, 0xffff0000
    buffer_load_dwordx4 v[68:71], v250, s[32:35], s83 offen sc1
    s_mov_b64 exec, -1
    v_mov_b32 v72, s60
    v_mov_b32 v73, s60
    v_mov_b32 v74, s60
    v_mov_b32 v75, s60
    v_mov_b32 v76, s60
    v_mov_b32 v77, s60
    v_mov_b32 v78, s60
    v_mov_b32 v79, s60
    s_nop 0
    s_mov_b32 exec_lo, 0x0000ffff
    s_mov_b32 exec_hi, 0x0000ffff
    buffer_load_dwordx4 v[72:75], v250, s[32:35], s84 offen sc1
    s_mov_b32 exec_lo, 0xffff0000
    s_mov_b32 exec_hi, 0xffff0000
    buffer_load_dwordx4 v[76:79], v250, s[32:35], s84 offen sc1
    s_mov_b64 exec, -1
    s_branch L_p1join_3
L_typeB_2:
    s_lshl_b32 s59, s41, 2
    s_add_u32 s59, s59, s44
    s_mul_i32 s58, s59, 144
    s_lshl_b32 s57, s45, 1
    s_add_u32 s58, s58, s57
    s_mul_i32 s56, s42, 7
    s_lshl_b32 s76, s42, 7
    s_add_u32 s47, s76, 0
    s_lshl_b32 s76, s42, 2
    s_add_u32 s76, s76, 0
    s_add_u32 s76, s76, s57
    s_lshl_b32 s76, s76, 6
    s_add_u32 s76, s76, s59
    s_lshl_b32 s51, s76, 10
    s_lshl_b32 s76, s42, 7
    s_add_u32 s48, s76, 1024
    s_lshl_b32 s76, s42, 2
    s_add_u32 s76, s76, 32
    s_add_u32 s76, s76, s57
    s_lshl_b32 s76, s76, 6
    s_add_u32 s76, s76, s59
    s_lshl_b32 s52, s76, 10
    s_lshl_b32 s76, s42, 7
    s_add_u32 s49, s76, 2048
    s_lshl_b32 s76, s42, 2
    s_add_u32 s76, s76, 64
    s_add_u32 s76, s76, s57
    s_lshl_b32 s76, s76, 6
    s_add_u32 s76, s76, s59
    s_lshl_b32 s53, s76, 10
    s_add_u32 s76, s56, 6
    s_lshl_b32 s50, s76, 7
    s_lshl_b32 s76, s76, 2
    s_add_u32 s76, s76, s58
    s_lshl_b32 s76, s76, 10
    s_add_u32 s54, s76, 0x600000
    s_mov_b32 s64, 0x3eb8aa3b
    s_bfe_u32 s56, s2, 0x30003
    s_lshl_b32 s56, s56, 3
    s_add_u32 s56, s56, s40
    s_lshl_b32 s56, s56, 3
    v_and_b32 v236, 7, v233
    v_add_u32 v236, s56, v236
    v_lshrrev_b32 v237, 3, v233
    s_movk_i32 s56, 3072
    s_movk_i32 s57, 3584
    v_lshlrev_b32 v238, 10, v237
    v_mad_u32_u24 v238, v236, s56, v238
    v_lshlrev_b32 v239, 7, v237
    v_mad_u32_u24 v239, v236, s57, v239
    s_add_u32 s58, s47, 0
    s_add_u32 s59, s50, 0
    s_mov_b64 exec, 0xff
    buffer_load_dword v156, v238, s[8:11], s58 offen
    s_mov_b64 exec, -1
    s_nop 0
    buffer_load_dword v247, off, s[36:39], 0 sc0 sc1
    buffer_load_dword v155, off, s[32:35], s51
    buffer_load_dword v155, off, s[32:35], s52
    buffer_load_dword v155, off, s[32:35], s53
    buffer_load_dword v155, off, s[32:35], s54
    s_lshl_b32 s56, s65, 16
    s_lshl_b32 s57, s66, 7
    s_add_u32 s56, s56, s57
    buffer_load_dword v155, off, s[28:31], s56
    buffer_load_dword v155, off, s[24:27], s57
    buffer_load_dword v155, off, s[20:23], s57
    v_mov_b32 v128, 0
    v_mov_b32 v129, 0
    v_mov_b32 v130, 0
    v_mov_b32 v131, 0
    v_mov_b32 v132, 0
    v_mov_b32 v133, 0
    v_mov_b32 v134, 0
    v_mov_b32 v135, 0
    s_waitcnt vmcnt(9)
    ds_read_b128 v[0:3], v160 offset:0
    ds_read_b128 v[4:7], v161 offset:0
    ds_read_b128 v[8:11], v162 offset:0
    ds_read_b128 v[12:15], v163 offset:0
    ds_read_b128 v[16:19], v160 offset:256
    ds_read_b128 v[20:23], v161 offset:256
    ds_read_b128 v[24:27], v162 offset:256
    ds_read_b128 v[28:31], v163 offset:256
    ds_read_b128 v[32:35], v160 offset:512
    ds_read_b128 v[36:39], v161 offset:512
    ds_read_b128 v[40:43], v162 offset:512
    ds_read_b128 v[44:47], v163 offset:512
    ds_read_b128 v[48:51], v160 offset:768
    ds_read_b128 v[52:55], v161 offset:768
    ds_read_b128 v[56:59], v162 offset:768
    ds_read_b128 v[60:63], v163 offset:768
    s_waitcnt lgkmcnt(14)
    v_dot2c_f32_bf16 v128, s60, v0
    v_dot2c_f32_bf16 v132, v0, v0
    v_dot2c_f32_bf16 v129, s60, v1
    v_dot2c_f32_bf16 v133, v1, v1
    v_dot2c_f32_bf16 v130, s60, v2
    v_dot2c_f32_bf16 v134, v2, v2
    v_dot2c_f32_bf16 v131, s60, v3
    v_dot2c_f32_bf16 v135, v3, v3
    v_dot2c_f32_bf16 v128, s60, v4
    v_dot2c_f32_bf16 v132, v4, v4
    v_dot2c_f32_bf16 v129, s60, v5
    v_dot2c_f32_bf16 v133, v5, v5
    v_dot2c_f32_bf16 v130, s60, v6
    v_dot2c_f32_bf16 v134, v6, v6
    v_dot2c_f32_bf16 v131, s60, v7
    v_dot2c_f32_bf16 v135, v7, v7
    s_waitcnt lgkmcnt(12)
    v_dot2c_f32_bf16 v128, s60, v8
    v_dot2c_f32_bf16 v132, v8, v8
    v_dot2c_f32_bf16 v129, s60, v9
    v_dot2c_f32_bf16 v133, v9, v9
    v_dot2c_f32_bf16 v130, s60, v10
    v_dot2c_f32_bf16 v134, v10, v10
    v_dot2c_f32_bf16 v131, s60, v11
    v_dot2c_f32_bf16 v135, v11, v11
    v_dot2c_f32_bf16 v128, s60, v12
    v_dot2c_f32_bf16 v132, v12, v12
    v_dot2c_f32_bf16 v129, s60, v13
    v_dot2c_f32_bf16 v133, v13, v13
    v_dot2c_f32_bf16 v130, s60, v14
    v_dot2c_f32_bf16 v134, v14, v14
    v_dot2c_f32_bf16 v131, s60, v15
    v_dot2c_f32_bf16 v135, v15, v15
    s_waitcnt lgkmcnt(10)
    v_dot2c_f32_bf16 v128, s60, v16
    v_dot2c_f32_bf16 v132, v16, v16
    v_dot2c_f32_bf16 v129, s60, v17
    v_dot2c_f32_bf16 v133, v17, v17
    v_dot2c_f32_bf16 v130, s60, v18
    v_dot2c_f32_bf16 v134, v18, v18
    v_dot2c_f32_bf16 v131, s60, v19
    v_dot2c_f32_bf16 v135, v19, v19
    v_dot2c_f32_bf16 v128, s60, v20
    v_dot2c_f32_bf16 v132, v20, v20
    v_dot2c_f32_bf16 v129, s60, v21
    v_dot2c_f32_bf16 v133, v21, v21
    v_dot2c_f32_bf16 v130, s60, v22
    v_dot2c_f32_bf16 v134, v22, v22
    v_dot2c_f32_bf16 v131, s60, v23
    v_dot2c_f32_bf16 v135, v23, v23
    s_waitcnt lgkmcnt(8)
    v_dot2c_f32_bf16 v128, s60, v24
    v_dot2c_f32_bf16 v132, v24, v24
    v_dot2c_f32_bf16 v129, s60, v25
    v_dot2c_f32_bf16 v133, v25, v25
    v_dot2c_f32_bf16 v130, s60, v26
    v_dot2c_f32_bf16 v134, v26, v26
    v_dot2c_f32_bf16 v131, s60, v27
    v_dot2c_f32_bf16 v135, v27, v27
    v_dot2c_f32_bf16 v128, s60, v28
    v_dot2c_f32_bf16 v132, v28, v28
    v_dot2c_f32_bf16 v129, s60, v29
    v_dot2c_f32_bf16 v133, v29, v29
    v_dot2c_f32_bf16 v130, s60, v30
    v_dot2c_f32_bf16 v134, v30, v30
    v_dot2c_f32_bf16 v131, s60, v31
    v_dot2c_f32_bf16 v135, v31, v31
    s_waitcnt lgkmcnt(6)
    v_dot2c_f32_bf16 v128, s60, v32
    v_dot2c_f32_bf16 v132, v32, v32
    v_dot2c_f32_bf16 v129, s60, v33
    v_dot2c_f32_bf16 v133, v33, v33
    v_dot2c_f32_bf16 v130, s60, v34
    v_dot2c_f32_bf16 v134, v34, v34
    v_dot2c_f32_bf16 v131, s60, v35
    v_dot2c_f32_bf16 v135, v35, v35
    v_dot2c_f32_bf16 v128, s60, v36
    v_dot2c_f32_bf16 v132, v36, v36
    v_dot2c_f32_bf16 v129, s60, v37
    v_dot2c_f32_bf16 v133, v37, v37
    v_dot2c_f32_bf16 v130, s60, v38
    v_dot2c_f32_bf16 v134, v38, v38
    v_dot2c_f32_bf16 v131, s60, v39
    v_dot2c_f32_bf16 v135, v39, v39
    s_waitcnt lgkmcnt(4)
    v_dot2c_f32_bf16 v128, s60, v40
    v_dot2c_f32_bf16 v132, v40, v40
    v_dot2c_f32_bf16 v129, s60, v41
    v_dot2c_f32_bf16 v133, v41, v41
    v_dot2c_f32_bf16 v130, s60, v42
    v_dot2c_f32_bf16 v134, v42, v42
    v_dot2c_f32_bf16 v131, s60, v43
    v_dot2c_f32_bf16 v135, v43, v43
    v_dot2c_f32_bf16 v128, s60, v44
    v_dot2c_f32_bf16 v132, v44, v44
    v_dot2c_f32_bf16 v129, s60, v45
    v_dot2c_f32_bf16 v133, v45, v45
    v_dot2c_f32_bf16 v130, s60, v46
    v_dot2c_f32_bf16 v134, v46, v46
    v_dot2c_f32_bf16 v131, s60, v47
    v_dot2c_f32_bf16 v135, v47, v47
    s_waitcnt lgkmcnt(2)
    v_dot2c_f32_bf16 v128, s60, v48
    v_dot2c_f32_bf16 v132, v48, v48
    v_dot2c_f32_bf16 v129, s60, v49
    v_dot2c_f32_bf16 v133, v49, v49
    v_dot2c_f32_bf16 v130, s60, v50
    v_dot2c_f32_bf16 v134, v50, v50
    v_dot2c_f32_bf16 v131, s60, v51
    v_dot2c_f32_bf16 v135, v51, v51
    v_dot2c_f32_bf16 v128, s60, v52
    v_dot2c_f32_bf16 v132, v52, v52
    v_dot2c_f32_bf16 v129, s60, v53
    v_dot2c_f32_bf16 v133, v53, v53
    v_dot2c_f32_bf16 v130, s60, v54
    v_dot2c_f32_bf16 v134, v54, v54
    v_dot2c_f32_bf16 v131, s60, v55
    v_dot2c_f32_bf16 v135, v55, v55
    s_waitcnt lgkmcnt(0)
    v_dot2c_f32_bf16 v128, s60, v56
    v_dot2c_f32_bf16 v132, v56, v56
    v_dot2c_f32_bf16 v129, s60, v57
    v_dot2c_f32_bf16 v133, v57, v57
    v_dot2c_f32_bf16 v130, s60, v58
    v_dot2c_f32_bf16 v134, v58, v58
    v_dot2c_f32_bf16 v131, s60, v59
    v_dot2c_f32_bf16 v135, v59, v59
    v_dot2c_f32_bf16 v128, s60, v60
    v_dot2c_f32_bf16 v132, v60, v60
    v_dot2c_f32_bf16 v129, s60, v61
    v_dot2c_f32_bf16 v133, v61, v61
    v_dot2c_f32_bf16 v130, s60, v62
    v_dot2c_f32_bf16 v134, v62, v62
    v_dot2c_f32_bf16 v131, s60, v63
    v_dot2c_f32_bf16 v135, v63, v63
    v_add_f32 v128, v128, v129
    s_nop 0
    v_add_f32 v130, v130, v131
    v_add_f32 v132, v132, v133
    v_add_f32 v134, v134, v135
    v_add_f32 v136, v128, v130
    v_add_f32 v137, v132, v134
    v_mov_b32 v128, v136
    v_mov_b32 v129, v137
    s_nop 0
    v_permlane16_swap_b32 v136, v128
    v_permlane16_swap_b32 v137, v129
    v_add_f32 v136, v136, v128
    v_add_f32 v137, v137, v129
    v_mov_b32 v128, v136
    v_mov_b32 v129, v137
    s_nop 0
    v_permlane32_swap_b32 v136, v128
    v_permlane32_swap_b32 v137, v129
    v_add_f32 v136, v136, v128
    v_add_f32 v137, v137, v129
    s_mov_b32 s56, 0x3b000000
    s_mov_b32 s57, 0x3727c5ac
    v_mul_f32 v136, s56, v136
    v_mul_f32 v137, s56, v137
    v_fma_f32 v137, -v136, v136, v137
    v_max_f32 v137, 0, v137
    v_cvt_pk_bf16_f32 v128, v136, v137
    v_lshlrev_b32 v136, 16, v128
    v_and_b32 v137, s61, v128
    v_add_f32 v137, s57, v137
    v_cvt_pk_bf16_f32 v128, v137, v137
    v_and_b32 v137, s61, v128
    v_sqrt_f32 v137, v137
    s_nop 0
    v_cvt_pk_bf16_f32 v128, v137, v137
    v_and_b32 v137, s61, v128
    v_rcp_f32 v137, v137
    s_nop 0
    v_mul_f32 v136, v136, v137
    v_sub_f32 v136, 0, v136
    v_lshlrev_b32 v224, 16, v0
    v_and_b32 v225, s61, v0
    v_lshlrev_b32 v226, 16, v1
    v_and_b32 v227, s61, v1
    v_lshlrev_b32 v228, 16, v2
    v_and_b32 v229, s61, v2
    v_lshlrev_b32 v230, 16, v3
    v_and_b32 v231, s61, v3
    s_nop 0
    v_pk_fma_f32 v[224:225], v[224:225], v[136:137], v[136:137] op_sel:[0,1,0] op_sel_hi:[1,1,0]
    v_pk_fma_f32 v[226:227], v[226:227], v[136:137], v[136:137] op_sel:[0,1,0] op_sel_hi:[1,1,0]
    v_pk_fma_f32 v[228:229], v[228:229], v[136:137], v[136:137] op_sel:[0,1,0] op_sel_hi:[1,1,0]
    v_pk_fma_f32 v[230:231], v[230:231], v[136:137], v[136:137] op_sel:[0,1,0] op_sel_hi:[1,1,0]
    v_cvt_pk_bf16_f32 v0, v224, v225
    v_cvt_pk_bf16_f32 v1, v226, v227
    v_cvt_pk_bf16_f32 v2, v228, v229
    v_cvt_pk_bf16_f32 v3, v230, v231
    ds_write_b128 v160, v[0:3] offset:0
    v_lshlrev_b32 v224, 16, v4
    v_and_b32 v225, s61, v4
    v_lshlrev_b32 v226, 16, v5
    v_and_b32 v227, s61, v5
    v_lshlrev_b32 v228, 16, v6
    v_and_b32 v229, s61, v6
    v_lshlrev_b32 v230, 16, v7
    v_and_b32 v231, s61, v7
    v_pk_fma_f32 v[224:225], v[224:225], v[136:137], v[136:137] op_sel:[0,1,0] op_sel_hi:[1,1,0]
    v_pk_fma_f32 v[226:227], v[226:227], v[136:137], v[136:137] op_sel:[0,1,0] op_sel_hi:[1,1,0]
    v_pk_fma_f32 v[228:229], v[228:229], v[136:137], v[136:137] op_sel:[0,1,0] op_sel_hi:[1,1,0]
    v_pk_fma_f32 v[230:231], v[230:231], v[136:137], v[136:137] op_sel:[0,1,0] op_sel_hi:[1,1,0]
    v_cvt_pk_bf16_f32 v4, v224, v225
    v_cvt_pk_bf16_f32 v5, v226, v227
    v_cvt_pk_bf16_f32 v6, v228, v229
    v_cvt_pk_bf16_f32 v7, v230, v231
    ds_write_b128 v161, v[4:7] offset:0
    v_lshlrev_b32 v224, 16, v8
    v_and_b32 v225, s61, v8
    v_lshlrev_b32 v226, 16, v9
    v_and_b32 v227, s61, v9
    v_lshlrev_b32 v228, 16, v10
    v_and_b32 v229, s61, v10
    v_lshlrev_b32 v230, 16, v11
    v_and_b32 v231, s61, v11
    v_pk_fma_f32 v[224:225], v[224:225], v[136:137], v[136:137] op_sel:[0,1,0] op_sel_hi:[1,1,0]
    v_pk_fma_f32 v[226:227], v[226:227], v[136:137], v[136:137] op_sel:[0,1,0] op_sel_hi:[1,1,0]
    v_pk_fma_f32 v[228:229], v[228:229], v[136:137], v[136:137] op_sel:[0,1,0] op_sel_hi:[1,1,0]
    v_pk_fma_f32 v[230:231], v[230:231], v[136:137], v[136:137] op_sel:[0,1,0] op_sel_hi:[1,1,0]
    v_cvt_pk_bf16_f32 v8, v224, v225
    v_cvt_pk_bf16_f32 v9, v226, v227
    v_cvt_pk_bf16_f32 v10, v228, v229
    v_cvt_pk_bf16_f32 v11, v230, v231
    ds_write_b128 v162, v[8:11] offset:0
    v_lshlrev_b32 v224, 16, v12
    v_and_b32 v225, s61, v12
    v_lshlrev_b32 v226, 16, v13
    v_and_b32 v227, s61, v13
    v_lshlrev_b32 v228, 16, v14
    v_and_b32 v229, s61, v14
    v_lshlrev_b32 v230, 16, v15
    v_and_b32 v231, s61, v15
    v_pk_fma_f32 v[224:225], v[224:225], v[136:137], v[136:137] op_sel:[0,1,0] op_sel_hi:[1,1,0]
    v_pk_fma_f32 v[226:227], v[226:227], v[136:137], v[136:137] op_sel:[0,1,0] op_sel_hi:[1,1,0]
    v_pk_fma_f32 v[228:229], v[228:229], v[136:137], v[136:137] op_sel:[0,1,0] op_sel_hi:[1,1,0]
    v_pk_fma_f32 v[230:231], v[230:231], v[136:137], v[136:137] op_sel:[0,1,0] op_sel_hi:[1,1,0]
    v_cvt_pk_bf16_f32 v12, v224, v225
    v_cvt_pk_bf16_f32 v13, v226, v227
    v_cvt_pk_bf16_f32 v14, v228, v229
    v_cvt_pk_bf16_f32 v15, v230, v231
    ds_write_b128 v163, v[12:15] offset:0
    v_lshlrev_b32 v224, 16, v16
    v_and_b32 v225, s61, v16
    v_lshlrev_b32 v226, 16, v17
    v_and_b32 v227, s61, v17
    v_lshlrev_b32 v228, 16, v18
    v_and_b32 v229, s61, v18
    v_lshlrev_b32 v230, 16, v19
    v_and_b32 v231, s61, v19
    v_pk_fma_f32 v[224:225], v[224:225], v[136:137], v[136:137] op_sel:[0,1,0] op_sel_hi:[1,1,0]
    v_pk_fma_f32 v[226:227], v[226:227], v[136:137], v[136:137] op_sel:[0,1,0] op_sel_hi:[1,1,0]
    v_pk_fma_f32 v[228:229], v[228:229], v[136:137], v[136:137] op_sel:[0,1,0] op_sel_hi:[1,1,0]
    v_pk_fma_f32 v[230:231], v[230:231], v[136:137], v[136:137] op_sel:[0,1,0] op_sel_hi:[1,1,0]
    v_cvt_pk_bf16_f32 v16, v224, v225
    v_cvt_pk_bf16_f32 v17, v226, v227
    v_cvt_pk_bf16_f32 v18, v228, v229
    v_cvt_pk_bf16_f32 v19, v230, v231
    ds_write_b128 v160, v[16:19] offset:256
    v_lshlrev_b32 v224, 16, v20
    v_and_b32 v225, s61, v20
    v_lshlrev_b32 v226, 16, v21
    v_and_b32 v227, s61, v21
    v_lshlrev_b32 v228, 16, v22
    v_and_b32 v229, s61, v22
    v_lshlrev_b32 v230, 16, v23
    v_and_b32 v231, s61, v23
    v_pk_fma_f32 v[224:225], v[224:225], v[136:137], v[136:137] op_sel:[0,1,0] op_sel_hi:[1,1,0]
    v_pk_fma_f32 v[226:227], v[226:227], v[136:137], v[136:137] op_sel:[0,1,0] op_sel_hi:[1,1,0]
    v_pk_fma_f32 v[228:229], v[228:229], v[136:137], v[136:137] op_sel:[0,1,0] op_sel_hi:[1,1,0]
    v_pk_fma_f32 v[230:231], v[230:231], v[136:137], v[136:137] op_sel:[0,1,0] op_sel_hi:[1,1,0]
    v_cvt_pk_bf16_f32 v20, v224, v225
    v_cvt_pk_bf16_f32 v21, v226, v227
    v_cvt_pk_bf16_f32 v22, v228, v229
    v_cvt_pk_bf16_f32 v23, v230, v231
    ds_write_b128 v161, v[20:23] offset:256
    v_lshlrev_b32 v224, 16, v24
    v_and_b32 v225, s61, v24
    v_lshlrev_b32 v226, 16, v25
    v_and_b32 v227, s61, v25
    v_lshlrev_b32 v228, 16, v26
    v_and_b32 v229, s61, v26
    v_lshlrev_b32 v230, 16, v27
    v_and_b32 v231, s61, v27
    v_pk_fma_f32 v[224:225], v[224:225], v[136:137], v[136:137] op_sel:[0,1,0] op_sel_hi:[1,1,0]
    v_pk_fma_f32 v[226:227], v[226:227], v[136:137], v[136:137] op_sel:[0,1,0] op_sel_hi:[1,1,0]
    v_pk_fma_f32 v[228:229], v[228:229], v[136:137], v[136:137] op_sel:[0,1,0] op_sel_hi:[1,1,0]
    v_pk_fma_f32 v[230:231], v[230:231], v[136:137], v[136:137] op_sel:[0,1,0] op_sel_hi:[1,1,0]
    v_cvt_pk_bf16_f32 v24, v224, v225
    v_cvt_pk_bf16_f32 v25, v226, v227
    v_cvt_pk_bf16_f32 v26, v228, v229
    v_cvt_pk_bf16_f32 v27, v230, v231
    ds_write_b128 v162, v[24:27] offset:256
    v_lshlrev_b32 v224, 16, v28
    v_and_b32 v225, s61, v28
    v_lshlrev_b32 v226, 16, v29
    v_and_b32 v227, s61, v29
    v_lshlrev_b32 v228, 16, v30
    v_and_b32 v229, s61, v30
    v_lshlrev_b32 v230, 16, v31
    v_and_b32 v231, s61, v31
    v_pk_fma_f32 v[224:225], v[224:225], v[136:137], v[136:137] op_sel:[0,1,0] op_sel_hi:[1,1,0]
    v_pk_fma_f32 v[226:227], v[226:227], v[136:137], v[136:137] op_sel:[0,1,0] op_sel_hi:[1,1,0]
    v_pk_fma_f32 v[228:229], v[228:229], v[136:137], v[136:137] op_sel:[0,1,0] op_sel_hi:[1,1,0]
    v_pk_fma_f32 v[230:231], v[230:231], v[136:137], v[136:137] op_sel:[0,1,0] op_sel_hi:[1,1,0]
    v_cvt_pk_bf16_f32 v28, v224, v225
    v_cvt_pk_bf16_f32 v29, v226, v227
    v_cvt_pk_bf16_f32 v30, v228, v229
    v_cvt_pk_bf16_f32 v31, v230, v231
    ds_write_b128 v163, v[28:31] offset:256
    v_lshlrev_b32 v224, 16, v32
    v_and_b32 v225, s61, v32
    v_lshlrev_b32 v226, 16, v33
    v_and_b32 v227, s61, v33
    v_lshlrev_b32 v228, 16, v34
    v_and_b32 v229, s61, v34
    v_lshlrev_b32 v230, 16, v35
    v_and_b32 v231, s61, v35
    v_pk_fma_f32 v[224:225], v[224:225], v[136:137], v[136:137] op_sel:[0,1,0] op_sel_hi:[1,1,0]
    v_pk_fma_f32 v[226:227], v[226:227], v[136:137], v[136:137] op_sel:[0,1,0] op_sel_hi:[1,1,0]
    v_pk_fma_f32 v[228:229], v[228:229], v[136:137], v[136:137] op_sel:[0,1,0] op_sel_hi:[1,1,0]
    v_pk_fma_f32 v[230:231], v[230:231], v[136:137], v[136:137] op_sel:[0,1,0] op_sel_hi:[1,1,0]
    v_cvt_pk_bf16_f32 v32, v224, v225
    v_cvt_pk_bf16_f32 v33, v226, v227
    v_cvt_pk_bf16_f32 v34, v228, v229
    v_cvt_pk_bf16_f32 v35, v230, v231
    ds_write_b128 v160, v[32:35] offset:512
    v_lshlrev_b32 v224, 16, v36
    v_and_b32 v225, s61, v36
    v_lshlrev_b32 v226, 16, v37
    v_and_b32 v227, s61, v37
    v_lshlrev_b32 v228, 16, v38
    v_and_b32 v229, s61, v38
    v_lshlrev_b32 v230, 16, v39
    v_and_b32 v231, s61, v39
    v_pk_fma_f32 v[224:225], v[224:225], v[136:137], v[136:137] op_sel:[0,1,0] op_sel_hi:[1,1,0]
    v_pk_fma_f32 v[226:227], v[226:227], v[136:137], v[136:137] op_sel:[0,1,0] op_sel_hi:[1,1,0]
    v_pk_fma_f32 v[228:229], v[228:229], v[136:137], v[136:137] op_sel:[0,1,0] op_sel_hi:[1,1,0]
    v_pk_fma_f32 v[230:231], v[230:231], v[136:137], v[136:137] op_sel:[0,1,0] op_sel_hi:[1,1,0]
    v_cvt_pk_bf16_f32 v36, v224, v225
    v_cvt_pk_bf16_f32 v37, v226, v227
    v_cvt_pk_bf16_f32 v38, v228, v229
    v_cvt_pk_bf16_f32 v39, v230, v231
    ds_write_b128 v161, v[36:39] offset:512
    v_lshlrev_b32 v224, 16, v40
    v_and_b32 v225, s61, v40
    v_lshlrev_b32 v226, 16, v41
    v_and_b32 v227, s61, v41
    v_lshlrev_b32 v228, 16, v42
    v_and_b32 v229, s61, v42
    v_lshlrev_b32 v230, 16, v43
    v_and_b32 v231, s61, v43
    v_pk_fma_f32 v[224:225], v[224:225], v[136:137], v[136:137] op_sel:[0,1,0] op_sel_hi:[1,1,0]
    v_pk_fma_f32 v[226:227], v[226:227], v[136:137], v[136:137] op_sel:[0,1,0] op_sel_hi:[1,1,0]
    v_pk_fma_f32 v[228:229], v[228:229], v[136:137], v[136:137] op_sel:[0,1,0] op_sel_hi:[1,1,0]
    v_pk_fma_f32 v[230:231], v[230:231], v[136:137], v[136:137] op_sel:[0,1,0] op_sel_hi:[1,1,0]
    v_cvt_pk_bf16_f32 v40, v224, v225
    v_cvt_pk_bf16_f32 v41, v226, v227
    v_cvt_pk_bf16_f32 v42, v228, v229
    v_cvt_pk_bf16_f32 v43, v230, v231
    ds_write_b128 v162, v[40:43] offset:512
    v_lshlrev_b32 v224, 16, v44
    v_and_b32 v225, s61, v44
    v_lshlrev_b32 v226, 16, v45
    v_and_b32 v227, s61, v45
    v_lshlrev_b32 v228, 16, v46
    v_and_b32 v229, s61, v46
    v_lshlrev_b32 v230, 16, v47
    v_and_b32 v231, s61, v47
    v_pk_fma_f32 v[224:225], v[224:225], v[136:137], v[136:137] op_sel:[0,1,0] op_sel_hi:[1,1,0]
    v_pk_fma_f32 v[226:227], v[226:227], v[136:137], v[136:137] op_sel:[0,1,0] op_sel_hi:[1,1,0]
    v_pk_fma_f32 v[228:229], v[228:229], v[136:137], v[136:137] op_sel:[0,1,0] op_sel_hi:[1,1,0]
    v_pk_fma_f32 v[230:231], v[230:231], v[136:137], v[136:137] op_sel:[0,1,0] op_sel_hi:[1,1,0]
    v_cvt_pk_bf16_f32 v44, v224, v225
    v_cvt_pk_bf16_f32 v45, v226, v227
    v_cvt_pk_bf16_f32 v46, v228, v229
    v_cvt_pk_bf16_f32 v47, v230, v231
    ds_write_b128 v163, v[44:47] offset:512
    v_lshlrev_b32 v224, 16, v48
    v_and_b32 v225, s61, v48
    v_lshlrev_b32 v226, 16, v49
    v_and_b32 v227, s61, v49
    v_lshlrev_b32 v228, 16, v50
    v_and_b32 v229, s61, v50
    v_lshlrev_b32 v230, 16, v51
    v_and_b32 v231, s61, v51
    v_pk_fma_f32 v[224:225], v[224:225], v[136:137], v[136:137] op_sel:[0,1,0] op_sel_hi:[1,1,0]
    v_pk_fma_f32 v[226:227], v[226:227], v[136:137], v[136:137] op_sel:[0,1,0] op_sel_hi:[1,1,0]
    v_pk_fma_f32 v[228:229], v[228:229], v[136:137], v[136:137] op_sel:[0,1,0] op_sel_hi:[1,1,0]
    v_pk_fma_f32 v[230:231], v[230:231], v[136:137], v[136:137] op_sel:[0,1,0] op_sel_hi:[1,1,0]
    v_cvt_pk_bf16_f32 v48, v224, v225
    v_cvt_pk_bf16_f32 v49, v226, v227
    v_cvt_pk_bf16_f32 v50, v228, v229
    v_cvt_pk_bf16_f32 v51, v230, v231
    ds_write_b128 v160, v[48:51] offset:768
    v_lshlrev_b32 v224, 16, v52
    v_and_b32 v225, s61, v52
    v_lshlrev_b32 v226, 16, v53
    v_and_b32 v227, s61, v53
    v_lshlrev_b32 v228, 16, v54
    v_and_b32 v229, s61, v54
    v_lshlrev_b32 v230, 16, v55
    v_and_b32 v231, s61, v55
    v_pk_fma_f32 v[224:225], v[224:225], v[136:137], v[136:137] op_sel:[0,1,0] op_sel_hi:[1,1,0]
    v_pk_fma_f32 v[226:227], v[226:227], v[136:137], v[136:137] op_sel:[0,1,0] op_sel_hi:[1,1,0]
    v_pk_fma_f32 v[228:229], v[228:229], v[136:137], v[136:137] op_sel:[0,1,0] op_sel_hi:[1,1,0]
    v_pk_fma_f32 v[230:231], v[230:231], v[136:137], v[136:137] op_sel:[0,1,0] op_sel_hi:[1,1,0]
    v_cvt_pk_bf16_f32 v52, v224, v225
    v_cvt_pk_bf16_f32 v53, v226, v227
    v_cvt_pk_bf16_f32 v54, v228, v229
    v_cvt_pk_bf16_f32 v55, v230, v231
    ds_write_b128 v161, v[52:55] offset:768
    v_lshlrev_b32 v224, 16, v56
    v_and_b32 v225, s61, v56
    v_lshlrev_b32 v226, 16, v57
    v_and_b32 v227, s61, v57
    v_lshlrev_b32 v228, 16, v58
    v_and_b32 v229, s61, v58
    v_lshlrev_b32 v230, 16, v59
    v_and_b32 v231, s61, v59
    v_pk_fma_f32 v[224:225], v[224:225], v[136:137], v[136:137] op_sel:[0,1,0] op_sel_hi:[1,1,0]
    v_pk_fma_f32 v[226:227], v[226:227], v[136:137], v[136:137] op_sel:[0,1,0] op_sel_hi:[1,1,0]
    v_pk_fma_f32 v[228:229], v[228:229], v[136:137], v[136:137] op_sel:[0,1,0] op_sel_hi:[1,1,0]
    v_pk_fma_f32 v[230:231], v[230:231], v[136:137], v[136:137] op_sel:[0,1,0] op_sel_hi:[1,1,0]
    v_cvt_pk_bf16_f32 v56, v224, v225
    v_cvt_pk_bf16_f32 v57, v226, v227
    v_cvt_pk_bf16_f32 v58, v228, v229
    v_cvt_pk_bf16_f32 v59, v230, v231
    ds_write_b128 v162, v[56:59] offset:768
    v_lshlrev_b32 v224, 16, v60
    v_and_b32 v225, s61, v60
    v_lshlrev_b32 v226, 16, v61
    v_and_b32 v227, s61, v61
    v_lshlrev_b32 v228, 16, v62
    v_and_b32 v229, s61, v62
    v_lshlrev_b32 v230, 16, v63
    v_and_b32 v231, s61, v63
    v_pk_fma_f32 v[224:225], v[224:225], v[136:137], v[136:137] op_sel:[0,1,0] op_sel_hi:[1,1,0]
    v_pk_fma_f32 v[226:227], v[226:227], v[136:137], v[136:137] op_sel:[0,1,0] op_sel_hi:[1,1,0]
    v_pk_fma_f32 v[228:229], v[228:229], v[136:137], v[136:137] op_sel:[0,1,0] op_sel_hi:[1,1,0]
    v_pk_fma_f32 v[230:231], v[230:231], v[136:137], v[136:137] op_sel:[0,1,0] op_sel_hi:[1,1,0]
    v_cvt_pk_bf16_f32 v60, v224, v225
    v_cvt_pk_bf16_f32 v61, v226, v227
    v_cvt_pk_bf16_f32 v62, v228, v229
    v_cvt_pk_bf16_f32 v63, v230, v231
    ds_write_b128 v163, v[60:63] offset:768
    s_add_u32 s56, s47, 0x0
    s_add_u32 m0, s46, 0x0
    s_nop 0
    buffer_load_dwordx4 v252, s[8:11], s56 offen lds
    s_add_u32 s56, s47, 0x30000
    s_add_u32 m0, s46, 0x2000
    s_nop 0
    buffer_load_dwordx4 v252, s[8:11], s56 offen lds
    s_add_u32 s56, s47, 0x60000
    s_add_u32 m0, s46, 0x4000
    s_nop 0
    buffer_load_dwordx4 v252, s[8:11], s56 offen lds
    s_add_u32 s56, s47, 0x90000
    s_add_u32 m0, s46, 0x6000
    s_nop 0
    buffer_load_dwordx4 v252, s[8:11], s56 offen lds
    s_bfe_u32 s56, s2, 0x30003
    s_lshl_b32 s56, s56, 3
    s_add_u32 s56, s56, s40
    s_lshl_b32 s56, s56, 3
    v_and_b32 v236, 7, v233
    v_add_u32 v236, s56, v236
    v_lshrrev_b32 v237, 3, v233
    s_movk_i32 s56, 3072
    s_movk_i32 s57, 3584
    v_lshlrev_b32 v238, 10, v237
    v_mad_u32_u24 v238, v236, s56, v238
    v_lshlrev_b32 v239, 7, v237
    v_mad_u32_u24 v239, v236, s57, v239
    s_add_u32 s58, s47, 0
    s_add_u32 s59, s50, 0
    s_mov_b64 exec, 0xffff00
    buffer_load_dword v156, v238, s[8:11], s58 offen
    s_mov_b64 exec, 0xff
    buffer_load_dword v157, v239, s[12:15], s59 offen
    buffer_load_dword v158, v239, s[16:19], s59 offen
    s_mov_b64 exec, -1
    v_xor_b32 v165, 32, v164
    v_xor_b32 v166, 64, v164
    s_nop 0
    v_xor_b32 v167, 96, v164
    v_xor_b32 v168, 128, v164
    v_xor_b32 v169, 160, v164
    v_xor_b32 v170, 192, v164
    v_xor_b32 v171, 224, v164
    s_waitcnt lgkmcnt(0)
    s_barrier
    ds_read_b128 v[0:3], v164 offset:0
    ds_read_b128 v[4:7], v165 offset:0
    ds_read_b128 v[8:11], v166 offset:0
    ds_read_b128 v[12:15], v167 offset:0
    ds_read_b128 v[16:19], v168 offset:0
    ds_read_b128 v[20:23], v169 offset:0
    ds_read_b128 v[24:27], v170 offset:0
    ds_read_b128 v[28:31], v171 offset:0
    ds_read_b128 v[32:35], v164 offset:256
    ds_read_b128 v[36:39], v165 offset:256
    ds_read_b128 v[40:43], v166 offset:256
    ds_read_b128 v[44:47], v167 offset:256
    ds_read_b128 v[48:51], v168 offset:256
    ds_read_b128 v[52:55], v169 offset:256
    ds_read_b128 v[56:59], v170 offset:256
    ds_read_b128 v[60:63], v171 offset:256
    ds_read_b128 v[64:67], v164 offset:512
    ds_read_b128 v[68:71], v165 offset:512
    ds_read_b128 v[72:75], v166 offset:512
    ds_read_b128 v[76:79], v167 offset:512
    ds_read_b128 v[80:83], v168 offset:512
    ds_read_b128 v[84:87], v169 offset:512
    ds_read_b128 v[88:91], v170 offset:512
    ds_read_b128 v[92:95], v171 offset:512
    ds_read_b128 v[96:99], v164 offset:768
    ds_read_b128 v[100:103], v165 offset:768
    ds_read_b128 v[104:107], v166 offset:768
    ds_read_b128 v[108:111], v167 offset:768
    ds_read_b128 v[112:115], v168 offset:768
    ds_read_b128 v[116:119], v169 offset:768
    ds_read_b128 v[120:123], v170 offset:768
    ds_read_b128 v[124:127], v171 offset:768
    s_waitcnt lgkmcnt(0)
    s_waitcnt vmcnt(3)
    s_barrier
    s_add_u32 s56, s47, 0xc0000
    s_add_u32 m0, s46, 0x8000
    s_nop 0
    buffer_load_dwordx4 v252, s[8:11], s56 offen lds
    s_add_u32 s56, s47, 0xf0000
    s_add_u32 m0, s46, 0xa000
    s_nop 0
    buffer_load_dwordx4 v252, s[8:11], s56 offen lds
    s_add_u32 s56, s47, 0x120000
    s_add_u32 m0, s46, 0xc000
    s_nop 0
    buffer_load_dwordx4 v252, s[8:11], s56 offen lds
    s_add_u32 s56, s47, 0x150000
    s_add_u32 m0, s46, 0xe000
    s_nop 0
    s_nop 0
    buffer_load_dwordx4 v252, s[8:11], s56 offen lds
    s_mov_b32 s63, 0xbdd2d3e8
    v_mov_b32 v246, 0xc0135761
    ds_read_b64_tr_b16 v[192:193], v243 offset:0
    ds_read_b64_tr_b16 v[194:195], v243 offset:512
    ds_read_b64_tr_b16 v[196:197], v243 offset:2048
    ds_read_b64_tr_b16 v[198:199], v243 offset:2560
    ds_read_b64_tr_b16 v[200:201], v243 offset:4096
    ds_read_b64_tr_b16 v[202:203], v243 offset:4608
    ds_read_b64_tr_b16 v[204:205], v243 offset:6144
    ds_read_b64_tr_b16 v[206:207], v243 offset:6656
    ds_read_b64_tr_b16 v[208:209], v243 offset:8192
    ds_read_b64_tr_b16 v[210:211], v243 offset:8704
    ds_read_b64_tr_b16 v[212:213], v243 offset:10240
    ds_read_b64_tr_b16 v[214:215], v243 offset:10752
    ds_read_b64_tr_b16 v[216:217], v243 offset:12288
    ds_read_b64_tr_b16 v[218:219], v243 offset:12800
    s_waitcnt lgkmcnt(12)
    v_mfma_f32_32x32x16_bf16 v[128:143], v[192:195], v[0:3], 0
    s_cmp_lt_u32 s40, 4
    s_cbranch_scc1 L_pr_55
    s_setprio 1
L_pr_55:
    ds_read_b64_tr_b16 v[220:221], v243 offset:14336
    ds_read_b64_tr_b16 v[222:223], v243 offset:14848
    s_waitcnt lgkmcnt(12)
    v_mfma_f32_32x32x16_bf16 v[128:143], v[196:199], v[4:7], v[128:143]
    s_add_u32 s56, s48, 0x0
    s_add_u32 m0, s46, 0x10000
    s_nop 0
    buffer_load_dwordx4 v252, s[8:11], s56 offen lds
    ds_read_b64_tr_b16 v[192:193], v243 offset:16384
    ds_read_b64_tr_b16 v[194:195], v243 offset:16896
    s_waitcnt lgkmcnt(12)
    v_mfma_f32_32x32x16_bf16 v[128:143], v[200:203], v[8:11], v[128:143]
    ds_read_b64_tr_b16 v[196:197], v243 offset:18432
    ds_read_b64_tr_b16 v[198:199], v243 offset:18944
    s_waitcnt lgkmcnt(12)
    v_mfma_f32_32x32x16_bf16 v[128:143], v[204:207], v[12:15], v[128:143]
    s_add_u32 s56, s48, 0x30000
    s_add_u32 m0, s46, 0x12000
    s_nop 0
    buffer_load_dwordx4 v252, s[8:11], s56 offen lds
    ds_read_b64_tr_b16 v[200:201], v243 offset:20480
    ds_read_b64_tr_b16 v[202:203], v243 offset:20992
    s_waitcnt lgkmcnt(12)
    v_mfma_f32_32x32x16_bf16 v[128:143], v[208:211], v[16:19], v[128:143]
    ds_read_b64_tr_b16 v[204:205], v243 offset:22528
    ds_read_b64_tr_b16 v[206:207], v243 offset:23040
    s_waitcnt lgkmcnt(12)
    v_mfma_f32_32x32x16_bf16 v[128:143], v[212:215], v[20:23], v[128:143]
    s_add_u32 s56, s48, 0x60000
    s_add_u32 m0, s46, 0x14000
    s_nop 0
    buffer_load_dwordx4 v252, s[8:11], s56 offen lds
    ds_read_b64_tr_b16 v[208:209], v243 offset:24576
    ds_read_b64_tr_b16 v[210:211], v243 offset:25088
    s_waitcnt lgkmcnt(12)
    v_mfma_f32_32x32x16_bf16 v[128:143], v[216:219], v[24:27], v[128:143]
    ds_read_b64_tr_b16 v[212:213], v243 offset:26624
    ds_read_b64_tr_b16 v[214:215], v243 offset:27136
    s_waitcnt lgkmcnt(12)
    v_mfma_f32_32x32x16_bf16 v[128:143], v[220:223], v[28:31], v[128:143]
    s_add_u32 s56, s48, 0x90000
    s_add_u32 m0, s46, 0x16000
    s_nop 0
    buffer_load_dwordx4 v252, s[8:11], s56 offen lds
    ds_read_b64_tr_b16 v[216:217], v243 offset:28672
    ds_read_b64_tr_b16 v[218:219], v243 offset:29184
    s_waitcnt lgkmcnt(12)
    v_mfma_f32_32x32x16_bf16 v[128:143], v[192:195], v[32:35], v[128:143]
    s_cmp_lt_u32 s40, 4
    s_cbranch_scc1 L_pr_56
    s_setprio 0
L_pr_56:
    ds_read_b64_tr_b16 v[220:221], v243 offset:30720
    ds_read_b64_tr_b16 v[222:223], v243 offset:31232
    s_waitcnt lgkmcnt(12)
    v_mfma_f32_32x32x16_bf16 v[128:143], v[196:199], v[36:39], v[128:143]
    s_add_u32 s56, s48, 0xc0000
    s_add_u32 m0, s46, 0x18000
    s_nop 0
    buffer_load_dwordx4 v252, s[8:11], s56 offen lds
    s_waitcnt vmcnt(5)
    s_barrier
    ds_read_b64_tr_b16 v[192:193], v243 offset:32768
    ds_read_b64_tr_b16 v[194:195], v243 offset:33280
    s_waitcnt lgkmcnt(12)
    v_mfma_f32_32x32x16_bf16 v[128:143], v[200:203], v[40:43], v[128:143]
    ds_read_b64_tr_b16 v[196:197], v243 offset:34816
    ds_read_b64_tr_b16 v[198:199], v243 offset:35328
    s_waitcnt lgkmcnt(12)
    v_mfma_f32_32x32x16_bf16 v[128:143], v[204:207], v[44:47], v[128:143]
    s_add_u32 s56, s48, 0xf0000
    s_add_u32 m0, s46, 0x1a000
    s_nop 0
    buffer_load_dwordx4 v252, s[8:11], s56 offen lds
    ds_read_b64_tr_b16 v[200:201], v243 offset:36864
    ds_read_b64_tr_b16 v[202:203], v243 offset:37376
    s_waitcnt lgkmcnt(12)
    v_mfma_f32_32x32x16_bf16 v[128:143], v[208:211], v[48:51], v[128:143]
    ds_read_b64_tr_b16 v[204:205], v243 offset:38912
    ds_read_b64_tr_b16 v[206:207], v243 offset:39424
    s_waitcnt lgkmcnt(12)
    v_mfma_f32_32x32x16_bf16 v[128:143], v[212:215], v[52:55], v[128:143]
    s_add_u32 s56, s48, 0x120000
    s_add_u32 m0, s46, 0x1c000
    s_nop 0
    buffer_load_dwordx4 v252, s[8:11], s56 offen lds
    ds_read_b64_tr_b16 v[208:209], v243 offset:40960
    ds_read_b64_tr_b16 v[210:211], v243 offset:41472
    s_waitcnt lgkmcnt(12)
    v_mfma_f32_32x32x16_bf16 v[128:143], v[216:219], v[56:59], v[128:143]
    ds_read_b64_tr_b16 v[212:213], v243 offset:43008
    ds_read_b64_tr_b16 v[214:215], v243 offset:43520
    s_waitcnt lgkmcnt(12)
    v_mfma_f32_32x32x16_bf16 v[128:143], v[220:223], v[60:63], v[128:143]
    s_add_u32 s56, s48, 0x150000
    s_add_u32 m0, s46, 0x1e000
    s_nop 0
    buffer_load_dwordx4 v252, s[8:11], s56 offen lds
    s_waitcnt vmcnt(4)
    s_barrier
    ds_read_b64_tr_b16 v[216:217], v243 offset:45056
    ds_read_b64_tr_b16 v[218:219], v243 offset:45568
    s_waitcnt lgkmcnt(12)
    v_mfma_f32_32x32x16_bf16 v[128:143], v[192:195], v[64:67], v[128:143]
    s_cmp_lt_u32 s40, 4
    s_cbranch_scc1 L_pr_57
    s_setprio 1
L_pr_57:
    ds_read_b64_tr_b16 v[220:221], v243 offset:47104
    ds_read_b64_tr_b16 v[222:223], v243 offset:47616
    s_waitcnt lgkmcnt(12)
    v_mfma_f32_32x32x16_bf16 v[128:143], v[196:199], v[68:71], v[128:143]
    s_add_u32 s56, s49, 0x0
    s_add_u32 m0, s46, 0x20000
    s_nop 0
    buffer_load_dwordx4 v252, s[8:11], s56 offen lds
    ds_read_b64_tr_b16 v[192:193], v243 offset:49152
    ds_read_b64_tr_b16 v[194:195], v243 offset:49664
    s_waitcnt lgkmcnt(12)
    v_mfma_f32_32x32x16_bf16 v[128:143], v[200:203], v[72:75], v[128:143]
    ds_read_b64_tr_b16 v[196:197], v243 offset:51200
    ds_read_b64_tr_b16 v[198:199], v243 offset:51712
    s_waitcnt lgkmcnt(12)
    v_mfma_f32_32x32x16_bf16 v[128:143], v[204:207], v[76:79], v[128:143]
    s_add_u32 s56, s49, 0x30000
    s_add_u32 m0, s46, 0x22000
    s_nop 0
    buffer_load_dwordx4 v252, s[8:11], s56 offen lds
    ds_read_b64_tr_b16 v[200:201], v243 offset:53248
    ds_read_b64_tr_b16 v[202:203], v243 offset:53760
    s_waitcnt lgkmcnt(12)
    v_mfma_f32_32x32x16_bf16 v[128:143], v[208:211], v[80:83], v[128:143]
    ds_read_b64_tr_b16 v[204:205], v243 offset:55296
    ds_read_b64_tr_b16 v[206:207], v243 offset:55808
    s_waitcnt lgkmcnt(12)
    v_mfma_f32_32x32x16_bf16 v[128:143], v[212:215], v[84:87], v[128:143]
    s_add_u32 s56, s49, 0x60000
    s_add_u32 m0, s46, 0x24000
    s_nop 0
    buffer_load_dwordx4 v252, s[8:11], s56 offen lds
    ds_read_b64_tr_b16 v[208:209], v243 offset:57344
    ds_read_b64_tr_b16 v[210:211], v243 offset:57856
    s_waitcnt lgkmcnt(12)
    v_mfma_f32_32x32x16_bf16 v[128:143], v[216:219], v[88:91], v[128:143]
    ds_read_b64_tr_b16 v[212:213], v243 offset:59392
    ds_read_b64_tr_b16 v[214:215], v243 offset:59904
    s_waitcnt lgkmcnt(12)
    v_mfma_f32_32x32x16_bf16 v[128:143], v[220:223], v[92:95], v[128:143]
    s_add_u32 s56, s49, 0x90000
    s_add_u32 m0, s46, 0x26000
    s_nop 0
    buffer_load_dwordx4 v252, s[8:11], s56 offen lds
    ds_read_b64_tr_b16 v[216:217], v243 offset:61440
    ds_read_b64_tr_b16 v[218:219], v243 offset:61952
    s_waitcnt lgkmcnt(12)
    v_mfma_f32_32x32x16_bf16 v[128:143], v[192:195], v[96:99], v[128:143]
    s_cmp_lt_u32 s40, 4
    s_cbranch_scc1 L_pr_58
    s_setprio 0
L_pr_58:
    ds_read_b64_tr_b16 v[220:221], v243 offset:63488
    ds_read_b64_tr_b16 v[222:223], v243 offset:64000
    s_waitcnt lgkmcnt(12)
    v_mfma_f32_32x32x16_bf16 v[128:143], v[196:199], v[100:103], v[128:143]
    s_add_u32 s56, s49, 0xc0000
    s_add_u32 m0, s46, 0x0
    s_nop 0
    buffer_load_dwordx4 v252, s[8:11], s56 offen lds
    ds_read_b64_tr_b16 v[192:193], v244 offset:0
    ds_read_b64_tr_b16 v[194:195], v244 offset:512
    s_waitcnt lgkmcnt(12)
    v_mfma_f32_32x32x16_bf16 v[128:143], v[200:203], v[104:107], v[128:143]
    ds_read_b64_tr_b16 v[196:197], v244 offset:2048
    ds_read_b64_tr_b16 v[198:199], v244 offset:2560
    s_waitcnt lgkmcnt(12)
    v_mfma_f32_32x32x16_bf16 v[128:143], v[204:207], v[108:111], v[128:143]
    s_add_u32 s56, s49, 0xf0000
    s_add_u32 m0, s46, 0x2000
    s_nop 0
    buffer_load_dwordx4 v252, s[8:11], s56 offen lds
    ds_read_b64_tr_b16 v[200:201], v244 offset:4096
    ds_read_b64_tr_b16 v[202:203], v244 offset:4608
    s_waitcnt lgkmcnt(12)
    v_mfma_f32_32x32x16_bf16 v[128:143], v[208:211], v[112:115], v[128:143]
    ds_read_b64_tr_b16 v[204:205], v244 offset:6144
    ds_read_b64_tr_b16 v[206:207], v244 offset:6656
    s_waitcnt lgkmcnt(12)
    v_mfma_f32_32x32x16_bf16 v[128:143], v[212:215], v[116:119], v[128:143]
    s_add_u32 s56, s49, 0x120000
    s_add_u32 m0, s46, 0x4000
    s_nop 0
    buffer_load_dwordx4 v252, s[8:11], s56 offen lds
    ds_read_b64_tr_b16 v[208:209], v244 offset:8192
    ds_read_b64_tr_b16 v[210:211], v244 offset:8704
    s_waitcnt lgkmcnt(12)
    v_mfma_f32_32x32x16_bf16 v[128:143], v[216:219], v[120:123], v[128:143]
    ds_read_b64_tr_b16 v[212:213], v244 offset:10240
    ds_read_b64_tr_b16 v[214:215], v244 offset:10752
    s_waitcnt lgkmcnt(12)
    v_mfma_f32_32x32x16_bf16 v[128:143], v[220:223], v[124:127], v[128:143]
    s_add_u32 s56, s49, 0x150000
    s_add_u32 m0, s46, 0x6000
    s_nop 0
    buffer_load_dwordx4 v252, s[8:11], s56 offen lds
    s_waitcnt vmcnt(8)
    s_barrier
    ds_read_b64_tr_b16 v[216:217], v244 offset:12288
    ds_read_b64_tr_b16 v[218:219], v244 offset:12800
    s_waitcnt lgkmcnt(12)
    v_mfma_f32_32x32x16_bf16 v[160:175], v[192:195], v[0:3], 0
    s_cmp_lt_u32 s40, 4
    s_cbranch_scc1 L_pr_59
    s_setprio 1
L_pr_59:
    ds_read_b64_tr_b16 v[220:221], v244 offset:14336
    ds_read_b64_tr_b16 v[222:223], v244 offset:14848
    s_waitcnt lgkmcnt(12)
    v_mfma_f32_32x32x16_bf16 v[160:175], v[196:199], v[4:7], v[160:175]
    s_add_u32 s56, s50, 0x0
    s_add_u32 m0, s46, 0x8000
    s_nop 0
    buffer_load_dwordx4 v253, s[12:15], s56 offen lds
    ds_read_b64_tr_b16 v[192:193], v244 offset:16384
    ds_read_b64_tr_b16 v[194:195], v244 offset:16896
    s_waitcnt lgkmcnt(12)
    v_mfma_f32_32x32x16_bf16 v[160:175], v[200:203], v[8:11], v[160:175]
    v_mul_f32 v128, s64, v128
    v_mul_f32 v129, s64, v129
    v_mul_f32 v130, s64, v130
    v_mul_f32 v131, s64, v131
    ds_read_b64_tr_b16 v[196:197], v244 offset:18432
    ds_read_b64_tr_b16 v[198:199], v244 offset:18944
    s_waitcnt lgkmcnt(12)
    v_mfma_f32_32x32x16_bf16 v[160:175], v[204:207], v[12:15], v[160:175]
    v_mul_f32 v132, s64, v132
    v_mul_f32 v133, s64, v133
    v_mul_f32 v134, s64, v134
    v_mul_f32 v135, s64, v135
    ds_read_b64_tr_b16 v[200:201], v244 offset:20480
    ds_read_b64_tr_b16 v[202:203], v244 offset:20992
    s_waitcnt lgkmcnt(12)
    v_mfma_f32_32x32x16_bf16 v[160:175], v[208:211], v[16:19], v[160:175]
    v_mul_f32 v136, s64, v136
    v_mul_f32 v137, s64, v137
    v_mul_f32 v138, s64, v138
    v_mul_f32 v139, s64, v139
    ds_read_b64_tr_b16 v[204:205], v244 offset:22528
    ds_read_b64_tr_b16 v[206:207], v244 offset:23040
    s_waitcnt lgkmcnt(12)
    v_mfma_f32_32x32x16_bf16 v[160:175], v[212:215], v[20:23], v[160:175]
    s_add_u32 s56, s50, 0x0
    s_add_u32 m0, s46, 0xc000
    s_nop 0
    buffer_load_dwordx4 v253, s[16:19], s56 offen lds
    v_mul_f32 v140, s64, v140
    v_mul_f32 v141, s64, v141
    v_mul_f32 v142, s64, v142
    v_mul_f32 v143, s64, v143
    ds_read_b64_tr_b16 v[208:209], v244 offset:24576
    ds_read_b64_tr_b16 v[210:211], v244 offset:25088
    s_waitcnt lgkmcnt(12)
    s_nop 0
    v_mfma_f32_32x32x16_bf16 v[160:175], v[216:219], v[24:27], v[160:175]
    v_cvt_pk_bf16_f32 v224, v128, v129
    v_cvt_pk_bf16_f32 v225, v130, v131
    v_cvt_pk_bf16_f32 v226, v132, v133
    v_cvt_pk_bf16_f32 v227, v134, v135
    ds_read_b64_tr_b16 v[212:213], v244 offset:26624
    ds_read_b64_tr_b16 v[214:215], v244 offset:27136
    s_waitcnt lgkmcnt(12)
    s_nop 0
    v_mfma_f32_32x32x16_bf16 v[160:175], v[220:223], v[28:31], v[160:175]
    buffer_store_dwordx4 v[224:227], v250, s[32:35], s51 offen sc1
    v_cvt_pk_bf16_f32 v228, v136, v137
    v_cvt_pk_bf16_f32 v229, v138, v139
    v_cvt_pk_bf16_f32 v230, v140, v141
    ds_read_b64_tr_b16 v[216:217], v244 offset:28672
    ds_read_b64_tr_b16 v[218:219], v244 offset:29184
    s_waitcnt lgkmcnt(12)
    v_mfma_f32_32x32x16_bf16 v[160:175], v[192:195], v[32:35], v[160:175]
    s_cmp_lt_u32 s40, 4
    s_cbranch_scc1 L_pr_60
    s_setprio 0
L_pr_60:
    v_cvt_pk_bf16_f32 v231, v142, v143
    s_add_u32 s57, s51, 0x10000
    buffer_store_dwordx4 v[228:231], v250, s[32:35], s57 offen sc1
    ds_read_b64_tr_b16 v[220:221], v244 offset:30720
    ds_read_b64_tr_b16 v[222:223], v244 offset:31232
    s_waitcnt lgkmcnt(12)
    v_mfma_f32_32x32x16_bf16 v[160:175], v[196:199], v[36:39], v[160:175]
    s_add_u32 s56, s50, 0x38000
    s_add_u32 m0, s46, 0xa000
    s_nop 0
    buffer_load_dwordx4 v253, s[12:15], s56 offen lds
    ds_read_b64_tr_b16 v[192:193], v244 offset:32768
    ds_read_b64_tr_b16 v[194:195], v244 offset:33280
    s_waitcnt lgkmcnt(12)
    v_mfma_f32_32x32x16_bf16 v[160:175], v[200:203], v[40:43], v[160:175]
    ds_read_b64_tr_b16 v[196:197], v244 offset:34816
    ds_read_b64_tr_b16 v[198:199], v244 offset:35328
    s_waitcnt lgkmcnt(12)
    v_mfma_f32_32x32x16_bf16 v[160:175], v[204:207], v[44:47], v[160:175]
    ds_read_b64_tr_b16 v[200:201], v244 offset:36864
    ds_read_b64_tr_b16 v[202:203], v244 offset:37376
    s_waitcnt lgkmcnt(12)
    v_mfma_f32_32x32x16_bf16 v[160:175], v[208:211], v[48:51], v[160:175]
    ds_read_b64_tr_b16 v[204:205], v244 offset:38912
    ds_read_b64_tr_b16 v[206:207], v244 offset:39424
    s_waitcnt lgkmcnt(12)
    v_mfma_f32_32x32x16_bf16 v[160:175], v[212:215], v[52:55], v[160:175]
    s_add_u32 s56, s50, 0x38000
    s_add_u32 m0, s46, 0xe000
    s_nop 0
    buffer_load_dwordx4 v253, s[16:19], s56 offen lds
    ds_read_b64_tr_b16 v[208:209], v244 offset:40960
    ds_read_b64_tr_b16 v[210:211], v244 offset:41472
    s_waitcnt lgkmcnt(12)
    v_mfma_f32_32x32x16_bf16 v[160:175], v[216:219], v[56:59], v[160:175]
    ds_read_b64_tr_b16 v[212:213], v244 offset:43008
    ds_read_b64_tr_b16 v[214:215], v244 offset:43520
    s_waitcnt lgkmcnt(12)
    v_mfma_f32_32x32x16_bf16 v[160:175], v[220:223], v[60:63], v[160:175]
    s_waitcnt vmcnt(10)
    s_barrier
    v_lshlrev_b32 v254, 3, v250
    s_lshl_b32 s58, s2, 3
    s_add_u32 s58, s58, s40
    s_mul_i32 s59, s58, 896
    s_mov_b64 exec, 0x7f
    buffer_load_dword v255, v254, s[20:23], s59 offen
    s_lshl_b32 s59, s58, 8
    s_mov_b64 exec, 3
    buffer_load_dword v255, v254, s[24:27], s59 offen
    s_mov_b64 exec, -1
    ds_read_b64_tr_b16 v[216:217], v244 offset:45056
    ds_read_b64_tr_b16 v[218:219], v244 offset:45568
    s_waitcnt lgkmcnt(12)
    v_mfma_f32_32x32x16_bf16 v[160:175], v[192:195], v[64:67], v[160:175]
    s_cmp_lt_u32 s40, 4
    s_cbranch_scc1 L_pr_61
    s_setprio 1
L_pr_61:
    ds_read_b64_tr_b16 v[220:221], v244 offset:47104
    ds_read_b64_tr_b16 v[222:223], v244 offset:47616
    s_waitcnt lgkmcnt(12)
    v_mfma_f32_32x32x16_bf16 v[160:175], v[196:199], v[68:71], v[160:175]
    s_add_u32 s56, s50, 0x70000
    s_add_u32 m0, s46, 0x10000
    s_nop 0
    buffer_load_dwordx4 v253, s[12:15], s56 offen lds
    ds_read_b64_tr_b16 v[192:193], v244 offset:49152
    ds_read_b64_tr_b16 v[194:195], v244 offset:49664
    s_waitcnt lgkmcnt(12)
    v_mfma_f32_32x32x16_bf16 v[160:175], v[200:203], v[72:75], v[160:175]
    ds_read_b64_tr_b16 v[196:197], v244 offset:51200
    ds_read_b64_tr_b16 v[198:199], v244 offset:51712
    s_waitcnt lgkmcnt(12)
    v_mfma_f32_32x32x16_bf16 v[160:175], v[204:207], v[76:79], v[160:175]
    ds_read_b64_tr_b16 v[200:201], v244 offset:53248
    ds_read_b64_tr_b16 v[202:203], v244 offset:53760
    s_waitcnt lgkmcnt(12)
    v_mfma_f32_32x32x16_bf16 v[160:175], v[208:211], v[80:83], v[160:175]
    ds_read_b64_tr_b16 v[204:205], v244 offset:55296
    ds_read_b64_tr_b16 v[206:207], v244 offset:55808
    s_waitcnt lgkmcnt(12)
    v_mfma_f32_32x32x16_bf16 v[160:175], v[212:215], v[84:87], v[160:175]
    s_add_u32 s56, s50, 0x70000
    s_add_u32 m0, s46, 0x14000
    s_nop 0
    buffer_load_dwordx4 v253, s[16:19], s56 offen lds
    ds_read_b64_tr_b16 v[208:209], v244 offset:57344
    ds_read_b64_tr_b16 v[210:211], v244 offset:57856
    s_waitcnt lgkmcnt(12)
    v_mfma_f32_32x32x16_bf16 v[160:175], v[216:219], v[88:91], v[160:175]
    ds_read_b64_tr_b16 v[212:213], v244 offset:59392
    ds_read_b64_tr_b16 v[214:215], v244 offset:59904
    s_waitcnt lgkmcnt(12)
    v_mfma_f32_32x32x16_bf16 v[160:175], v[220:223], v[92:95], v[160:175]
    ds_read_b64_tr_b16 v[216:217], v244 offset:61440
    ds_read_b64_tr_b16 v[218:219], v244 offset:61952
    s_waitcnt lgkmcnt(12)
    v_mfma_f32_32x32x16_bf16 v[160:175], v[192:195], v[96:99], v[160:175]
    s_cmp_lt_u32 s40, 4
    s_cbranch_scc1 L_pr_62
    s_setprio 0
L_pr_62:
    ds_read_b64_tr_b16 v[220:221], v244 offset:63488
    ds_read_b64_tr_b16 v[222:223], v244 offset:64000
    s_waitcnt lgkmcnt(12)
    v_mfma_f32_32x32x16_bf16 v[160:175], v[196:199], v[100:103], v[160:175]
    s_add_u32 s56, s50, 0xa8000
    s_add_u32 m0, s46, 0x12000
    s_nop 0
    buffer_load_dwordx4 v253, s[12:15], s56 offen lds
    ds_read_b64_tr_b16 v[192:193], v245 offset:0
    ds_read_b64_tr_b16 v[194:195], v245 offset:512
    s_waitcnt lgkmcnt(12)
    v_mfma_f32_32x32x16_bf16 v[160:175], v[200:203], v[104:107], v[160:175]
    ds_read_b64_tr_b16 v[196:197], v245 offset:2048
    ds_read_b64_tr_b16 v[198:199], v245 offset:2560
    s_waitcnt lgkmcnt(12)
    v_mfma_f32_32x32x16_bf16 v[160:175], v[204:207], v[108:111], v[160:175]
    ds_read_b64_tr_b16 v[200:201], v245 offset:4096
    ds_read_b64_tr_b16 v[202:203], v245 offset:4608
    s_waitcnt lgkmcnt(12)
    v_mfma_f32_32x32x16_bf16 v[160:175], v[208:211], v[112:115], v[160:175]
    ds_read_b64_tr_b16 v[204:205], v245 offset:6144
    ds_read_b64_tr_b16 v[206:207], v245 offset:6656
    s_waitcnt lgkmcnt(12)
    v_mfma_f32_32x32x16_bf16 v[160:175], v[212:215], v[116:119], v[160:175]
    s_add_u32 s56, s50, 0xa8000
    s_add_u32 m0, s46, 0x16000
    s_nop 0
    buffer_load_dwordx4 v253, s[16:19], s56 offen lds
    ds_read_b64_tr_b16 v[208:209], v245 offset:8192
    ds_read_b64_tr_b16 v[210:211], v245 offset:8704
    s_waitcnt lgkmcnt(12)
    v_mfma_f32_32x32x16_bf16 v[160:175], v[216:219], v[120:123], v[160:175]
    ds_read_b64_tr_b16 v[212:213], v245 offset:10240
    ds_read_b64_tr_b16 v[214:215], v245 offset:10752
    s_waitcnt lgkmcnt(12)
    v_mfma_f32_32x32x16_bf16 v[160:175], v[220:223], v[124:127], v[160:175]
    s_waitcnt vmcnt(12)
    s_mov_b32 s55, 0
    s_nop 9
L_epr_63:
    v_readfirstlane_b32 s94, v247
    s_nop 0
    s_cmp_lg_u32 s94, 0
    s_nop 2
    s_cbranch_scc1 L_epd_64
    s_sleep 4
    buffer_load_dword v247, off, s[36:39], 0 sc0 sc1
    s_waitcnt vmcnt(0)
    s_add_u32 s55, s55, 1
    s_cmp_lt_u32 s55, 0x100000
    s_cbranch_scc1 L_epr_63
L_epd_64:
    s_barrier
    ds_read_b64_tr_b16 v[216:217], v245 offset:12288
    ds_read_b64_tr_b16 v[218:219], v245 offset:12800
    s_waitcnt lgkmcnt(12)
    v_mfma_f32_32x32x16_bf16 v[128:143], v[0:3], v[192:195], 0
    s_cmp_lt_u32 s40, 4
    s_cbranch_scc1 L_pr_65
    s_setprio 1
L_pr_65:
    ds_read_b64_tr_b16 v[220:221], v245 offset:14336
    ds_read_b64_tr_b16 v[222:223], v245 offset:14848
    s_waitcnt lgkmcnt(12)
    v_mfma_f32_32x32x16_bf16 v[128:143], v[4:7], v[196:199], v[128:143]
    s_add_u32 s56, s50, 0xe0000
    s_add_u32 m0, s46, 0x18000
    s_nop 0
    buffer_load_dwordx4 v253, s[12:15], s56 offen lds
    ds_read_b64_tr_b16 v[192:193], v245 offset:16384
    ds_read_b64_tr_b16 v[194:195], v245 offset:16896
    s_waitcnt lgkmcnt(12)
    s_nop 0
    v_mfma_f32_32x32x16_bf16 v[128:143], v[8:11], v[200:203], v[128:143]
    v_cvt_pk_bf16_f32 v224, v160, v161
    v_cvt_pk_bf16_f32 v225, v162, v163
    v_cvt_pk_bf16_f32 v226, v164, v165
    v_cvt_pk_bf16_f32 v227, v166, v167
    ds_read_b64_tr_b16 v[196:197], v245 offset:18432
    ds_read_b64_tr_b16 v[198:199], v245 offset:18944
    s_waitcnt lgkmcnt(12)
    s_nop 0
    v_mfma_f32_32x32x16_bf16 v[128:143], v[12:15], v[204:207], v[128:143]
    buffer_store_dwordx4 v[224:227], v250, s[32:35], s52 offen sc1
    v_cvt_pk_bf16_f32 v228, v168, v169
    v_cvt_pk_bf16_f32 v229, v170, v171
    v_cvt_pk_bf16_f32 v230, v172, v173
    ds_read_b64_tr_b16 v[200:201], v245 offset:20480
    ds_read_b64_tr_b16 v[202:203], v245 offset:20992
    s_waitcnt lgkmcnt(12)
    s_nop 0
    v_mfma_f32_32x32x16_bf16 v[128:143], v[16:19], v[208:211], v[128:143]
    v_cvt_pk_bf16_f32 v231, v174, v175
    s_add_u32 s57, s52, 0x10000
    buffer_store_dwordx4 v[228:231], v250, s[32:35], s57 offen sc1
    ds_read_b64_tr_b16 v[204:205], v245 offset:22528
    ds_read_b64_tr_b16 v[206:207], v245 offset:23040
    s_waitcnt lgkmcnt(12)
    v_mfma_f32_32x32x16_bf16 v[128:143], v[20:23], v[212:215], v[128:143]
    s_add_u32 s56, s50, 0xe0000
    s_add_u32 m0, s46, 0x1c000
    s_nop 0
    buffer_load_dwordx4 v253, s[16:19], s56 offen lds
    ds_read_b64_tr_b16 v[208:209], v245 offset:24576
    ds_read_b64_tr_b16 v[210:211], v245 offset:25088
    s_waitcnt lgkmcnt(12)
    v_mfma_f32_32x32x16_bf16 v[128:143], v[24:27], v[216:219], v[128:143]
    ds_read_b64_tr_b16 v[212:213], v245 offset:26624
    ds_read_b64_tr_b16 v[214:215], v245 offset:27136
    s_waitcnt lgkmcnt(12)
    v_mfma_f32_32x32x16_bf16 v[128:143], v[28:31], v[220:223], v[128:143]
    ds_read_b64_tr_b16 v[216:217], v245 offset:28672
    ds_read_b64_tr_b16 v[218:219], v245 offset:29184
    s_waitcnt lgkmcnt(12)
    v_mfma_f32_32x32x16_bf16 v[128:143], v[32:35], v[192:195], v[128:143]
    s_cmp_lt_u32 s40, 4
    s_cbranch_scc1 L_pr_66
    s_setprio 0
L_pr_66:
    ds_read_b64_tr_b16 v[220:221], v245 offset:30720
    ds_read_b64_tr_b16 v[222:223], v245 offset:31232
    s_waitcnt lgkmcnt(12)
    v_mfma_f32_32x32x16_bf16 v[128:143], v[36:39], v[196:199], v[128:143]
    s_add_u32 s56, s50, 0x118000
    s_add_u32 m0, s46, 0x1a000
    s_nop 0
    buffer_load_dwordx4 v253, s[12:15], s56 offen lds
    ds_read_b64_tr_b16 v[192:193], v243 offset:0
    ds_read_b64_tr_b16 v[194:195], v243 offset:512
    s_waitcnt lgkmcnt(12)
    v_mfma_f32_32x32x16_bf16 v[128:143], v[40:43], v[200:203], v[128:143]
    ds_read_b64_tr_b16 v[196:197], v243 offset:2048
    ds_read_b64_tr_b16 v[198:199], v243 offset:2560
    s_waitcnt lgkmcnt(12)
    v_mfma_f32_32x32x16_bf16 v[128:143], v[44:47], v[204:207], v[128:143]
    ds_read_b64_tr_b16 v[200:201], v243 offset:4096
    ds_read_b64_tr_b16 v[202:203], v243 offset:4608
    s_waitcnt lgkmcnt(12)
    v_mfma_f32_32x32x16_bf16 v[128:143], v[48:51], v[208:211], v[128:143]
    ds_read_b64_tr_b16 v[204:205], v243 offset:6144
    ds_read_b64_tr_b16 v[206:207], v243 offset:6656
    s_waitcnt lgkmcnt(12)
    v_mfma_f32_32x32x16_bf16 v[128:143], v[52:55], v[212:215], v[128:143]
    s_add_u32 s56, s50, 0x118000
    s_add_u32 m0, s46, 0x1e000
    s_nop 0
    buffer_load_dwordx4 v253, s[16:19], s56 offen lds
    ds_read_b64_tr_b16 v[208:209], v243 offset:8192
    ds_read_b64_tr_b16 v[210:211], v243 offset:8704
    s_waitcnt lgkmcnt(12)
    v_mfma_f32_32x32x16_bf16 v[128:143], v[56:59], v[216:219], v[128:143]
    ds_read_b64_tr_b16 v[212:213], v243 offset:10240
    ds_read_b64_tr_b16 v[214:215], v243 offset:10752
    s_waitcnt lgkmcnt(12)
    v_mfma_f32_32x32x16_bf16 v[128:143], v[60:63], v[220:223], v[128:143]
    s_waitcnt vmcnt(12)
    s_barrier
    ds_read_b64_tr_b16 v[216:217], v243 offset:12288
    ds_read_b64_tr_b16 v[218:219], v243 offset:12800
    s_waitcnt lgkmcnt(12)
    v_mfma_f32_32x32x16_bf16 v[128:143], v[64:67], v[192:195], v[128:143]
    s_cmp_lt_u32 s40, 4
    s_cbranch_scc1 L_pr_67
    s_setprio 1
L_pr_67:
    ds_read_b64_tr_b16 v[220:221], v243 offset:14336
    ds_read_b64_tr_b16 v[222:223], v243 offset:14848
    s_waitcnt lgkmcnt(12)
    v_mfma_f32_32x32x16_bf16 v[128:143], v[68:71], v[196:199], v[128:143]
    s_add_u32 s56, s50, 0x150000
    s_add_u32 m0, s46, 0x20000
    s_nop 0
    buffer_load_dwordx4 v253, s[12:15], s56 offen lds
    ds_read_b64_tr_b16 v[192:193], v243 offset:16384
    ds_read_b64_tr_b16 v[194:195], v243 offset:16896
    s_waitcnt lgkmcnt(12)
    v_mfma_f32_32x32x16_bf16 v[128:143], v[72:75], v[200:203], v[128:143]
    ds_read_b64_tr_b16 v[196:197], v243 offset:18432
    ds_read_b64_tr_b16 v[198:199], v243 offset:18944
    s_waitcnt lgkmcnt(12)
    v_mfma_f32_32x32x16_bf16 v[128:143], v[76:79], v[204:207], v[128:143]
    ds_read_b64_tr_b16 v[200:201], v243 offset:20480
    ds_read_b64_tr_b16 v[202:203], v243 offset:20992
    s_waitcnt lgkmcnt(12)
    v_mfma_f32_32x32x16_bf16 v[128:143], v[80:83], v[208:211], v[128:143]
    ds_read_b64_tr_b16 v[204:205], v243 offset:22528
    ds_read_b64_tr_b16 v[206:207], v243 offset:23040
    s_waitcnt lgkmcnt(12)
    v_mfma_f32_32x32x16_bf16 v[128:143], v[84:87], v[212:215], v[128:143]
    s_add_u32 s56, s50, 0x150000
    s_add_u32 m0, s46, 0x24000
    s_nop 0
    buffer_load_dwordx4 v253, s[16:19], s56 offen lds
    ds_read_b64_tr_b16 v[208:209], v243 offset:24576
    ds_read_b64_tr_b16 v[210:211], v243 offset:25088
    s_waitcnt lgkmcnt(12)
    v_mfma_f32_32x32x16_bf16 v[128:143], v[88:91], v[216:219], v[128:143]
    ds_read_b64_tr_b16 v[212:213], v243 offset:26624
    ds_read_b64_tr_b16 v[214:215], v243 offset:27136
    s_waitcnt lgkmcnt(12)
    v_mfma_f32_32x32x16_bf16 v[128:143], v[92:95], v[220:223], v[128:143]
    ds_read_b64_tr_b16 v[216:217], v243 offset:28672
    ds_read_b64_tr_b16 v[218:219], v243 offset:29184
    s_waitcnt lgkmcnt(12)
    v_mfma_f32_32x32x16_bf16 v[128:143], v[96:99], v[192:195], v[128:143]
    s_cmp_lt_u32 s40, 4
    s_cbranch_scc1 L_pr_68
    s_setprio 0
L_pr_68:
    ds_read_b64_tr_b16 v[220:221], v243 offset:30720
    ds_read_b64_tr_b16 v[222:223], v243 offset:31232
    s_waitcnt lgkmcnt(12)
    v_mfma_f32_32x32x16_bf16 v[128:143], v[100:103], v[196:199], v[128:143]
    s_add_u32 s56, s50, 0x188000
    s_add_u32 m0, s46, 0x22000
    s_nop 0
    buffer_load_dwordx4 v253, s[12:15], s56 offen lds
    ds_read_b64_tr_b16 v[192:193], v243 offset:32768
    ds_read_b64_tr_b16 v[194:195], v243 offset:33280
    s_waitcnt lgkmcnt(12)
    v_mfma_f32_32x32x16_bf16 v[128:143], v[104:107], v[200:203], v[128:143]
    ds_read_b64_tr_b16 v[196:197], v243 offset:49152
    ds_read_b64_tr_b16 v[198:199], v243 offset:49664
    s_waitcnt lgkmcnt(12)
    v_mfma_f32_32x32x16_bf16 v[128:143], v[108:111], v[204:207], v[128:143]
    ds_read_b64_tr_b16 v[200:201], v243 offset:34816
    ds_read_b64_tr_b16 v[202:203], v243 offset:35328
    s_waitcnt lgkmcnt(12)
    v_mfma_f32_32x32x16_bf16 v[128:143], v[112:115], v[208:211], v[128:143]
    ds_read_b64_tr_b16 v[204:205], v243 offset:51200
    ds_read_b64_tr_b16 v[206:207], v243 offset:51712
    s_waitcnt lgkmcnt(12)
    v_mfma_f32_32x32x16_bf16 v[128:143], v[116:119], v[212:215], v[128:143]
    s_add_u32 s56, s50, 0x188000
    s_add_u32 m0, s46, 0x26000
    s_nop 0
    buffer_load_dwordx4 v253, s[16:19], s56 offen lds
    ds_read_b64_tr_b16 v[208:209], v243 offset:36864
    ds_read_b64_tr_b16 v[210:211], v243 offset:37376
    s_waitcnt lgkmcnt(12)
    v_mfma_f32_32x32x16_bf16 v[128:143], v[120:123], v[216:219], v[128:143]
    ds_read_b64_tr_b16 v[212:213], v243 offset:53248
    ds_read_b64_tr_b16 v[214:215], v243 offset:53760
    s_waitcnt lgkmcnt(12)
    v_mfma_f32_32x32x16_bf16 v[128:143], v[124:127], v[220:223], v[128:143]
    s_waitcnt vmcnt(10)
    s_barrier
    s_and_b32 s67, s40, 3
    s_lshr_b32 s68, s40, 2
    v_lshrrev_b32 v254, 7, v250
    v_bfe_u32 v255, v250, 4, 3
    v_bfe_u32 v253, v254, 1, 1
    v_lshlrev_b32 v253, 2, v253
    v_xor_b32 v255, v255, v253
    v_lshlrev_b32 v255, 4, v255
    v_lshrrev_b32 v253, 2, v254
    v_and_b32 v254, 3, v254
    v_lshl_add_u32 v254, v253, 3, v254
    v_lshl_add_u32 v252, v254, 10, v255
    s_lshl_b32 s56, s66, 7
    s_lshl_b32 s57, s68, 5
    s_mul_i32 s58, s67, 448
    s_add_u32 s58, s58, s57
    s_lshl_b32 s58, s58, 10
    s_add_u32 s71, s58, s56
    s_lshl_b32 s58, s67, 7
    s_add_u32 s58, s58, s57
    s_lshl_b32 s58, s58, 10
    s_add_u32 s72, s58, s56
    s_lshl_b32 s58, s67, 13
    s_lshl_b32 s57, s68, 12
    s_add_u32 s73, s58, s57
    ds_read_b64_tr_b16 v[216:217], v243 offset:38912
    ds_read_b64_tr_b16 v[218:219], v243 offset:39424
    s_waitcnt lgkmcnt(12)
    v_mfma_f32_32x32x16_bf16 v[160:175], v[192:195], v[0:3], 0
    s_cmp_lt_u32 s40, 4
    s_cbranch_scc1 L_pr_69
    s_setprio 1
L_pr_69:
    ds_read_b64_tr_b16 v[220:221], v243 offset:55296
    ds_read_b64_tr_b16 v[222:223], v243 offset:55808
    s_waitcnt lgkmcnt(12)
    v_mfma_f32_32x32x16_bf16 v[176:191], v[196:199], v[0:3], 0
    s_add_u32 s56, s71, 0x0
    s_add_u32 m0, s73, 0x0
    s_nop 0
    buffer_load_dwordx4 v252, s[20:23], s56 offen lds
    ds_read_b64_tr_b16 v[192:193], v243 offset:40960
    ds_read_b64_tr_b16 v[194:195], v243 offset:41472
    s_waitcnt lgkmcnt(12)
    v_mfma_f32_32x32x16_bf16 v[160:175], v[200:203], v[4:7], v[160:175]
    v_cvt_pk_bf16_f32 v224, v128, v129
    v_cvt_pk_bf16_f32 v225, v130, v131
    v_cvt_pk_bf16_f32 v226, v132, v133
    v_cvt_pk_bf16_f32 v227, v134, v135
    ds_read_b64_tr_b16 v[196:197], v243 offset:57344
    ds_read_b64_tr_b16 v[198:199], v243 offset:57856
    s_waitcnt lgkmcnt(12)
    s_nop 0
    v_mfma_f32_32x32x16_bf16 v[176:191], v[204:207], v[4:7], v[176:191]
    buffer_store_dwordx4 v[224:227], v251, s[32:35], s53 offen offset:0 sc1
    v_cvt_pk_bf16_f32 v228, v136, v137
    v_cvt_pk_bf16_f32 v229, v138, v139
    v_cvt_pk_bf16_f32 v230, v140, v141
    ds_read_b64_tr_b16 v[200:201], v243 offset:43008
    ds_read_b64_tr_b16 v[202:203], v243 offset:43520
    s_waitcnt lgkmcnt(12)
    s_nop 0
    v_mfma_f32_32x32x16_bf16 v[160:175], v[208:211], v[8:11], v[160:175]
    v_cvt_pk_bf16_f32 v231, v142, v143
    buffer_store_dwordx4 v[228:231], v251, s[32:35], s53 offen offset:256 sc1
    ds_read_b64_tr_b16 v[204:205], v243 offset:59392
    ds_read_b64_tr_b16 v[206:207], v243 offset:59904
    s_waitcnt lgkmcnt(12)
    v_mfma_f32_32x32x16_bf16 v[176:191], v[212:215], v[8:11], v[176:191]
    s_add_u32 s56, s71, 0x1000
    s_add_u32 m0, s73, 0x400
    s_nop 0
    buffer_load_dwordx4 v252, s[20:23], s56 offen lds
    ds_read_b64_tr_b16 v[208:209], v243 offset:45056
    ds_read_b64_tr_b16 v[210:211], v243 offset:45568
    s_waitcnt lgkmcnt(12)
    v_mfma_f32_32x32x16_bf16 v[160:175], v[216:219], v[12:15], v[160:175]
    ds_read_b64_tr_b16 v[212:213], v243 offset:61440
    ds_read_b64_tr_b16 v[214:215], v243 offset:61952
    s_waitcnt lgkmcnt(12)
    v_mfma_f32_32x32x16_bf16 v[176:191], v[220:223], v[12:15], v[176:191]
    ds_read_b64_tr_b16 v[216:217], v243 offset:47104
    ds_read_b64_tr_b16 v[218:219], v243 offset:47616
    s_waitcnt lgkmcnt(12)
    v_mfma_f32_32x32x16_bf16 v[160:175], v[192:195], v[16:19], v[160:175]
    s_cmp_lt_u32 s40, 4
    s_cbranch_scc1 L_pr_70
    s_setprio 0
L_pr_70:
    ds_read_b64_tr_b16 v[220:221], v243 offset:63488
    ds_read_b64_tr_b16 v[222:223], v243 offset:64000
    s_waitcnt lgkmcnt(12)
    v_mfma_f32_32x32x16_bf16 v[176:191], v[196:199], v[16:19], v[176:191]
    s_add_u32 s56, s71, 0x4000
    s_add_u32 m0, s73, 0x800
    s_nop 0
    buffer_load_dwordx4 v252, s[20:23], s56 offen lds
    ds_read_b64_tr_b16 v[192:193], v244 offset:0
    ds_read_b64_tr_b16 v[194:195], v244 offset:512
    s_waitcnt lgkmcnt(12)
    v_mfma_f32_32x32x16_bf16 v[160:175], v[200:203], v[20:23], v[160:175]
    ds_read_b64_tr_b16 v[196:197], v244 offset:16384
    ds_read_b64_tr_b16 v[198:199], v244 offset:16896
    s_waitcnt lgkmcnt(12)
    v_mfma_f32_32x32x16_bf16 v[176:191], v[204:207], v[20:23], v[176:191]
    ds_read_b64_tr_b16 v[200:201], v244 offset:2048
    ds_read_b64_tr_b16 v[202:203], v244 offset:2560
    s_waitcnt lgkmcnt(12)
    v_mfma_f32_32x32x16_bf16 v[160:175], v[208:211], v[24:27], v[160:175]
    ds_read_b64_tr_b16 v[204:205], v244 offset:18432
    ds_read_b64_tr_b16 v[206:207], v244 offset:18944
    s_waitcnt lgkmcnt(12)
    v_mfma_f32_32x32x16_bf16 v[176:191], v[212:215], v[24:27], v[176:191]
    s_add_u32 s56, s71, 0x5000
    s_add_u32 m0, s73, 0xc00
    s_nop 0
    buffer_load_dwordx4 v252, s[20:23], s56 offen lds
    ds_read_b64_tr_b16 v[208:209], v244 offset:4096
    ds_read_b64_tr_b16 v[210:211], v244 offset:4608
    s_waitcnt lgkmcnt(12)
    v_mfma_f32_32x32x16_bf16 v[160:175], v[216:219], v[28:31], v[160:175]
    ds_read_b64_tr_b16 v[212:213], v244 offset:20480
    ds_read_b64_tr_b16 v[214:215], v244 offset:20992
    s_waitcnt lgkmcnt(12)
    v_mfma_f32_32x32x16_bf16 v[176:191], v[220:223], v[28:31], v[176:191]
    s_waitcnt vmcnt(10)
    s_waitcnt vmcnt(3)
    s_barrier
    s_cmp_lg_u32 s40, 0
    s_nop 7
    s_cbranch_scc1 L_nopub_71
    s_lshl_b32 s58, s41, 7
    s_add_u32 s58, s58, s95
    s_add_u32 s58, s58, 0x1000000
    v_mov_b32 v247, s94
    s_mov_b64 exec, 1
    buffer_store_dword v247, off, s[32:35], s58 sc0 sc1
    s_mov_b64 exec, -1
L_nopub_71:
    ds_read_b64_tr_b16 v[216:217], v244 offset:6144
    ds_read_b64_tr_b16 v[218:219], v244 offset:6656
    s_waitcnt lgkmcnt(12)
    v_mfma_f32_32x32x16_bf16 v[160:175], v[192:195], v[32:35], v[160:175]
    s_cmp_lt_u32 s40, 4
    s_cbranch_scc1 L_pr_72
    s_setprio 1
L_pr_72:
    ds_read_b64_tr_b16 v[220:221], v244 offset:22528
    ds_read_b64_tr_b16 v[222:223], v244 offset:23040
    s_waitcnt lgkmcnt(12)
    v_mfma_f32_32x32x16_bf16 v[176:191], v[196:199], v[32:35], v[176:191]
    s_add_u32 s56, s71, 0x10000
    s_add_u32 m0, s73, 0x8000
    s_nop 0
    buffer_load_dwordx4 v252, s[20:23], s56 offen lds
    ds_read_b64_tr_b16 v[192:193], v244 offset:8192
    ds_read_b64_tr_b16 v[194:195], v244 offset:8704
    s_waitcnt lgkmcnt(12)
    v_mfma_f32_32x32x16_bf16 v[160:175], v[200:203], v[36:39], v[160:175]
    ds_read_b64_tr_b16 v[196:197], v244 offset:24576
    ds_read_b64_tr_b16 v[198:199], v244 offset:25088
    s_waitcnt lgkmcnt(12)
    v_mfma_f32_32x32x16_bf16 v[176:191], v[204:207], v[36:39], v[176:191]
    ds_read_b64_tr_b16 v[200:201], v244 offset:10240
    ds_read_b64_tr_b16 v[202:203], v244 offset:10752
    s_waitcnt lgkmcnt(12)
    v_mfma_f32_32x32x16_bf16 v[160:175], v[208:211], v[40:43], v[160:175]
    ds_read_b64_tr_b16 v[204:205], v244 offset:26624
    ds_read_b64_tr_b16 v[206:207], v244 offset:27136
    s_waitcnt lgkmcnt(12)
    v_mfma_f32_32x32x16_bf16 v[176:191], v[212:215], v[40:43], v[176:191]
    s_add_u32 s56, s71, 0x11000
    s_add_u32 m0, s73, 0x8400
    s_nop 0
    buffer_load_dwordx4 v252, s[20:23], s56 offen lds
    ds_read_b64_tr_b16 v[208:209], v244 offset:12288
    ds_read_b64_tr_b16 v[210:211], v244 offset:12800
    s_waitcnt lgkmcnt(12)
    v_mfma_f32_32x32x16_bf16 v[160:175], v[216:219], v[44:47], v[160:175]
    ds_read_b64_tr_b16 v[212:213], v244 offset:28672
    ds_read_b64_tr_b16 v[214:215], v244 offset:29184
    s_waitcnt lgkmcnt(12)
    v_mfma_f32_32x32x16_bf16 v[176:191], v[220:223], v[44:47], v[176:191]
    ds_read_b64_tr_b16 v[216:217], v244 offset:14336
    ds_read_b64_tr_b16 v[218:219], v244 offset:14848
    s_waitcnt lgkmcnt(12)
    v_mfma_f32_32x32x16_bf16 v[160:175], v[192:195], v[48:51], v[160:175]
    s_cmp_lt_u32 s40, 4
    s_cbranch_scc1 L_pr_73
    s_setprio 0
L_pr_73:
    ds_read_b64_tr_b16 v[220:221], v244 offset:30720
    ds_read_b64_tr_b16 v[222:223], v244 offset:31232
    s_waitcnt lgkmcnt(12)
    v_mfma_f32_32x32x16_bf16 v[176:191], v[196:199], v[48:51], v[176:191]
    s_add_u32 s56, s71, 0x14000
    s_add_u32 m0, s73, 0x8800
    s_nop 0
    buffer_load_dwordx4 v252, s[20:23], s56 offen lds
    ds_read_b64_tr_b16 v[192:193], v244 offset:32768
    ds_read_b64_tr_b16 v[194:195], v244 offset:33280
    s_waitcnt lgkmcnt(12)
    v_mfma_f32_32x32x16_bf16 v[160:175], v[200:203], v[52:55], v[160:175]
    ds_read_b64_tr_b16 v[196:197], v244 offset:49152
    ds_read_b64_tr_b16 v[198:199], v244 offset:49664
    s_waitcnt lgkmcnt(12)
    v_mfma_f32_32x32x16_bf16 v[176:191], v[204:207], v[52:55], v[176:191]
    ds_read_b64_tr_b16 v[200:201], v244 offset:34816
    ds_read_b64_tr_b16 v[202:203], v244 offset:35328
    s_waitcnt lgkmcnt(12)
    v_mfma_f32_32x32x16_bf16 v[160:175], v[208:211], v[56:59], v[160:175]
    ds_read_b64_tr_b16 v[204:205], v244 offset:51200
    ds_read_b64_tr_b16 v[206:207], v244 offset:51712
    s_waitcnt lgkmcnt(12)
    v_mfma_f32_32x32x16_bf16 v[176:191], v[212:215], v[56:59], v[176:191]
    s_add_u32 s56, s71, 0x15000
    s_add_u32 m0, s73, 0x8c00
    s_nop 0
    buffer_load_dwordx4 v252, s[20:23], s56 offen lds
    ds_read_b64_tr_b16 v[208:209], v244 offset:36864
    ds_read_b64_tr_b16 v[210:211], v244 offset:37376
    s_waitcnt lgkmcnt(12)
    v_mfma_f32_32x32x16_bf16 v[160:175], v[216:219], v[60:63], v[160:175]
    ds_read_b64_tr_b16 v[212:213], v244 offset:53248
    ds_read_b64_tr_b16 v[214:215], v244 offset:53760
    s_waitcnt lgkmcnt(12)
    v_mfma_f32_32x32x16_bf16 v[176:191], v[220:223], v[60:63], v[176:191]
    s_barrier
    ds_read_b64_tr_b16 v[216:217], v244 offset:38912
    ds_read_b64_tr_b16 v[218:219], v244 offset:39424
    s_waitcnt lgkmcnt(12)
    v_mfma_f32_32x32x16_bf16 v[160:175], v[192:195], v[64:67], v[160:175]
    s_cmp_lt_u32 s40, 4
    s_cbranch_scc1 L_pr_74
    s_setprio 1
L_pr_74:
    ds_read_b64_tr_b16 v[220:221], v244 offset:55296
    ds_read_b64_tr_b16 v[222:223], v244 offset:55808
    s_waitcnt lgkmcnt(12)
    v_mfma_f32_32x32x16_bf16 v[176:191], v[196:199], v[64:67], v[176:191]
    s_add_u32 s56, s71, 0x20000
    s_add_u32 m0, s73, 0x10000
    s_nop 0
    buffer_load_dwordx4 v252, s[20:23], s56 offen lds
    ds_read_b64_tr_b16 v[192:193], v244 offset:40960
    ds_read_b64_tr_b16 v[194:195], v244 offset:41472
    s_waitcnt lgkmcnt(12)
    v_mfma_f32_32x32x16_bf16 v[160:175], v[200:203], v[68:71], v[160:175]
    ds_read_b64_tr_b16 v[196:197], v244 offset:57344
    ds_read_b64_tr_b16 v[198:199], v244 offset:57856
    s_waitcnt lgkmcnt(12)
    v_mfma_f32_32x32x16_bf16 v[176:191], v[204:207], v[68:71], v[176:191]
    ds_read_b64_tr_b16 v[200:201], v244 offset:43008
    ds_read_b64_tr_b16 v[202:203], v244 offset:43520
    s_waitcnt lgkmcnt(12)
    v_mfma_f32_32x32x16_bf16 v[160:175], v[208:211], v[72:75], v[160:175]
    ds_read_b64_tr_b16 v[204:205], v244 offset:59392
    ds_read_b64_tr_b16 v[206:207], v244 offset:59904
    s_waitcnt lgkmcnt(12)
    v_mfma_f32_32x32x16_bf16 v[176:191], v[212:215], v[72:75], v[176:191]
    s_add_u32 s56, s71, 0x21000
    s_add_u32 m0, s73, 0x10400
    s_nop 0
    buffer_load_dwordx4 v252, s[20:23], s56 offen lds
    ds_read_b64_tr_b16 v[208:209], v244 offset:45056
    ds_read_b64_tr_b16 v[210:211], v244 offset:45568
    s_waitcnt lgkmcnt(12)
    v_mfma_f32_32x32x16_bf16 v[160:175], v[216:219], v[76:79], v[160:175]
    ds_read_b64_tr_b16 v[212:213], v244 offset:61440
    ds_read_b64_tr_b16 v[214:215], v244 offset:61952
    s_waitcnt lgkmcnt(12)
    v_mfma_f32_32x32x16_bf16 v[176:191], v[220:223], v[76:79], v[176:191]
    ds_read_b64_tr_b16 v[216:217], v244 offset:47104
    ds_read_b64_tr_b16 v[218:219], v244 offset:47616
    s_waitcnt lgkmcnt(12)
    v_mfma_f32_32x32x16_bf16 v[160:175], v[192:195], v[80:83], v[160:175]
    s_cmp_lt_u32 s40, 4
    s_cbranch_scc1 L_pr_75
    s_setprio 0
L_pr_75:
    ds_read_b64_tr_b16 v[220:221], v244 offset:63488
    ds_read_b64_tr_b16 v[222:223], v244 offset:64000
    s_waitcnt lgkmcnt(12)
    v_mfma_f32_32x32x16_bf16 v[176:191], v[196:199], v[80:83], v[176:191]
    s_add_u32 s56, s71, 0x24000
    s_add_u32 m0, s73, 0x10800
    s_nop 0
    buffer_load_dwordx4 v252, s[20:23], s56 offen lds
    ds_read_b64_tr_b16 v[192:193], v245 offset:0
    ds_read_b64_tr_b16 v[194:195], v245 offset:512
    s_waitcnt lgkmcnt(12)
    v_mfma_f32_32x32x16_bf16 v[160:175], v[200:203], v[84:87], v[160:175]
    ds_read_b64_tr_b16 v[196:197], v245 offset:16384
    ds_read_b64_tr_b16 v[198:199], v245 offset:16896
    s_waitcnt lgkmcnt(12)
    v_mfma_f32_32x32x16_bf16 v[176:191], v[204:207], v[84:87], v[176:191]
    ds_read_b64_tr_b16 v[200:201], v245 offset:2048
    ds_read_b64_tr_b16 v[202:203], v245 offset:2560
    s_waitcnt lgkmcnt(12)
    v_mfma_f32_32x32x16_bf16 v[160:175], v[208:211], v[88:91], v[160:175]
    ds_read_b64_tr_b16 v[204:205], v245 offset:18432
    ds_read_b64_tr_b16 v[206:207], v245 offset:18944
    s_waitcnt lgkmcnt(12)
    v_mfma_f32_32x32x16_bf16 v[176:191], v[212:215], v[88:91], v[176:191]
    s_add_u32 s56, s71, 0x25000
    s_add_u32 m0, s73, 0x10c00
    s_nop 0
    buffer_load_dwordx4 v252, s[20:23], s56 offen lds
    ds_read_b64_tr_b16 v[208:209], v245 offset:4096
    ds_read_b64_tr_b16 v[210:211], v245 offset:4608
    s_waitcnt lgkmcnt(12)
    v_mfma_f32_32x32x16_bf16 v[160:175], v[216:219], v[92:95], v[160:175]
    ds_read_b64_tr_b16 v[212:213], v245 offset:20480
    ds_read_b64_tr_b16 v[214:215], v245 offset:20992
    s_waitcnt lgkmcnt(12)
    v_mfma_f32_32x32x16_bf16 v[176:191], v[220:223], v[92:95], v[176:191]
    s_waitcnt vmcnt(8)
    s_barrier
    v_lshrrev_b32 v255, 8, v250
    v_min_u32 v255, 2, v255
    v_sub_u32 v255, s41, v255
    v_max_i32 v255, 0, v255
    v_bfe_u32 v254, v250, 4, 4
    v_lshlrev_b32 v254, 2, v254
    v_lshl_add_u32 v254, v255, 7, v254
    v_add_u32 v254, 0x1000000, v254
    buffer_load_dword v255, v254, s[32:35], 0 offen sc0 sc1
    ds_read_b64_tr_b16 v[216:217], v245 offset:6144
    ds_read_b64_tr_b16 v[218:219], v245 offset:6656
    s_waitcnt lgkmcnt(12)
    v_mfma_f32_32x32x16_bf16 v[160:175], v[192:195], v[96:99], v[160:175]
    s_cmp_lt_u32 s40, 4
    s_cbranch_scc1 L_pr_76
    s_setprio 1
L_pr_76:
    ds_read_b64_tr_b16 v[220:221], v245 offset:22528
    ds_read_b64_tr_b16 v[222:223], v245 offset:23040
    s_waitcnt lgkmcnt(12)
    v_mfma_f32_32x32x16_bf16 v[176:191], v[196:199], v[96:99], v[176:191]
    s_add_u32 s56, s71, 0x30000
    s_add_u32 m0, s73, 0x18000
    s_nop 0
    buffer_load_dwordx4 v252, s[20:23], s56 offen lds
    ds_read_b64_tr_b16 v[192:193], v245 offset:8192
    ds_read_b64_tr_b16 v[194:195], v245 offset:8704
    s_waitcnt lgkmcnt(12)
    v_mfma_f32_32x32x16_bf16 v[160:175], v[200:203], v[100:103], v[160:175]
    ds_read_b64_tr_b16 v[196:197], v245 offset:24576
    ds_read_b64_tr_b16 v[198:199], v245 offset:25088
    s_waitcnt lgkmcnt(12)
    v_mfma_f32_32x32x16_bf16 v[176:191], v[204:207], v[100:103], v[176:191]
    ds_read_b64_tr_b16 v[200:201], v245 offset:10240
    ds_read_b64_tr_b16 v[202:203], v245 offset:10752
    s_waitcnt lgkmcnt(12)
    v_mfma_f32_32x32x16_bf16 v[160:175], v[208:211], v[104:107], v[160:175]
    ds_read_b64_tr_b16 v[204:205], v245 offset:26624
    ds_read_b64_tr_b16 v[206:207], v245 offset:27136
    s_waitcnt lgkmcnt(12)
    v_mfma_f32_32x32x16_bf16 v[176:191], v[212:215], v[104:107], v[176:191]
    s_add_u32 s56, s71, 0x31000
    s_add_u32 m0, s73, 0x18400
    s_nop 0
    buffer_load_dwordx4 v252, s[20:23], s56 offen lds
    ds_read_b64_tr_b16 v[208:209], v245 offset:12288
    ds_read_b64_tr_b16 v[210:211], v245 offset:12800
    s_waitcnt lgkmcnt(12)
    v_mfma_f32_32x32x16_bf16 v[160:175], v[216:219], v[108:111], v[160:175]
    ds_read_b64_tr_b16 v[212:213], v245 offset:28672
    ds_read_b64_tr_b16 v[214:215], v245 offset:29184
    s_waitcnt lgkmcnt(12)
    v_mfma_f32_32x32x16_bf16 v[176:191], v[220:223], v[108:111], v[176:191]
    ds_read_b64_tr_b16 v[216:217], v245 offset:14336
    ds_read_b64_tr_b16 v[218:219], v245 offset:14848
    s_waitcnt lgkmcnt(12)
    v_mfma_f32_32x32x16_bf16 v[160:175], v[192:195], v[112:115], v[160:175]
    s_cmp_lt_u32 s40, 4
    s_cbranch_scc1 L_pr_77
    s_setprio 0
L_pr_77:
    ds_read_b64_tr_b16 v[220:221], v245 offset:30720
    ds_read_b64_tr_b16 v[222:223], v245 offset:31232
    s_waitcnt lgkmcnt(12)
    v_mfma_f32_32x32x16_bf16 v[176:191], v[196:199], v[112:115], v[176:191]
    s_add_u32 s56, s71, 0x34000
    s_add_u32 m0, s73, 0x18800
    s_nop 0
    buffer_load_dwordx4 v252, s[20:23], s56 offen lds
    s_waitcnt lgkmcnt(10)
    v_mfma_f32_32x32x16_bf16 v[160:175], v[200:203], v[116:119], v[160:175]
    s_waitcnt lgkmcnt(8)
    v_mfma_f32_32x32x16_bf16 v[176:191], v[204:207], v[116:119], v[176:191]
    s_waitcnt lgkmcnt(6)
    v_mfma_f32_32x32x16_bf16 v[160:175], v[208:211], v[120:123], v[160:175]
    s_waitcnt lgkmcnt(4)
    v_mfma_f32_32x32x16_bf16 v[176:191], v[212:215], v[120:123], v[176:191]
    s_add_u32 s56, s71, 0x35000
    s_add_u32 m0, s73, 0x18c00
    s_nop 0
    buffer_load_dwordx4 v252, s[20:23], s56 offen lds
    s_waitcnt lgkmcnt(2)
    v_mfma_f32_32x32x16_bf16 v[160:175], v[216:219], v[124:127], v[160:175]
    s_waitcnt lgkmcnt(0)
    v_mfma_f32_32x32x16_bf16 v[176:191], v[220:223], v[124:127], v[176:191]
    s_waitcnt vmcnt(4)
    s_mov_b32 s55, 0
    s_nop 9
L_flr_78:
    v_cmp_ne_u32 vcc, s94, v255
    s_nop 4
    s_cbranch_vccz L_fld_79
    s_sleep 1
    buffer_load_dword v255, v254, s[32:35], 0 offen sc0 sc1
    s_waitcnt vmcnt(0)
    s_add_u32 s55, s55, 1
    s_cmp_lt_u32 s55, 0x100000
    s_cbranch_scc1 L_flr_78
L_fld_79:
    s_lshl_b32 s75, s42, 3
    s_lshl_b32 s56, s43, 1
    s_add_u32 s75, s75, s56
    s_add_u32 s75, s75, s45
    s_lshl_b32 s74, s41, 2
    s_add_u32 s74, s74, s44
    s_lshl_b32 s56, s75, 6
    s_add_u32 s57, s56, s74
    s_lshl_b32 s57, s57, 10
    buffer_load_dwordx4 v[140:143], v250, s[32:35], s57 offen sc1
    s_add_i32 s57, s74, 0
    s_max_i32 s57, s57, 0
    s_add_u32 s57, s57, s56
    s_lshl_b32 s57, s57, 10
    s_add_u32 s58, s57, 0x200000
    buffer_load_dwordx4 v[136:139], v250, s[32:35], s58 offen sc1
    s_add_u32 s84, s57, 0x400000
    s_add_i32 s57, s74, -1
    s_max_i32 s57, s57, 0
    s_add_u32 s57, s57, s56
    s_lshl_b32 s57, s57, 10
    s_add_u32 s58, s57, 0x200000
    buffer_load_dwordx4 v[132:135], v250, s[32:35], s58 offen sc1
    s_add_u32 s83, s57, 0x400000
    s_add_i32 s57, s74, -2
    s_max_i32 s57, s57, 0
    s_add_u32 s57, s57, s56
    s_lshl_b32 s57, s57, 10
    s_add_u32 s58, s57, 0x200000
    buffer_load_dwordx4 v[128:131], v250, s[32:35], s58 offen sc1
    s_add_u32 s82, s57, 0x400000
    s_add_i32 s57, s74, -3
    s_max_i32 s57, s57, 0
    s_add_u32 s57, s57, s56
    s_lshl_b32 s57, s57, 10
    s_add_u32 s58, s57, 0x200000
    buffer_load_dwordx4 v[124:127], v250, s[32:35], s58 offen sc1
    s_add_u32 s81, s57, 0x400000
    s_add_i32 s57, s74, -4
    s_max_i32 s57, s57, 0
    s_add_u32 s57, s57, s56
    s_lshl_b32 s57, s57, 10
    s_add_u32 s58, s57, 0x200000
    buffer_load_dwordx4 v[120:123], v250, s[32:35], s58 offen sc1
    s_add_u32 s80, s57, 0x400000
    s_add_i32 s57, s74, -5
    s_max_i32 s57, s57, 0
    s_add_u32 s57, s57, s56
    s_lshl_b32 s57, s57, 10
    s_add_u32 s58, s57, 0x200000
    buffer_load_dwordx4 v[116:119], v250, s[32:35], s58 offen sc1
    s_add_u32 s79, s57, 0x400000
    s_add_i32 s57, s74, -6
    s_max_i32 s57, s57, 0
    s_add_u32 s57, s57, s56
    s_lshl_b32 s57, s57, 10
    s_add_u32 s58, s57, 0x200000
    buffer_load_dwordx4 v[112:115], v250, s[32:35], s58 offen sc1
    s_add_u32 s78, s57, 0x400000
    s_add_i32 s57, s74, -7
    s_max_i32 s57, s57, 0
    s_add_u32 s57, s57, s56
    s_lshl_b32 s57, s57, 10
    s_add_u32 s58, s57, 0x200000
    buffer_load_dwordx4 v[108:111], v250, s[32:35], s58 offen sc1
    s_add_u32 s77, s57, 0x400000
    s_add_i32 s57, s74, -8
    s_max_i32 s57, s57, 0
    s_add_u32 s57, s57, s56
    s_lshl_b32 s57, s57, 10
    s_add_u32 s58, s57, 0x200000
    buffer_load_dwordx4 v[104:107], v250, s[32:35], s58 offen sc1
    s_add_u32 s76, s57, 0x400000
    v_mul_f32 v232, v160, v160
    v_mul_f32 v233, v161, v161
    v_mul_f32 v234, v162, v162
    v_mul_f32 v235, v163, v163
    s_nop 0
    v_fma_f32 v232, v232, s63, v246
    v_fma_f32 v233, v233, s63, v246
    v_fma_f32 v234, v234, s63, v246
    v_fma_f32 v235, v235, s63, v246
    v_mul_f32 v232, v232, v160
    v_mul_f32 v233, v233, v161
    v_mul_f32 v234, v234, v162
    v_mul_f32 v235, v235, v163
    v_exp_f32 v232, v232
    v_exp_f32 v233, v233
    v_exp_f32 v234, v234
    v_exp_f32 v235, v235
    v_mul_f32 v160, v160, v176
    v_mul_f32 v161, v161, v177
    v_mul_f32 v162, v162, v178
    v_mul_f32 v163, v163, v179
    v_add_f32 v232, 1.0, v232
    v_add_f32 v233, 1.0, v233
    v_add_f32 v234, 1.0, v234
    v_add_f32 v235, 1.0, v235
    v_rcp_f32 v232, v232
    v_rcp_f32 v233, v233
    v_rcp_f32 v234, v234
    v_rcp_f32 v235, v235
    v_mul_f32 v160, v160, v232
    v_mul_f32 v161, v161, v233
    v_mul_f32 v162, v162, v234
    v_mul_f32 v163, v163, v235
    v_cvt_pk_bf16_f32 v224, v160, v161
    v_cvt_pk_bf16_f32 v225, v162, v163
    v_mul_f32 v236, v164, v164
    v_mul_f32 v237, v165, v165
    v_mul_f32 v238, v166, v166
    v_mul_f32 v239, v167, v167
    v_fma_f32 v236, v236, s63, v246
    v_fma_f32 v237, v237, s63, v246
    v_fma_f32 v238, v238, s63, v246
    v_fma_f32 v239, v239, s63, v246
    v_mul_f32 v236, v236, v164
    v_mul_f32 v237, v237, v165
    v_mul_f32 v238, v238, v166
    v_mul_f32 v239, v239, v167
    v_exp_f32 v236, v236
    v_exp_f32 v237, v237
    v_exp_f32 v238, v238
    v_exp_f32 v239, v239
    v_mul_f32 v164, v164, v180
    v_mul_f32 v165, v165, v181
    v_mul_f32 v166, v166, v182
    v_mul_f32 v167, v167, v183
    v_add_f32 v236, 1.0, v236
    v_add_f32 v237, 1.0, v237
    v_add_f32 v238, 1.0, v238
    v_add_f32 v239, 1.0, v239
    v_rcp_f32 v236, v236
    v_rcp_f32 v237, v237
    v_rcp_f32 v238, v238
    v_rcp_f32 v239, v239
    v_mul_f32 v164, v164, v236
    v_mul_f32 v165, v165, v237
    v_mul_f32 v166, v166, v238
    v_mul_f32 v167, v167, v239
    v_cvt_pk_bf16_f32 v226, v164, v165
    v_cvt_pk_bf16_f32 v227, v166, v167
    buffer_store_dwordx4 v[224:227], v250, s[32:35], s54 offen offset:0 sc1
    v_mul_f32 v232, v168, v168
    v_mul_f32 v233, v169, v169
    v_mul_f32 v234, v170, v170
    v_mul_f32 v235, v171, v171
    v_fma_f32 v232, v232, s63, v246
    v_fma_f32 v233, v233, s63, v246
    v_fma_f32 v234, v234, s63, v246
    v_fma_f32 v235, v235, s63, v246
    v_mul_f32 v232, v232, v168
    v_mul_f32 v233, v233, v169
    v_mul_f32 v234, v234, v170
    v_mul_f32 v235, v235, v171
    v_exp_f32 v232, v232
    v_exp_f32 v233, v233
    v_exp_f32 v234, v234
    v_exp_f32 v235, v235
    v_mul_f32 v168, v168, v184
    v_mul_f32 v169, v169, v185
    v_mul_f32 v170, v170, v186
    v_mul_f32 v171, v171, v187
    v_add_f32 v232, 1.0, v232
    v_add_f32 v233, 1.0, v233
    v_add_f32 v234, 1.0, v234
    v_add_f32 v235, 1.0, v235
    v_rcp_f32 v232, v232
    v_rcp_f32 v233, v233
    v_rcp_f32 v234, v234
    v_rcp_f32 v235, v235
    v_mul_f32 v168, v168, v232
    v_mul_f32 v169, v169, v233
    v_mul_f32 v170, v170, v234
    v_mul_f32 v171, v171, v235
    v_cvt_pk_bf16_f32 v228, v168, v169
    v_cvt_pk_bf16_f32 v229, v170, v171
    v_mul_f32 v236, v172, v172
    v_mul_f32 v237, v173, v173
    v_mul_f32 v238, v174, v174
    v_mul_f32 v239, v175, v175
    v_fma_f32 v236, v236, s63, v246
    v_fma_f32 v237, v237, s63, v246
    v_fma_f32 v238, v238, s63, v246
    v_fma_f32 v239, v239, s63, v246
    v_mul_f32 v236, v236, v172
    v_mul_f32 v237, v237, v173
    v_mul_f32 v238, v238, v174
    v_mul_f32 v239, v239, v175
    v_exp_f32 v236, v236
    v_exp_f32 v237, v237
    v_exp_f32 v238, v238
    v_exp_f32 v239, v239
    v_mul_f32 v172, v172, v188
    v_mul_f32 v173, v173, v189
    v_mul_f32 v174, v174, v190
    v_mul_f32 v175, v175, v191
    v_add_f32 v236, 1.0, v236
    v_add_f32 v237, 1.0, v237
    v_add_f32 v238, 1.0, v238
    v_add_f32 v239, 1.0, v239
    v_rcp_f32 v236, v236
    v_rcp_f32 v237, v237
    v_rcp_f32 v238, v238
    v_rcp_f32 v239, v239
    v_mul_f32 v172, v172, v236
    v_mul_f32 v173, v173, v237
    v_mul_f32 v174, v174, v238
    v_mul_f32 v175, v175, v239
    v_cvt_pk_bf16_f32 v230, v172, v173
    v_cvt_pk_bf16_f32 v231, v174, v175
    buffer_store_dwordx4 v[228:231], v250, s[32:35], s54 offen offset:1024 sc1
    v_mov_b32 v192, s60
    v_mov_b32 v193, s60
    v_mov_b32 v194, s60
    v_mov_b32 v195, s60
    v_mov_b32 v196, s60
    v_mov_b32 v197, s60
    v_mov_b32 v198, s60
    v_mov_b32 v199, s60
    s_mov_b32 exec_lo, 0x0000ffff
    s_mov_b32 exec_hi, 0x0000ffff
    buffer_load_dwordx4 v[192:195], v250, s[32:35], s76 offen sc1
    s_mov_b32 exec_lo, 0xffff0000
    s_mov_b32 exec_hi, 0xffff0000
    buffer_load_dwordx4 v[196:199], v250, s[32:35], s76 offen sc1
    s_mov_b64 exec, -1
    v_mov_b32 v200, s60
    v_mov_b32 v201, s60
    v_mov_b32 v202, s60
    v_mov_b32 v203, s60
    v_mov_b32 v204, s60
    v_mov_b32 v205, s60
    v_mov_b32 v206, s60
    v_mov_b32 v207, s60
    s_nop 0
    s_mov_b32 exec_lo, 0x0000ffff
    s_mov_b32 exec_hi, 0x0000ffff
    buffer_load_dwordx4 v[200:203], v250, s[32:35], s77 offen sc1
    s_mov_b32 exec_lo, 0xffff0000
    s_mov_b32 exec_hi, 0xffff0000
    buffer_load_dwordx4 v[204:207], v250, s[32:35], s77 offen sc1
    s_mov_b64 exec, -1
    v_mov_b32 v208, s60
    v_mov_b32 v209, s60
    v_mov_b32 v210, s60
    v_mov_b32 v211, s60
    v_mov_b32 v212, s60
    v_mov_b32 v213, s60
    v_mov_b32 v214, s60
    v_mov_b32 v215, s60
    s_nop 0
    s_mov_b32 exec_lo, 0x0000ffff
    s_mov_b32 exec_hi, 0x0000ffff
    buffer_load_dwordx4 v[208:211], v250, s[32:35], s78 offen sc1
    s_mov_b32 exec_lo, 0xffff0000
    s_mov_b32 exec_hi, 0xffff0000
    buffer_load_dwordx4 v[212:215], v250, s[32:35], s78 offen sc1
    s_mov_b64 exec, -1
    v_mov_b32 v32, s60
    v_mov_b32 v33, s60
    v_mov_b32 v34, s60
    v_mov_b32 v35, s60
    v_mov_b32 v36, s60
    v_mov_b32 v37, s60
    v_mov_b32 v38, s60
    v_mov_b32 v39, s60
    s_nop 0
    s_mov_b32 exec_lo, 0x0000ffff
    s_mov_b32 exec_hi, 0x0000ffff
    buffer_load_dwordx4 v[32:35], v250, s[32:35], s79 offen sc1
    s_mov_b32 exec_lo, 0xffff0000
    s_mov_b32 exec_hi, 0xffff0000
    buffer_load_dwordx4 v[36:39], v250, s[32:35], s79 offen sc1
    s_mov_b64 exec, -1
    v_mov_b32 v40, s60
    v_mov_b32 v41, s60
    v_mov_b32 v42, s60
    v_mov_b32 v43, s60
    v_mov_b32 v44, s60
    v_mov_b32 v45, s60
    v_mov_b32 v46, s60
    v_mov_b32 v47, s60
    s_nop 0
    s_mov_b32 exec_lo, 0x0000ffff
    s_mov_b32 exec_hi, 0x0000ffff
    buffer_load_dwordx4 v[40:43], v250, s[32:35], s80 offen sc1
    s_mov_b32 exec_lo, 0xffff0000
    s_mov_b32 exec_hi, 0xffff0000
    buffer_load_dwordx4 v[44:47], v250, s[32:35], s80 offen sc1
    s_mov_b64 exec, -1
    v_mov_b32 v48, s60
    v_mov_b32 v49, s60
    v_mov_b32 v50, s60
    v_mov_b32 v51, s60
    v_mov_b32 v52, s60
    v_mov_b32 v53, s60
    v_mov_b32 v54, s60
    v_mov_b32 v55, s60
    s_nop 0
    s_mov_b32 exec_lo, 0x0000ffff
    s_mov_b32 exec_hi, 0x0000ffff
    buffer_load_dwordx4 v[48:51], v250, s[32:35], s81 offen sc1
    s_mov_b32 exec_lo, 0xffff0000
    s_mov_b32 exec_hi, 0xffff0000
    buffer_load_dwordx4 v[52:55], v250, s[32:35], s81 offen sc1
    s_mov_b64 exec, -1
    v_mov_b32 v56, s60
    v_mov_b32 v57, s60
    v_mov_b32 v58, s60
    v_mov_b32 v59, s60
    v_mov_b32 v60, s60
    v_mov_b32 v61, s60
    v_mov_b32 v62, s60
    v_mov_b32 v63, s60
    s_nop 0
    s_mov_b32 exec_lo, 0x0000ffff
    s_mov_b32 exec_hi, 0x0000ffff
    buffer_load_dwordx4 v[56:59], v250, s[32:35], s82 offen sc1
    s_mov_b32 exec_lo, 0xffff0000
    s_mov_b32 exec_hi, 0xffff0000
    buffer_load_dwordx4 v[60:63], v250, s[32:35], s82 offen sc1
    s_mov_b64 exec, -1
    v_mov_b32 v64, s60
    v_mov_b32 v65, s60
    v_mov_b32 v66, s60
    v_mov_b32 v67, s60
    v_mov_b32 v68, s60
    v_mov_b32 v69, s60
    v_mov_b32 v70, s60
    v_mov_b32 v71, s60
    s_nop 0
    s_mov_b32 exec_lo, 0x0000ffff
    s_mov_b32 exec_hi, 0x0000ffff
    buffer_load_dwordx4 v[64:67], v250, s[32:35], s83 offen sc1
    s_mov_b32 exec_lo, 0xffff0000
    s_mov_b32 exec_hi, 0xffff0000
    buffer_load_dwordx4 v[68:71], v250, s[32:35], s83 offen sc1
    s_mov_b64 exec, -1
    v_mov_b32 v72, s60
    v_mov_b32 v73, s60
    v_mov_b32 v74, s60
    v_mov_b32 v75, s60
    v_mov_b32 v76, s60
    v_mov_b32 v77, s60
    v_mov_b32 v78, s60
    v_mov_b32 v79, s60
    s_nop 0
    s_mov_b32 exec_lo, 0x0000ffff
    s_mov_b32 exec_hi, 0x0000ffff
    buffer_load_dwordx4 v[72:75], v250, s[32:35], s84 offen sc1
    s_mov_b32 exec_lo, 0xffff0000
    s_mov_b32 exec_hi, 0xffff0000
    buffer_load_dwordx4 v[76:79], v250, s[32:35], s84 offen sc1
    s_mov_b64 exec, -1
L_p1join_3:
    v_bfe_u32 v248, v250, 4, 5
    v_lshrrev_b32 v249, 9, v250
    v_lshlrev_b32 v249, 2, v249
    v_sub_u32 v248, v248, v249
    v_mov_b32 v249, 0xf149f2ca
    v_mov_b32 v96, v249
    v_mov_b32 v97, v249
    v_mov_b32 v98, v249
    s_waitcnt vmcnt(28)
    v_mfma_f32_32x32x16_bf16 v[0:15], v[136:139], v[140:143], 0
    s_waitcnt vmcnt(27)
    v_mfma_f32_32x32x16_bf16 v[160:175], v[132:135], v[140:143], 0
    s_waitcnt vmcnt(26)
    v_mfma_f32_32x32x16_bf16 v[176:191], v[128:131], v[140:143], 0
    s_waitcnt vmcnt(20)
    v_mfma_f32_32x32x16_bf16 v[16:31], v[104:107], v[140:143], 0
    s_cmp_lt_u32 s74, 1
    s_cbranch_scc1 L_skip7_L_p1done_80
    s_nop 7
    v_max3_f32 v96, v96, v160, v161
    v_max3_f32 v97, v97, v162, v163
    v_max3_f32 v98, v98, v164, v165
    v_max3_f32 v96, v96, v166, v167
    v_max3_f32 v97, v97, v168, v169
    v_max3_f32 v98, v98, v170, v171
    v_max3_f32 v96, v96, v172, v173
    v_max3_f32 v97, v97, v174, v175
L_skip7_L_p1done_80:
    v_mfma_f32_32x32x16_bf16 v[160:175], v[124:127], v[140:143], 0
    s_waitcnt vmcnt(18)
    s_lshl_b32 s58, s74, 7
    s_lshl_b32 s59, s95, 1
    s_add_u32 s58, s58, s59
    s_lshl_b32 s59, s45, 2
    s_add_u32 s58, s58, s59
    s_add_u32 s58, s58, 0x1002000
    v_mov_b32 v253, s94
    s_mov_b64 exec, 1
    buffer_store_dword v253, off, s[32:35], s58 sc0 sc1
    s_mov_b64 exec, -1
    s_cmp_lt_u32 s74, 2
    s_cbranch_scc1 L_skip6_L_p1done_80
    s_nop 0
    v_max3_f32 v96, v96, v176, v177
    v_max3_f32 v97, v97, v178, v179
    v_max3_f32 v98, v98, v180, v181
    v_max3_f32 v96, v96, v182, v183
    v_max3_f32 v97, v97, v184, v185
    v_max3_f32 v98, v98, v186, v187
    v_max3_f32 v96, v96, v188, v189
    v_max3_f32 v97, v97, v190, v191
L_skip6_L_p1done_80:
    v_mfma_f32_32x32x16_bf16 v[176:191], v[120:123], v[140:143], 0
    s_cmp_ge_u32 s74, 8
    s_cbranch_scc1 L_t0ok_81
    s_nop 7
    s_nop 7
    v_mov_b32 v16, v249
    v_mov_b32 v17, v249
    v_mov_b32 v18, v249
    v_mov_b32 v19, v249
    v_mov_b32 v20, v249
    v_mov_b32 v21, v249
    v_mov_b32 v22, v249
    v_mov_b32 v23, v249
    v_mov_b32 v24, v249
    v_mov_b32 v25, v249
    v_mov_b32 v26, v249
    v_mov_b32 v27, v249
    v_mov_b32 v28, v249
    v_mov_b32 v29, v249
    v_mov_b32 v30, v249
    v_mov_b32 v31, v249
L_t0ok_81:
    v_cmp_le_i32 s[86:87], 0, v248
    v_cmp_le_i32 s[88:89], 1, v248
    v_cmp_le_i32 s[90:91], 2, v248
    v_cmp_le_i32 s[92:93], 3, v248
    v_cndmask_b32 v0, v16, v0, s[86:87]
    v_cndmask_b32 v1, v17, v1, s[88:89]
    v_cndmask_b32 v2, v18, v2, s[90:91]
    v_cndmask_b32 v3, v19, v3, s[92:93]
    v_cmp_le_i32 s[86:87], 8, v248
    v_cmp_le_i32 s[88:89], 9, v248
    v_cmp_le_i32 s[90:91], 10, v248
    v_cmp_le_i32 s[92:93], 11, v248
    v_cndmask_b32 v4, v20, v4, s[86:87]
    v_cndmask_b32 v5, v21, v5, s[88:89]
    v_cndmask_b32 v6, v22, v6, s[90:91]
    v_cndmask_b32 v7, v23, v7, s[92:93]
    v_cmp_le_i32 s[86:87], 16, v248
    v_cmp_le_i32 s[88:89], 17, v248
    v_cmp_le_i32 s[90:91], 18, v248
    v_cmp_le_i32 s[92:93], 19, v248
    v_cndmask_b32 v8, v24, v8, s[86:87]
    v_cndmask_b32 v9, v25, v9, s[88:89]
    v_cndmask_b32 v10, v26, v10, s[90:91]
    v_cndmask_b32 v11, v27, v11, s[92:93]
    v_cmp_le_i32 s[86:87], 24, v248
    v_cmp_le_i32 s[88:89], 25, v248
    v_cmp_le_i32 s[90:91], 26, v248
    v_cmp_le_i32 s[92:93], 27, v248
    v_cndmask_b32 v12, v28, v12, s[86:87]
    v_cndmask_b32 v13, v29, v13, s[88:89]
    v_cndmask_b32 v14, v30, v14, s[90:91]
    v_cndmask_b32 v15, v31, v15, s[92:93]
    v_max3_f32 v96, v96, v0, v1
    v_max3_f32 v97, v97, v2, v3
    v_max3_f32 v98, v98, v4, v5
    v_max3_f32 v96, v96, v6, v7
    v_max3_f32 v97, v97, v8, v9
    v_max3_f32 v98, v98, v10, v11
    v_max3_f32 v96, v96, v12, v13
    v_max3_f32 v97, v97, v14, v15
    v_mfma_f32_32x32x16_bf16 v[0:15], v[116:119], v[140:143], 0
    v_mfma_f32_32x32x16_bf16 v[16:31], v[112:115], v[140:143], 0
    s_cmp_lt_u32 s74, 3
    s_cbranch_scc1 L_skip5_L_p1done_80
    v_max3_f32 v96, v96, v160, v161
    v_max3_f32 v97, v97, v162, v163
    v_max3_f32 v98, v98, v164, v165
    v_max3_f32 v96, v96, v166, v167
    v_max3_f32 v97, v97, v168, v169
    v_max3_f32 v98, v98, v170, v171
    v_max3_f32 v96, v96, v172, v173
    v_max3_f32 v97, v97, v174, v175
L_skip5_L_p1done_80:
    v_mfma_f32_32x32x16_bf16 v[160:175], v[108:111], v[140:143], 0
    s_cmp_lt_u32 s74, 4
    s_cbranch_scc1 L_skip4_L_p1done_80
    v_max3_f32 v96, v96, v176, v177
    v_max3_f32 v97, v97, v178, v179
    v_max3_f32 v98, v98, v180, v181
    v_max3_f32 v96, v96, v182, v183
    v_max3_f32 v97, v97, v184, v185
    v_max3_f32 v98, v98, v186, v187
    v_max3_f32 v96, v96, v188, v189
    v_max3_f32 v97, v97, v190, v191
L_skip4_L_p1done_80:
    s_cmp_lt_u32 s74, 5
    s_cbranch_scc1 L_skip3_L_p1done_80
    v_max3_f32 v96, v96, v0, v1
    v_max3_f32 v97, v97, v2, v3
    v_max3_f32 v98, v98, v4, v5
    v_max3_f32 v96, v96, v6, v7
    v_max3_f32 v97, v97, v8, v9
    v_max3_f32 v98, v98, v10, v11
    v_max3_f32 v96, v96, v12, v13
    v_max3_f32 v97, v97, v14, v15
L_skip3_L_p1done_80:
    s_cmp_lt_u32 s74, 6
    s_cbranch_scc1 L_skip2_L_p1done_80
    v_max3_f32 v96, v96, v16, v17
    v_max3_f32 v97, v97, v18, v19
    v_max3_f32 v98, v98, v20, v21
    v_max3_f32 v96, v96, v22, v23
    v_max3_f32 v97, v97, v24, v25
    v_max3_f32 v98, v98, v26, v27
    v_max3_f32 v96, v96, v28, v29
    v_max3_f32 v97, v97, v30, v31
L_skip2_L_p1done_80:
    s_cmp_lt_u32 s74, 7
    s_cbranch_scc1 L_skip1_L_p1done_80
    v_max3_f32 v96, v96, v160, v161
    v_max3_f32 v97, v97, v162, v163
    v_max3_f32 v98, v98, v164, v165
    v_max3_f32 v96, v96, v166, v167
    v_max3_f32 v97, v97, v168, v169
    v_max3_f32 v98, v98, v170, v171
    v_max3_f32 v96, v96, v172, v173
    v_max3_f32 v97, v97, v174, v175
L_skip1_L_p1done_80:
    s_nop 11
    v_max3_f32 v96, v96, v97, v98
    v_mov_b32 v97, v96
    s_nop 1
    v_permlane32_swap_b32 v96, v97
    v_max_f32 v96, v96, v97
    v_sub_f32 v251, 0, v96
    s_cmp_ge_u32 s74, 8
    s_cselect_b64 s[86:87], -1, 0
    v_cndmask_b32 v96, v249, v251, s[86:87]
    v_mov_b32 v144, v96
    v_mov_b32 v145, v96
    v_mov_b32 v146, v96
    v_mov_b32 v147, v96
    v_mov_b32 v148, v96
    v_mov_b32 v149, v96
    v_mov_b32 v150, v96
    v_mov_b32 v151, v96
    v_mov_b32 v152, v96
    v_mov_b32 v153, v96
    v_mov_b32 v154, v96
    v_mov_b32 v155, v96
    v_mov_b32 v156, v96
    v_mov_b32 v157, v96
    v_mov_b32 v158, v96
    v_mov_b32 v159, v96
    s_lshl_b32 s56, s65, 1
    s_add_u32 s56, s56, s68
    s_mul_i32 s57, s56, 144
    s_mul_i32 s58, s67, 28
    s_add_u32 s58, s58, s57
    s_lshl_b32 s58, s58, 10
    s_add_u32 s69, s58, 0x600000
    s_lshl_b32 s58, s67, 3
    s_add_u32 s58, s58, s57
    s_add_u32 s58, s58, 112
    s_lshl_b32 s58, s58, 10
    s_add_u32 s70, s58, 0x600000
    v_lshrrev_b32 v80, 9, v250
    v_bfe_u32 v81, v250, 6, 2
    v_lshl_add_u32 v81, v80, 3, v81
    v_lshlrev_b32 v81, 7, v81
    v_bfe_u32 v82, v250, 8, 1
    v_lshl_add_u32 v81, v82, 5, v81
    v_bfe_u32 v82, v250, 4, 2
    v_lshl_add_u32 v81, v82, 3, v81
    s_lshl_b32 s56, s67, 13
    v_add_u32 v81, s56, v81
    v_bfe_u32 v82, v250, 7, 1
    v_lshl_add_u32 v96, v82, 6, v81
    v_xor_b32 v82, 1, v82
    s_nop 0
    v_lshl_add_u32 v97, v82, 6, v81
    v_add_u32 v98, 0x10000, v96
    v_add_u32 v99, 0x10000, v97
    v_add_u32 v100, 0x20000, v96
    v_add_u32 v101, 0x20000, v97
    s_lshl_b32 s56, s65, 1
    s_add_u32 s56, s56, s68
    s_lshl_b32 s56, s56, 5
    v_bfe_u32 v81, v250, 4, 5
    v_add_u32 v81, s56, v81
    v_lshlrev_b32 v81, 10, v81
    v_lshl_add_u32 v81, v80, 4, v81
    s_lshl_b32 s56, s66, 7
    s_lshl_b32 s57, s67, 5
    s_add_u32 s56, s56, s57
    v_add_u32 v102, s56, v81
    v_mfma_f32_32x32x16_bf16 v[160:175], v[104:107], v[140:143], v[144:159]
    v_mfma_f32_32x32x16_bf16 v[176:191], v[136:139], v[140:143], 0
    v_mov_b32 v253, 0xffff
    s_nop 10
    v_add_f32 v176, v176, v251
    v_add_f32 v177, v177, v251
    v_add_f32 v178, v178, v251
    v_add_f32 v179, v179, v251
    v_add_f32 v180, v180, v251
    v_add_f32 v181, v181, v251
    v_add_f32 v182, v182, v251
    v_add_f32 v183, v183, v251
    v_add_f32 v184, v184, v251
    v_add_f32 v185, v185, v251
    v_add_f32 v186, v186, v251
    v_add_f32 v187, v187, v251
    v_add_f32 v188, v188, v251
    v_add_f32 v189, v189, v251
    v_add_f32 v190, v190, v251
    v_add_f32 v191, v191, v251
    v_cmp_le_i32 s[86:87], 0, v248
    v_cmp_le_i32 s[88:89], 1, v248
    v_cmp_le_i32 s[90:91], 2, v248
    v_cmp_le_i32 s[92:93], 3, v248
    v_cndmask_b32 v176, v160, v176, s[86:87]
    v_cndmask_b32 v177, v161, v177, s[88:89]
    v_cndmask_b32 v178, v162, v178, s[90:91]
    v_cndmask_b32 v179, v163, v179, s[92:93]
    v_cndmask_b32 v80, 0, v253, s[86:87]
    v_cndmask_b32 v80, v80, -1, s[88:89]
    v_cndmask_b32 v81, 0, v253, s[90:91]
    v_cndmask_b32 v81, v81, -1, s[92:93]
    v_cmp_le_i32 s[86:87], 8, v248
    v_cmp_le_i32 s[88:89], 9, v248
    v_cmp_le_i32 s[90:91], 10, v248
    v_cmp_le_i32 s[92:93], 11, v248
    v_cndmask_b32 v180, v164, v180, s[86:87]
    v_cndmask_b32 v181, v165, v181, s[88:89]
    v_cndmask_b32 v182, v166, v182, s[90:91]
    v_cndmask_b32 v183, v167, v183, s[92:93]
    v_cndmask_b32 v82, 0, v253, s[86:87]
    v_cndmask_b32 v82, v82, -1, s[88:89]
    v_cndmask_b32 v83, 0, v253, s[90:91]
    v_cndmask_b32 v83, v83, -1, s[92:93]
    v_cmp_le_i32 s[86:87], 16, v248
    v_cmp_le_i32 s[88:89], 17, v248
    v_cmp_le_i32 s[90:91], 18, v248
    v_cmp_le_i32 s[92:93], 19, v248
    v_cndmask_b32 v184, v168, v184, s[86:87]
    v_cndmask_b32 v185, v169, v185, s[88:89]
    v_cndmask_b32 v186, v170, v186, s[90:91]
    v_cndmask_b32 v187, v171, v187, s[92:93]
    v_cndmask_b32 v92, 0, v253, s[86:87]
    v_cndmask_b32 v92, v92, -1, s[88:89]
    v_cndmask_b32 v93, 0, v253, s[90:91]
    v_cndmask_b32 v93, v93, -1, s[92:93]
    v_cmp_le_i32 s[86:87], 24, v248
    v_cmp_le_i32 s[88:89], 25, v248
    v_cmp_le_i32 s[90:91], 26, v248
    v_cmp_le_i32 s[92:93], 27, v248
    v_cndmask_b32 v188, v172, v188, s[86:87]
    v_cndmask_b32 v189, v173, v189, s[88:89]
    v_cndmask_b32 v190, v174, v190, s[90:91]
    v_cndmask_b32 v191, v175, v191, s[92:93]
    v_cndmask_b32 v94, 0, v253, s[86:87]
    v_cndmask_b32 v94, v94, -1, s[88:89]
    v_cndmask_b32 v95, 0, v253, s[90:91]
    v_cndmask_b32 v95, v95, -1, s[92:93]
    s_cmp_lg_u32 s74, 7
    s_cbranch_scc1 L_cs_82
    s_nop 7
    v_mov_b32 v144, v251
    v_mov_b32 v145, v251
    v_mov_b32 v146, v251
    v_mov_b32 v147, v251
    v_mov_b32 v148, v251
    v_mov_b32 v149, v251
    v_mov_b32 v150, v251
    v_mov_b32 v151, v251
    v_mov_b32 v152, v251
    v_mov_b32 v153, v251
    v_mov_b32 v154, v251
    v_mov_b32 v155, v251
    v_mov_b32 v156, v251
    v_mov_b32 v157, v251
    v_mov_b32 v158, v251
    v_mov_b32 v159, v251
    s_nop 1
L_cs_82:
    v_mfma_f32_32x32x16_bf16 v[160:175], v[108:111], v[140:143], v[144:159]
    v_exp_f32 v176, v176
    v_exp_f32 v177, v177
    v_exp_f32 v178, v178
    v_exp_f32 v179, v179
    v_exp_f32 v180, v180
    v_exp_f32 v181, v181
    v_exp_f32 v182, v182
    v_exp_f32 v183, v183
    v_exp_f32 v184, v184
    v_exp_f32 v185, v185
    v_exp_f32 v186, v186
    v_exp_f32 v187, v187
    v_exp_f32 v188, v188
    v_exp_f32 v189, v189
    v_exp_f32 v190, v190
    v_exp_f32 v191, v191
    v_cvt_pk_bf16_f32 v84, v176, v177
    v_cvt_pk_bf16_f32 v85, v178, v179
    v_cvt_pk_bf16_f32 v86, v180, v181
    v_cvt_pk_bf16_f32 v87, v182, v183
    v_cvt_pk_bf16_f32 v88, v184, v185
    v_cvt_pk_bf16_f32 v89, v186, v187
    v_cvt_pk_bf16_f32 v90, v188, v189
    v_cvt_pk_bf16_f32 v91, v190, v191
    v_and_b32 v104, v84, v80
    v_and_b32 v105, v85, v81
    v_and_b32 v106, v86, v82
    v_and_b32 v107, v87, v83
    v_and_b32 v136, v88, v92
    v_and_b32 v137, v89, v93
    v_and_b32 v138, v90, v94
    v_and_b32 v139, v91, v95
    v_xor_b32 v84, v84, v104
    v_xor_b32 v85, v85, v105
    v_xor_b32 v86, v86, v106
    v_xor_b32 v87, v87, v107
    v_xor_b32 v88, v88, v136
    v_xor_b32 v89, v89, v137
    v_xor_b32 v90, v90, v138
    v_xor_b32 v91, v91, v139
    v_exp_f32 v160, v160
    v_exp_f32 v161, v161
    s_waitcnt vmcnt(17)
    v_mfma_f32_32x32x16_bf16 v[216:231], v[192:195], v[84:87], 0
    v_exp_f32 v162, v162
    v_exp_f32 v163, v163
    v_exp_f32 v164, v164
    v_exp_f32 v165, v165
    v_mfma_f32_32x32x16_bf16 v[232:247], v[196:199], v[88:91], 0
    v_exp_f32 v166, v166
    v_exp_f32 v167, v167
    v_exp_f32 v168, v168
    v_exp_f32 v169, v169
    s_cmp_lg_u32 s74, 6
    s_cbranch_scc1 L_cs_83
    s_nop 7
    v_mov_b32 v144, v251
    v_mov_b32 v145, v251
    v_mov_b32 v146, v251
    v_mov_b32 v147, v251
    v_mov_b32 v148, v251
    v_mov_b32 v149, v251
    v_mov_b32 v150, v251
    v_mov_b32 v151, v251
    v_mov_b32 v152, v251
    v_mov_b32 v153, v251
    v_mov_b32 v154, v251
    v_mov_b32 v155, v251
    v_mov_b32 v156, v251
    v_mov_b32 v157, v251
    v_mov_b32 v158, v251
    v_mov_b32 v159, v251
    s_nop 1
L_cs_83:
    v_mfma_f32_32x32x16_bf16 v[176:191], v[112:115], v[140:143], v[144:159]
    v_exp_f32 v170, v170
    v_exp_f32 v171, v171
    v_exp_f32 v172, v172
    v_exp_f32 v173, v173
    s_waitcnt vmcnt(1)
    v_mfma_f32_32x32x16_bf16 v[216:231], v[72:75], v[104:107], v[216:231]
    v_exp_f32 v174, v174
    v_exp_f32 v175, v175
    v_cvt_pk_bf16_f32 v84, v160, v161
    v_cvt_pk_bf16_f32 v85, v162, v163
    v_cvt_pk_bf16_f32 v86, v164, v165
    v_cvt_pk_bf16_f32 v87, v166, v167
    v_cvt_pk_bf16_f32 v88, v168, v169
    v_cvt_pk_bf16_f32 v89, v170, v171
    v_cvt_pk_bf16_f32 v90, v172, v173
    v_cvt_pk_bf16_f32 v91, v174, v175
    v_exp_f32 v176, v176
    v_exp_f32 v177, v177
    v_mfma_f32_32x32x16_bf16 v[216:231], v[200:203], v[84:87], v[216:231]
    v_exp_f32 v178, v178
    v_exp_f32 v179, v179
    v_exp_f32 v180, v180
    v_exp_f32 v181, v181
    v_mfma_f32_32x32x16_bf16 v[232:247], v[204:207], v[88:91], v[232:247]
    v_exp_f32 v182, v182
    v_exp_f32 v183, v183
    v_exp_f32 v184, v184
    v_exp_f32 v185, v185
    s_cmp_lg_u32 s74, 5
    s_cbranch_scc1 L_cs_84
    s_nop 7
    v_mov_b32 v144, v251
    v_mov_b32 v145, v251
    v_mov_b32 v146, v251
    v_mov_b32 v147, v251
    v_mov_b32 v148, v251
    v_mov_b32 v149, v251
    v_mov_b32 v150, v251
    v_mov_b32 v151, v251
    v_mov_b32 v152, v251
    v_mov_b32 v153, v251
    v_mov_b32 v154, v251
    v_mov_b32 v155, v251
    v_mov_b32 v156, v251
    v_mov_b32 v157, v251
    v_mov_b32 v158, v251
    v_mov_b32 v159, v251
    s_nop 1
L_cs_84:
    v_mfma_f32_32x32x16_bf16 v[160:175], v[116:119], v[140:143], v[144:159]
    v_exp_f32 v186, v186
    v_exp_f32 v187, v187
    v_exp_f32 v188, v188
    v_exp_f32 v189, v189
    v_mfma_f32_32x32x16_bf16 v[232:247], v[76:79], v[136:139], v[232:247]
    v_exp_f32 v190, v190
    v_exp_f32 v191, v191
    v_cvt_pk_bf16_f32 v84, v176, v177
    v_cvt_pk_bf16_f32 v85, v178, v179
    v_cvt_pk_bf16_f32 v86, v180, v181
    v_cvt_pk_bf16_f32 v87, v182, v183
    v_cvt_pk_bf16_f32 v88, v184, v185
    v_cvt_pk_bf16_f32 v89, v186, v187
    v_cvt_pk_bf16_f32 v90, v188, v189
    v_cvt_pk_bf16_f32 v91, v190, v191
    v_exp_f32 v160, v160
    v_exp_f32 v161, v161
    v_mfma_f32_32x32x16_bf16 v[216:231], v[208:211], v[84:87], v[216:231]
    v_exp_f32 v162, v162
    v_exp_f32 v163, v163
    v_exp_f32 v164, v164
    v_exp_f32 v165, v165
    v_mfma_f32_32x32x16_bf16 v[232:247], v[212:215], v[88:91], v[232:247]
    s_lshl_b32 s59, s65, 8
    v_lshrrev_b32 v254, 2, v250
    v_add_u32 v254, s59, v254
    v_add_u32 v254, 0x1002000, v254
    buffer_load_dword v255, v254, s[32:35], 0 offen sc0 sc1
    v_exp_f32 v166, v166
    v_exp_f32 v167, v167
    v_exp_f32 v168, v168
    v_exp_f32 v169, v169
    s_cmp_lg_u32 s74, 4
    s_cbranch_scc1 L_cs_85
    s_nop 7
    v_mov_b32 v144, v251
    v_mov_b32 v145, v251
    v_mov_b32 v146, v251
    v_mov_b32 v147, v251
    v_mov_b32 v148, v251
    v_mov_b32 v149, v251
    v_mov_b32 v150, v251
    v_mov_b32 v151, v251
    v_mov_b32 v152, v251
    v_mov_b32 v153, v251
    v_mov_b32 v154, v251
    v_mov_b32 v155, v251
    v_mov_b32 v156, v251
    v_mov_b32 v157, v251
    v_mov_b32 v158, v251
    v_mov_b32 v159, v251
    s_nop 1
L_cs_85:
    v_mfma_f32_32x32x16_bf16 v[176:191], v[120:123], v[140:143], v[144:159]
    v_exp_f32 v170, v170
    v_exp_f32 v171, v171
    v_exp_f32 v172, v172
    v_exp_f32 v173, v173
    v_exp_f32 v174, v174
    v_exp_f32 v175, v175
    s_nop 0
    v_cvt_pk_bf16_f32 v84, v160, v161
    v_cvt_pk_bf16_f32 v85, v162, v163
    v_cvt_pk_bf16_f32 v86, v164, v165
    v_cvt_pk_bf16_f32 v87, v166, v167
    v_cvt_pk_bf16_f32 v88, v168, v169
    v_cvt_pk_bf16_f32 v89, v170, v171
    v_cvt_pk_bf16_f32 v90, v172, v173
    v_cvt_pk_bf16_f32 v91, v174, v175
    v_exp_f32 v176, v176
    v_exp_f32 v177, v177
    v_mfma_f32_32x32x16_bf16 v[216:231], v[32:35], v[84:87], v[216:231]
    v_exp_f32 v178, v178
    v_exp_f32 v179, v179
    v_exp_f32 v180, v180
    v_exp_f32 v181, v181
    v_mfma_f32_32x32x16_bf16 v[232:247], v[36:39], v[88:91], v[232:247]
    v_exp_f32 v182, v182
    v_exp_f32 v183, v183
    v_exp_f32 v184, v184
    v_exp_f32 v185, v185
    s_cmp_lg_u32 s74, 3
    s_cbranch_scc1 L_cs_86
    s_nop 7
    v_mov_b32 v144, v251
    v_mov_b32 v145, v251
    v_mov_b32 v146, v251
    v_mov_b32 v147, v251
    v_mov_b32 v148, v251
    v_mov_b32 v149, v251
    v_mov_b32 v150, v251
    v_mov_b32 v151, v251
    v_mov_b32 v152, v251
    v_mov_b32 v153, v251
    v_mov_b32 v154, v251
    v_mov_b32 v155, v251
    v_mov_b32 v156, v251
    v_mov_b32 v157, v251
    v_mov_b32 v158, v251
    v_mov_b32 v159, v251
    s_nop 1
L_cs_86:
    v_mfma_f32_32x32x16_bf16 v[160:175], v[124:127], v[140:143], v[144:159]
    v_exp_f32 v186, v186
    v_exp_f32 v187, v187
    v_exp_f32 v188, v188
    v_exp_f32 v189, v189
    v_exp_f32 v190, v190
    v_exp_f32 v191, v191
    v_cvt_pk_bf16_f32 v84, v176, v177
    v_cvt_pk_bf16_f32 v85, v178, v179
    v_cvt_pk_bf16_f32 v86, v180, v181
    v_cvt_pk_bf16_f32 v87, v182, v183
    v_cvt_pk_bf16_f32 v88, v184, v185
    v_cvt_pk_bf16_f32 v89, v186, v187
    v_cvt_pk_bf16_f32 v90, v188, v189
    v_cvt_pk_bf16_f32 v91, v190, v191
    v_exp_f32 v160, v160
    v_exp_f32 v161, v161
    v_mfma_f32_32x32x16_bf16 v[216:231], v[40:43], v[84:87], v[216:231]
    v_exp_f32 v162, v162
    v_exp_f32 v163, v163
    v_exp_f32 v164, v164
    v_exp_f32 v165, v165
    v_mfma_f32_32x32x16_bf16 v[232:247], v[44:47], v[88:91], v[232:247]
    s_waitcnt vmcnt(0)
    s_mov_b32 s55, 0
    s_nop 9
L_flr_87:
    v_cmp_ne_u32 vcc, s94, v255
    s_nop 4
    s_cbranch_vccz L_fld_88
    s_sleep 1
    buffer_load_dword v255, v254, s[32:35], 0 offen sc0 sc1
    s_waitcnt vmcnt(0)
    s_add_u32 s55, s55, 1
    s_cmp_lt_u32 s55, 0x100000
    s_cbranch_scc1 L_flr_87
L_fld_88:
    s_add_u32 s57, s69, 0x0
    s_nop 0
    buffer_load_dwordx4 v[32:35], v250, s[32:35], s57 offen offset:0 sc1
    buffer_load_dwordx4 v[36:39], v250, s[32:35], s57 offen offset:1024 sc1
    buffer_load_dwordx4 v[40:43], v250, s[32:35], s57 offen offset:2048 sc1
    buffer_load_dwordx4 v[44:47], v250, s[32:35], s57 offen offset:3072 sc1
    v_exp_f32 v166, v166
    v_exp_f32 v167, v167
    v_exp_f32 v168, v168
    v_exp_f32 v169, v169
    s_cmp_lg_u32 s74, 2
    s_cbranch_scc1 L_cs_89
    s_nop 7
    v_mov_b32 v144, v251
    v_mov_b32 v145, v251
    v_mov_b32 v146, v251
    v_mov_b32 v147, v251
    v_mov_b32 v148, v251
    v_mov_b32 v149, v251
    v_mov_b32 v150, v251
    v_mov_b32 v151, v251
    v_mov_b32 v152, v251
    v_mov_b32 v153, v251
    v_mov_b32 v154, v251
    v_mov_b32 v155, v251
    v_mov_b32 v156, v251
    v_mov_b32 v157, v251
    v_mov_b32 v158, v251
    v_mov_b32 v159, v251
    s_nop 1
L_cs_89:
    v_mfma_f32_32x32x16_bf16 v[176:191], v[128:131], v[140:143], v[144:159]
    v_exp_f32 v170, v170
    v_exp_f32 v171, v171
    v_exp_f32 v172, v172
    v_exp_f32 v173, v173
    v_exp_f32 v174, v174
    v_exp_f32 v175, v175
    v_cvt_pk_bf16_f32 v84, v160, v161
    v_cvt_pk_bf16_f32 v85, v162, v163
    v_cvt_pk_bf16_f32 v86, v164, v165
    v_cvt_pk_bf16_f32 v87, v166, v167
    v_cvt_pk_bf16_f32 v88, v168, v169
    v_cvt_pk_bf16_f32 v89, v170, v171
    v_cvt_pk_bf16_f32 v90, v172, v173
    v_cvt_pk_bf16_f32 v91, v174, v175
    v_exp_f32 v176, v176
    v_exp_f32 v177, v177
    v_mfma_f32_32x32x16_bf16 v[216:231], v[48:51], v[84:87], v[216:231]
    v_exp_f32 v178, v178
    v_exp_f32 v179, v179
    v_exp_f32 v180, v180
    v_exp_f32 v181, v181
    v_mfma_f32_32x32x16_bf16 v[232:247], v[52:55], v[88:91], v[232:247]
    v_exp_f32 v182, v182
    v_exp_f32 v183, v183
    v_exp_f32 v184, v184
    v_exp_f32 v185, v185
    s_cmp_lg_u32 s74, 1
    s_cbranch_scc1 L_cs_90
    s_nop 7
    v_mov_b32 v144, v251
    v_mov_b32 v145, v251
    v_mov_b32 v146, v251
    v_mov_b32 v147, v251
    v_mov_b32 v148, v251
    v_mov_b32 v149, v251
    v_mov_b32 v150, v251
    v_mov_b32 v151, v251
    v_mov_b32 v152, v251
    v_mov_b32 v153, v251
    v_mov_b32 v154, v251
    v_mov_b32 v155, v251
    v_mov_b32 v156, v251
    v_mov_b32 v157, v251
    v_mov_b32 v158, v251
    v_mov_b32 v159, v251
    s_nop 1
L_cs_90:
    v_mfma_f32_32x32x16_bf16 v[160:175], v[132:135], v[140:143], v[144:159]
    v_exp_f32 v186, v186
    v_exp_f32 v187, v187
    v_exp_f32 v188, v188
    v_exp_f32 v189, v189
    v_exp_f32 v190, v190
    v_exp_f32 v191, v191
    v_cvt_pk_bf16_f32 v84, v176, v177
    v_cvt_pk_bf16_f32 v85, v178, v179
    v_cvt_pk_bf16_f32 v86, v180, v181
    v_cvt_pk_bf16_f32 v87, v182, v183
    v_cvt_pk_bf16_f32 v88, v184, v185
    v_cvt_pk_bf16_f32 v89, v186, v187
    v_cvt_pk_bf16_f32 v90, v188, v189
    v_cvt_pk_bf16_f32 v91, v190, v191
    v_exp_f32 v160, v160
    v_exp_f32 v161, v161
    v_mfma_f32_32x32x16_bf16 v[216:231], v[56:59], v[84:87], v[216:231]
    v_exp_f32 v162, v162
    v_exp_f32 v163, v163
    v_exp_f32 v164, v164
    v_exp_f32 v165, v165
    v_mfma_f32_32x32x16_bf16 v[232:247], v[60:63], v[88:91], v[232:247]
    s_add_u32 s57, s69, 0x1000
    buffer_load_dwordx4 v[48:51], v250, s[32:35], s57 offen offset:0 sc1
    buffer_load_dwordx4 v[52:55], v250, s[32:35], s57 offen offset:1024 sc1
    buffer_load_dwordx4 v[56:59], v250, s[32:35], s57 offen offset:2048 sc1
    buffer_load_dwordx4 v[60:63], v250, s[32:35], s57 offen offset:3072 sc1
    v_exp_f32 v166, v166
    v_exp_f32 v167, v167
    v_exp_f32 v168, v168
    v_exp_f32 v169, v169
    v_exp_f32 v170, v170
    v_exp_f32 v171, v171
    v_exp_f32 v172, v172
    v_exp_f32 v173, v173
    v_exp_f32 v174, v174
    v_exp_f32 v175, v175
    v_cvt_pk_bf16_f32 v84, v160, v161
    v_cvt_pk_bf16_f32 v85, v162, v163
    v_cvt_pk_bf16_f32 v86, v164, v165
    v_cvt_pk_bf16_f32 v87, v166, v167
    v_cvt_pk_bf16_f32 v88, v168, v169
    v_cvt_pk_bf16_f32 v89, v170, v171
    v_cvt_pk_bf16_f32 v90, v172, v173
    v_cvt_pk_bf16_f32 v91, v174, v175
    v_mfma_f32_32x32x16_bf16 v[216:231], v[64:67], v[84:87], v[216:231]
    s_nop 0
    v_mfma_f32_32x32x16_bf16 v[232:247], v[68:71], v[88:91], v[232:247]
    s_mul_i32 s58, s74, 144
    s_add_u32 s58, s58, s75
    s_add_u32 s58, s58, 112
    s_lshl_b32 s58, s58, 10
    s_add_u32 s58, s58, 0x600000
    s_nop 6
    v_add_f32 v224, v224, v232
    v_rcp_f32 v224, v224
    v_add_f32 v216, v216, v240
    v_add_f32 v217, v217, v241
    v_add_f32 v218, v218, v242
    v_add_f32 v219, v219, v243
    v_add_f32 v220, v220, v244
    v_add_f32 v221, v221, v245
    v_add_f32 v222, v222, v246
    v_add_f32 v223, v223, v247
    v_mul_f32 v216, v216, v224
    v_mul_f32 v217, v217, v224
    v_mul_f32 v218, v218, v224
    v_mul_f32 v219, v219, v224
    v_mul_f32 v220, v220, v224
    v_mul_f32 v221, v221, v224
    v_mul_f32 v222, v222, v224
    v_mul_f32 v223, v223, v224
    v_cvt_pk_bf16_f32 v160, v216, v217
    v_cvt_pk_bf16_f32 v161, v218, v219
    v_cvt_pk_bf16_f32 v162, v220, v221
    v_cvt_pk_bf16_f32 v163, v222, v223
    buffer_store_dwordx4 v[160:163], v250, s[32:35], s58 offen sc1
    s_barrier
    s_nop 0
    s_add_u32 s57, s69, 0x2000
    buffer_load_dwordx4 v[64:67], v250, s[32:35], s57 offen offset:0 sc1
    buffer_load_dwordx4 v[68:71], v250, s[32:35], s57 offen offset:1024 sc1
    buffer_load_dwordx4 v[72:75], v250, s[32:35], s57 offen offset:2048 sc1
    buffer_load_dwordx4 v[76:79], v250, s[32:35], s57 offen offset:3072 sc1
    s_add_u32 s56, s71, 0x40000
    s_add_u32 m0, s73, 0x20000
    s_nop 0
    buffer_load_dwordx4 v252, s[20:23], s56 offen lds
    s_add_u32 s56, s71, 0x41000
    s_add_u32 m0, s73, 0x20400
    s_nop 0
    buffer_load_dwordx4 v252, s[20:23], s56 offen lds
    s_add_u32 s56, s71, 0x44000
    s_add_u32 m0, s73, 0x20800
    s_nop 0
    buffer_load_dwordx4 v252, s[20:23], s56 offen lds
    s_add_u32 s56, s71, 0x45000
    s_add_u32 m0, s73, 0x20c00
    s_nop 0
    buffer_load_dwordx4 v252, s[20:23], s56 offen lds
    ds_read_b64_tr_b16 v[80:81], v96 offset:0
    ds_read_b64_tr_b16 v[82:83], v96 offset:512
    ds_read_b64_tr_b16 v[84:85], v97 offset:0
    ds_read_b64_tr_b16 v[86:87], v97 offset:512
    ds_read_b64_tr_b16 v[88:89], v96 offset:2048
    ds_read_b64_tr_b16 v[90:91], v96 offset:2560
    ds_read_b64_tr_b16 v[92:93], v97 offset:2048
    ds_read_b64_tr_b16 v[94:95], v97 offset:2560
    s_waitcnt vmcnt(16)
    s_waitcnt lgkmcnt(6)
    v_mfma_f32_32x32x16_bf16 v[0:15], v[80:83], v[32:35], 0
    ds_read_b64_tr_b16 v[80:81], v96 offset:4096
    ds_read_b64_tr_b16 v[82:83], v96 offset:4608
    s_waitcnt lgkmcnt(6)
    v_mfma_f32_32x32x16_bf16 v[16:31], v[84:87], v[32:35], 0
    ds_read_b64_tr_b16 v[84:85], v97 offset:4096
    ds_read_b64_tr_b16 v[86:87], v97 offset:4608
    s_waitcnt vmcnt(15)
    s_waitcnt lgkmcnt(6)
    v_mfma_f32_32x32x16_bf16 v[0:15], v[88:91], v[36:39], v[0:15]
    ds_read_b64_tr_b16 v[88:89], v96 offset:6144
    ds_read_b64_tr_b16 v[90:91], v96 offset:6656
    s_waitcnt lgkmcnt(6)
    v_mfma_f32_32x32x16_bf16 v[16:31], v[92:95], v[36:39], v[16:31]
    ds_read_b64_tr_b16 v[92:93], v97 offset:6144
    ds_read_b64_tr_b16 v[94:95], v97 offset:6656
    s_waitcnt vmcnt(14)
    s_waitcnt lgkmcnt(6)
    v_mfma_f32_32x32x16_bf16 v[0:15], v[80:83], v[40:43], v[0:15]
    ds_read_b64_tr_b16 v[80:81], v96 offset:32768
    ds_read_b64_tr_b16 v[82:83], v96 offset:33280
    s_waitcnt lgkmcnt(6)
    v_mfma_f32_32x32x16_bf16 v[16:31], v[84:87], v[40:43], v[16:31]
    ds_read_b64_tr_b16 v[84:85], v97 offset:32768
    ds_read_b64_tr_b16 v[86:87], v97 offset:33280
    s_waitcnt vmcnt(13)
    s_waitcnt lgkmcnt(6)
    v_mfma_f32_32x32x16_bf16 v[0:15], v[88:91], v[44:47], v[0:15]
    ds_read_b64_tr_b16 v[88:89], v96 offset:34816
    ds_read_b64_tr_b16 v[90:91], v96 offset:35328
    s_waitcnt lgkmcnt(6)
    v_mfma_f32_32x32x16_bf16 v[16:31], v[92:95], v[44:47], v[16:31]
    s_waitcnt vmcnt(8)
    s_barrier
    s_cmp_lg_u32 s40, 0
    s_nop 8
    s_cbranch_scc1 L_nopub_91
    s_lshl_b32 s58, s41, 7
    s_add_u32 s58, s58, s95
    s_add_u32 s58, s58, 0x1001000
    v_mov_b32 v253, s94
    s_mov_b64 exec, 1
    buffer_store_dword v253, off, s[32:35], s58 sc0 sc1
    s_mov_b64 exec, -1
L_nopub_91:
    ds_read_b64_tr_b16 v[92:93], v97 offset:34816
    ds_read_b64_tr_b16 v[94:95], v97 offset:35328
    s_waitcnt lgkmcnt(6)
    s_nop 0
    v_mfma_f32_32x32x16_bf16 v[0:15], v[80:83], v[48:51], v[0:15]
    s_add_u32 s57, s69, 0x3000
    buffer_load_dwordx4 v[32:35], v250, s[32:35], s57 offen offset:0 sc1
    ds_read_b64_tr_b16 v[80:81], v96 offset:36864
    ds_read_b64_tr_b16 v[82:83], v96 offset:37376
    s_waitcnt lgkmcnt(6)
    v_mfma_f32_32x32x16_bf16 v[16:31], v[84:87], v[48:51], v[16:31]
    s_add_u32 s56, s71, 0x50000
    s_add_u32 m0, s73, 0x0
    s_nop 0
    buffer_load_dwordx4 v252, s[20:23], s56 offen lds
    ds_read_b64_tr_b16 v[84:85], v97 offset:36864
    ds_read_b64_tr_b16 v[86:87], v97 offset:37376
    s_waitcnt lgkmcnt(6)
    v_mfma_f32_32x32x16_bf16 v[0:15], v[88:91], v[52:55], v[0:15]
    buffer_load_dwordx4 v[36:39], v250, s[32:35], s57 offen offset:1024 sc1
    ds_read_b64_tr_b16 v[88:89], v96 offset:38912
    ds_read_b64_tr_b16 v[90:91], v96 offset:39424
    s_waitcnt lgkmcnt(6)
    v_mfma_f32_32x32x16_bf16 v[16:31], v[92:95], v[52:55], v[16:31]
    s_add_u32 s56, s71, 0x51000
    s_add_u32 m0, s73, 0x400
    s_nop 0
    buffer_load_dwordx4 v252, s[20:23], s56 offen lds
    ds_read_b64_tr_b16 v[92:93], v97 offset:38912
    ds_read_b64_tr_b16 v[94:95], v97 offset:39424
    s_waitcnt lgkmcnt(6)
    s_nop 0
    v_mfma_f32_32x32x16_bf16 v[0:15], v[80:83], v[56:59], v[0:15]
    buffer_load_dwordx4 v[40:43], v250, s[32:35], s57 offen offset:2048 sc1
    ds_read_b64_tr_b16 v[80:81], v98 offset:0
    ds_read_b64_tr_b16 v[82:83], v98 offset:512
    s_waitcnt lgkmcnt(6)
    v_mfma_f32_32x32x16_bf16 v[16:31], v[84:87], v[56:59], v[16:31]
    s_add_u32 s56, s71, 0x54000
    s_add_u32 m0, s73, 0x800
    s_nop 0
    buffer_load_dwordx4 v252, s[20:23], s56 offen lds
    ds_read_b64_tr_b16 v[84:85], v99 offset:0
    ds_read_b64_tr_b16 v[86:87], v99 offset:512
    s_waitcnt lgkmcnt(6)
    s_nop 0
    v_mfma_f32_32x32x16_bf16 v[0:15], v[88:91], v[60:63], v[0:15]
    buffer_load_dwordx4 v[44:47], v250, s[32:35], s57 offen offset:3072 sc1
    ds_read_b64_tr_b16 v[88:89], v98 offset:2048
    ds_read_b64_tr_b16 v[90:91], v98 offset:2560
    s_waitcnt lgkmcnt(6)
    v_mfma_f32_32x32x16_bf16 v[16:31], v[92:95], v[60:63], v[16:31]
    s_add_u32 s56, s71, 0x55000
    s_add_u32 m0, s73, 0xc00
    s_nop 0
    buffer_load_dwordx4 v252, s[20:23], s56 offen lds
    s_barrier
    ds_read_b64_tr_b16 v[92:93], v99 offset:2048
    ds_read_b64_tr_b16 v[94:95], v99 offset:2560
    s_waitcnt vmcnt(15)
    s_waitcnt lgkmcnt(6)
    s_nop 0
    v_mfma_f32_32x32x16_bf16 v[0:15], v[80:83], v[64:67], v[0:15]
    s_add_u32 s57, s69, 0x4000
    buffer_load_dwordx4 v[48:51], v250, s[32:35], s57 offen offset:0 sc1
    ds_read_b64_tr_b16 v[80:81], v98 offset:4096
    ds_read_b64_tr_b16 v[82:83], v98 offset:4608
    s_waitcnt lgkmcnt(6)
    v_mfma_f32_32x32x16_bf16 v[16:31], v[84:87], v[64:67], v[16:31]
    s_add_u32 s56, s71, 0x60000
    s_add_u32 m0, s73, 0x8000
    s_nop 0
    buffer_load_dwordx4 v252, s[20:23], s56 offen lds
    ds_read_b64_tr_b16 v[84:85], v99 offset:4096
    ds_read_b64_tr_b16 v[86:87], v99 offset:4608
    s_waitcnt vmcnt(16)
    s_waitcnt lgkmcnt(6)
    v_mfma_f32_32x32x16_bf16 v[0:15], v[88:91], v[68:71], v[0:15]
    buffer_load_dwordx4 v[52:55], v250, s[32:35], s57 offen offset:1024 sc1
    ds_read_b64_tr_b16 v[88:89], v98 offset:6144
    ds_read_b64_tr_b16 v[90:91], v98 offset:6656
    s_waitcnt lgkmcnt(6)
    v_mfma_f32_32x32x16_bf16 v[16:31], v[92:95], v[68:71], v[16:31]
    s_add_u32 s56, s71, 0x61000
    s_add_u32 m0, s73, 0x8400
    s_nop 0
    buffer_load_dwordx4 v252, s[20:23], s56 offen lds
    ds_read_b64_tr_b16 v[92:93], v99 offset:6144
    ds_read_b64_tr_b16 v[94:95], v99 offset:6656
    s_waitcnt vmcnt(17)
    s_waitcnt lgkmcnt(6)
    v_mfma_f32_32x32x16_bf16 v[0:15], v[80:83], v[72:75], v[0:15]
    buffer_load_dwordx4 v[56:59], v250, s[32:35], s57 offen offset:2048 sc1
    ds_read_b64_tr_b16 v[80:81], v98 offset:32768
    ds_read_b64_tr_b16 v[82:83], v98 offset:33280
    s_waitcnt lgkmcnt(6)
    v_mfma_f32_32x32x16_bf16 v[16:31], v[84:87], v[72:75], v[16:31]
    s_add_u32 s56, s71, 0x64000
    s_add_u32 m0, s73, 0x8800
    s_nop 0
    buffer_load_dwordx4 v252, s[20:23], s56 offen lds
    ds_read_b64_tr_b16 v[84:85], v99 offset:32768
    ds_read_b64_tr_b16 v[86:87], v99 offset:33280
    s_waitcnt vmcnt(18)
    s_waitcnt lgkmcnt(6)
    v_mfma_f32_32x32x16_bf16 v[0:15], v[88:91], v[76:79], v[0:15]
    buffer_load_dwordx4 v[60:63], v250, s[32:35], s57 offen offset:3072 sc1
    ds_read_b64_tr_b16 v[88:89], v98 offset:34816
    ds_read_b64_tr_b16 v[90:91], v98 offset:35328
    s_waitcnt lgkmcnt(6)
    v_mfma_f32_32x32x16_bf16 v[16:31], v[92:95], v[76:79], v[16:31]
    s_add_u32 s56, s71, 0x65000
    s_add_u32 m0, s73, 0x8c00
    s_nop 0
    buffer_load_dwordx4 v252, s[20:23], s56 offen lds
    s_waitcnt vmcnt(16)
    s_barrier
    ds_read_b64_tr_b16 v[92:93], v99 offset:34816
    ds_read_b64_tr_b16 v[94:95], v99 offset:35328
    s_waitcnt vmcnt(15)
    s_waitcnt lgkmcnt(6)
    v_mfma_f32_32x32x16_bf16 v[0:15], v[80:83], v[32:35], v[0:15]
    s_add_u32 s57, s69, 0x5000
    buffer_load_dwordx4 v[64:67], v250, s[32:35], s57 offen offset:0 sc1
    ds_read_b64_tr_b16 v[80:81], v98 offset:36864
    ds_read_b64_tr_b16 v[82:83], v98 offset:37376
    s_waitcnt lgkmcnt(6)
    v_mfma_f32_32x32x16_bf16 v[16:31], v[84:87], v[32:35], v[16:31]
    s_add_u32 s56, s72, 0x0
    s_add_u32 m0, s73, 0x10000
    s_nop 0
    buffer_load_dwordx4 v252, s[24:27], s56 offen lds
    ds_read_b64_tr_b16 v[84:85], v99 offset:36864
    ds_read_b64_tr_b16 v[86:87], v99 offset:37376
    s_waitcnt vmcnt(15)
    s_waitcnt lgkmcnt(6)
    s_nop 0
    v_mfma_f32_32x32x16_bf16 v[0:15], v[88:91], v[36:39], v[0:15]
    buffer_load_dwordx4 v[68:71], v250, s[32:35], s57 offen offset:1024 sc1
    ds_read_b64_tr_b16 v[88:89], v98 offset:38912
    ds_read_b64_tr_b16 v[90:91], v98 offset:39424
    s_waitcnt lgkmcnt(6)
    v_mfma_f32_32x32x16_bf16 v[16:31], v[92:95], v[36:39], v[16:31]
    s_add_u32 s56, s72, 0x1000
    s_add_u32 m0, s73, 0x10400
    s_nop 0
    buffer_load_dwordx4 v252, s[24:27], s56 offen lds
    ds_read_b64_tr_b16 v[92:93], v99 offset:38912
    ds_read_b64_tr_b16 v[94:95], v99 offset:39424
    s_waitcnt vmcnt(15)
    s_waitcnt lgkmcnt(6)
    v_mfma_f32_32x32x16_bf16 v[0:15], v[80:83], v[40:43], v[0:15]
    buffer_load_dwordx4 v[72:75], v250, s[32:35], s57 offen offset:2048 sc1
    ds_read_b64_tr_b16 v[80:81], v100 offset:0
    ds_read_b64_tr_b16 v[82:83], v100 offset:512
    s_waitcnt lgkmcnt(6)
    v_mfma_f32_32x32x16_bf16 v[16:31], v[84:87], v[40:43], v[16:31]
    s_add_u32 s56, s72, 0x4000
    s_add_u32 m0, s73, 0x10800
    s_nop 0
    buffer_load_dwordx4 v252, s[24:27], s56 offen lds
    ds_read_b64_tr_b16 v[84:85], v101 offset:0
    ds_read_b64_tr_b16 v[86:87], v101 offset:512
    s_waitcnt vmcnt(15)
    s_waitcnt lgkmcnt(6)
    v_mfma_f32_32x32x16_bf16 v[0:15], v[88:91], v[44:47], v[0:15]
    buffer_load_dwordx4 v[76:79], v250, s[32:35], s57 offen offset:3072 sc1
    ds_read_b64_tr_b16 v[88:89], v100 offset:2048
    ds_read_b64_tr_b16 v[90:91], v100 offset:2560
    s_waitcnt lgkmcnt(6)
    v_mfma_f32_32x32x16_bf16 v[16:31], v[92:95], v[44:47], v[16:31]
    s_add_u32 s56, s72, 0x5000
    s_add_u32 m0, s73, 0x10c00
    s_nop 0
    buffer_load_dwordx4 v252, s[24:27], s56 offen lds
    s_waitcnt vmcnt(16)
    s_barrier
    ds_read_b64_tr_b16 v[92:93], v101 offset:2048
    ds_read_b64_tr_b16 v[94:95], v101 offset:2560
    s_waitcnt vmcnt(15)
    s_waitcnt lgkmcnt(6)
    v_mfma_f32_32x32x16_bf16 v[0:15], v[80:83], v[48:51], v[0:15]
    s_add_u32 s57, s69, 0x6000
    buffer_load_dwordx4 v[32:35], v250, s[32:35], s57 offen offset:0 sc1
    ds_read_b64_tr_b16 v[80:81], v100 offset:4096
    ds_read_b64_tr_b16 v[82:83], v100 offset:4608
    s_waitcnt lgkmcnt(6)
    v_mfma_f32_32x32x16_bf16 v[16:31], v[84:87], v[48:51], v[16:31]
    s_add_u32 s56, s72, 0x10000
    s_add_u32 m0, s73, 0x18000
    s_nop 0
    buffer_load_dwordx4 v252, s[24:27], s56 offen lds
    ds_read_b64_tr_b16 v[84:85], v101 offset:4096
    ds_read_b64_tr_b16 v[86:87], v101 offset:4608
    s_waitcnt vmcnt(15)
    s_waitcnt lgkmcnt(6)
    v_mfma_f32_32x32x16_bf16 v[0:15], v[88:91], v[52:55], v[0:15]
    buffer_load_dwordx4 v[36:39], v250, s[32:35], s57 offen offset:1024 sc1
    ds_read_b64_tr_b16 v[88:89], v100 offset:6144
    ds_read_b64_tr_b16 v[90:91], v100 offset:6656
    s_waitcnt lgkmcnt(6)
    v_mfma_f32_32x32x16_bf16 v[16:31], v[92:95], v[52:55], v[16:31]
    s_add_u32 s56, s72, 0x11000
    s_add_u32 m0, s73, 0x18400
    s_nop 0
    buffer_load_dwordx4 v252, s[24:27], s56 offen lds
    ds_read_b64_tr_b16 v[92:93], v101 offset:6144
    ds_read_b64_tr_b16 v[94:95], v101 offset:6656
    s_waitcnt vmcnt(15)
    s_waitcnt lgkmcnt(6)
    v_mfma_f32_32x32x16_bf16 v[0:15], v[80:83], v[56:59], v[0:15]
    buffer_load_dwordx4 v[40:43], v250, s[32:35], s57 offen offset:2048 sc1
    ds_read_b64_tr_b16 v[80:81], v96 offset:0
    ds_read_b64_tr_b16 v[82:83], v96 offset:512
    s_waitcnt lgkmcnt(6)
    v_mfma_f32_32x32x16_bf16 v[16:31], v[84:87], v[56:59], v[16:31]
    s_add_u32 s56, s72, 0x14000
    s_add_u32 m0, s73, 0x18800
    s_nop 0
    buffer_load_dwordx4 v252, s[24:27], s56 offen lds
    ds_read_b64_tr_b16 v[84:85], v97 offset:0
    ds_read_b64_tr_b16 v[86:87], v97 offset:512
    s_waitcnt vmcnt(15)
    s_waitcnt lgkmcnt(6)
    v_mfma_f32_32x32x16_bf16 v[0:15], v[88:91], v[60:63], v[0:15]
    buffer_load_dwordx4 v[44:47], v250, s[32:35], s57 offen offset:3072 sc1
    ds_read_b64_tr_b16 v[88:89], v96 offset:2048
    ds_read_b64_tr_b16 v[90:91], v96 offset:2560
    s_waitcnt lgkmcnt(6)
    v_mfma_f32_32x32x16_bf16 v[16:31], v[92:95], v[60:63], v[16:31]
    s_add_u32 s56, s72, 0x15000
    s_add_u32 m0, s73, 0x18c00
    s_nop 0
    buffer_load_dwordx4 v252, s[24:27], s56 offen lds
    s_waitcnt vmcnt(16)
    s_barrier
    s_lshr_b32 s59, s65, 1
    v_lshrrev_b32 v255, 8, v250
    v_min_u32 v255, 0, v255
    v_sub_u32 v255, s59, v255
    v_max_i32 v255, 0, v255
    v_bfe_u32 v254, v250, 4, 4
    v_lshlrev_b32 v254, 2, v254
    v_lshl_add_u32 v254, v255, 7, v254
    v_add_u32 v254, 0x1001000, v254
    buffer_load_dword v255, v254, s[32:35], 0 offen sc0 sc1
    ds_read_b64_tr_b16 v[92:93], v97 offset:2048
    ds_read_b64_tr_b16 v[94:95], v97 offset:2560
    s_waitcnt vmcnt(16)
    s_waitcnt lgkmcnt(6)
    v_mfma_f32_32x32x16_bf16 v[0:15], v[80:83], v[64:67], v[0:15]
    ds_read_b64_tr_b16 v[80:81], v96 offset:4096
    ds_read_b64_tr_b16 v[82:83], v96 offset:4608
    s_waitcnt lgkmcnt(6)
    v_mfma_f32_32x32x16_bf16 v[16:31], v[84:87], v[64:67], v[16:31]
    ds_read_b64_tr_b16 v[84:85], v97 offset:4096
    ds_read_b64_tr_b16 v[86:87], v97 offset:4608
    s_waitcnt vmcnt(14)
    s_waitcnt lgkmcnt(6)
    v_mfma_f32_32x32x16_bf16 v[0:15], v[88:91], v[68:71], v[0:15]
    ds_read_b64_tr_b16 v[88:89], v96 offset:6144
    ds_read_b64_tr_b16 v[90:91], v96 offset:6656
    s_waitcnt lgkmcnt(6)
    v_mfma_f32_32x32x16_bf16 v[16:31], v[92:95], v[68:71], v[16:31]
    ds_read_b64_tr_b16 v[92:93], v97 offset:6144
    ds_read_b64_tr_b16 v[94:95], v97 offset:6656
    s_waitcnt vmcnt(12)
    s_waitcnt lgkmcnt(6)
    v_mfma_f32_32x32x16_bf16 v[0:15], v[80:83], v[72:75], v[0:15]
    ds_read_b64_tr_b16 v[80:81], v96 offset:32768
    ds_read_b64_tr_b16 v[82:83], v96 offset:33280
    s_waitcnt lgkmcnt(6)
    v_mfma_f32_32x32x16_bf16 v[16:31], v[84:87], v[72:75], v[16:31]
    ds_read_b64_tr_b16 v[84:85], v97 offset:32768
    ds_read_b64_tr_b16 v[86:87], v97 offset:33280
    s_waitcnt vmcnt(10)
    s_waitcnt lgkmcnt(6)
    v_mfma_f32_32x32x16_bf16 v[0:15], v[88:91], v[76:79], v[0:15]
    ds_read_b64_tr_b16 v[88:89], v96 offset:34816
    ds_read_b64_tr_b16 v[90:91], v96 offset:35328
    s_waitcnt lgkmcnt(6)
    v_mfma_f32_32x32x16_bf16 v[16:31], v[92:95], v[76:79], v[16:31]
    s_waitcnt vmcnt(9)
    s_barrier
    s_waitcnt vmcnt(0)
    s_mov_b32 s55, 0
    s_nop 7
L_flr_92:
    v_cmp_ne_u32 vcc, s94, v255
    s_nop 4
    s_cbranch_vccz L_fld_93
    s_sleep 1
    buffer_load_dword v255, v254, s[32:35], 0 offen sc0 sc1
    s_waitcnt vmcnt(0)
    s_add_u32 s55, s55, 1
    s_cmp_lt_u32 s55, 0x100000
    s_cbranch_scc1 L_flr_92
L_fld_93:
    ds_read_b64_tr_b16 v[92:93], v97 offset:34816
    ds_read_b64_tr_b16 v[94:95], v97 offset:35328
    s_waitcnt lgkmcnt(6)
    v_mfma_f32_32x32x16_bf16 v[0:15], v[80:83], v[32:35], v[0:15]
    s_add_u32 s57, s70, 0x0
    buffer_load_dwordx4 v[48:51], v250, s[32:35], s57 offen offset:0 sc1
    ds_read_b64_tr_b16 v[80:81], v96 offset:36864
    ds_read_b64_tr_b16 v[82:83], v96 offset:37376
    s_waitcnt lgkmcnt(6)
    s_nop 0
    v_mfma_f32_32x32x16_bf16 v[16:31], v[84:87], v[32:35], v[16:31]
    buffer_load_dwordx4 v[52:55], v250, s[32:35], s57 offen offset:1024 sc1
    ds_read_b64_tr_b16 v[84:85], v97 offset:36864
    ds_read_b64_tr_b16 v[86:87], v97 offset:37376
    s_waitcnt lgkmcnt(6)
    s_nop 0
    v_mfma_f32_32x32x16_bf16 v[0:15], v[88:91], v[36:39], v[0:15]
    buffer_load_dwordx4 v[56:59], v250, s[32:35], s57 offen offset:2048 sc1
    ds_read_b64_tr_b16 v[88:89], v96 offset:38912
    ds_read_b64_tr_b16 v[90:91], v96 offset:39424
    s_waitcnt lgkmcnt(6)
    s_nop 0
    v_mfma_f32_32x32x16_bf16 v[16:31], v[92:95], v[36:39], v[16:31]
    buffer_load_dwordx4 v[60:63], v250, s[32:35], s57 offen offset:3072 sc1
    ds_read_b64_tr_b16 v[92:93], v97 offset:38912
    ds_read_b64_tr_b16 v[94:95], v97 offset:39424
    s_waitcnt lgkmcnt(6)
    s_nop 0
    v_mfma_f32_32x32x16_bf16 v[0:15], v[80:83], v[40:43], v[0:15]
    s_add_u32 s57, s70, 0x1000
    buffer_load_dwordx4 v[64:67], v250, s[32:35], s57 offen offset:0 sc1
    ds_read_b64_tr_b16 v[80:81], v98 offset:0
    ds_read_b64_tr_b16 v[82:83], v98 offset:512
    s_waitcnt lgkmcnt(6)
    s_nop 0
    v_mfma_f32_32x32x16_bf16 v[16:31], v[84:87], v[40:43], v[16:31]
    buffer_load_dwordx4 v[68:71], v250, s[32:35], s57 offen offset:1024 sc1
    ds_read_b64_tr_b16 v[84:85], v99 offset:0
    ds_read_b64_tr_b16 v[86:87], v99 offset:512
    s_waitcnt lgkmcnt(6)
    s_nop 0
    v_mfma_f32_32x32x16_bf16 v[0:15], v[88:91], v[44:47], v[0:15]
    buffer_load_dwordx4 v[72:75], v250, s[32:35], s57 offen offset:2048 sc1
    ds_read_b64_tr_b16 v[88:89], v98 offset:2048
    ds_read_b64_tr_b16 v[90:91], v98 offset:2560
    s_waitcnt lgkmcnt(6)
    v_mfma_f32_32x32x16_bf16 v[16:31], v[92:95], v[44:47], v[16:31]
    buffer_load_dwordx4 v[76:79], v250, s[32:35], s57 offen offset:3072 sc1
    s_barrier
    s_or_b32 s58, s2, s40
    s_cmp_lg_u32 s58, 0
    s_nop 7
    s_cbranch_scc1 L_noec_94
    v_lshrrev_b32 v148, 8, v250
    v_lshlrev_b32 v148, 7, v148
    v_bfe_u32 v149, v250, 4, 4
    v_lshl_add_u32 v148, v149, 2, v148
    v_add_u32 v148, 0x1001000, v148
    buffer_load_dword v149, v148, s[32:35], 0 offen offset:0 sc0 sc1
    buffer_load_dword v150, v148, s[32:35], 0 offen offset:512 sc0 sc1
    buffer_load_dword v151, v148, s[32:35], 0 offen offset:1024 sc0 sc1
    buffer_load_dword v152, v148, s[32:35], 0 offen offset:1536 sc0 sc1
L_noec_94:
    ds_read_b64_tr_b16 v[92:93], v99 offset:2048
    ds_read_b64_tr_b16 v[94:95], v99 offset:2560
    s_waitcnt vmcnt(7)
    s_waitcnt lgkmcnt(6)
    v_mfma_f32_32x32x16_bf16 v[0:15], v[80:83], v[48:51], v[0:15]
    buffer_load_dwordx4 v[104:107], v102, s[4:7], 0 offen
    ds_read_b64_tr_b16 v[80:81], v98 offset:4096
    ds_read_b64_tr_b16 v[82:83], v98 offset:4608
    s_waitcnt lgkmcnt(6)
    v_mfma_f32_32x32x16_bf16 v[16:31], v[84:87], v[48:51], v[16:31]
    ds_read_b64_tr_b16 v[84:85], v99 offset:4096
    ds_read_b64_tr_b16 v[86:87], v99 offset:4608
    s_waitcnt vmcnt(7)
    s_waitcnt lgkmcnt(6)
    v_mfma_f32_32x32x16_bf16 v[0:15], v[88:91], v[52:55], v[0:15]
    ds_read_b64_tr_b16 v[88:89], v98 offset:6144
    ds_read_b64_tr_b16 v[90:91], v98 offset:6656
    s_waitcnt lgkmcnt(6)
    v_mfma_f32_32x32x16_bf16 v[16:31], v[92:95], v[52:55], v[16:31]
    ds_read_b64_tr_b16 v[92:93], v99 offset:6144
    ds_read_b64_tr_b16 v[94:95], v99 offset:6656
    s_waitcnt vmcnt(6)
    s_waitcnt lgkmcnt(6)
    v_mfma_f32_32x32x16_bf16 v[0:15], v[80:83], v[56:59], v[0:15]
    ds_read_b64_tr_b16 v[80:81], v98 offset:32768
    ds_read_b64_tr_b16 v[82:83], v98 offset:33280
    s_waitcnt lgkmcnt(6)
    v_mfma_f32_32x32x16_bf16 v[16:31], v[84:87], v[56:59], v[16:31]
    ds_read_b64_tr_b16 v[84:85], v99 offset:32768
    ds_read_b64_tr_b16 v[86:87], v99 offset:33280
    s_waitcnt vmcnt(5)
    s_waitcnt lgkmcnt(6)
    v_mfma_f32_32x32x16_bf16 v[0:15], v[88:91], v[60:63], v[0:15]
    ds_read_b64_tr_b16 v[88:89], v98 offset:34816
    ds_read_b64_tr_b16 v[90:91], v98 offset:35328
    s_waitcnt lgkmcnt(6)
    v_mfma_f32_32x32x16_bf16 v[16:31], v[92:95], v[60:63], v[16:31]
    s_barrier
    ds_read_b64_tr_b16 v[92:93], v99 offset:34816
    ds_read_b64_tr_b16 v[94:95], v99 offset:35328
    s_waitcnt vmcnt(4)
    s_waitcnt lgkmcnt(6)
    v_mfma_f32_32x32x16_bf16 v[0:15], v[80:83], v[64:67], v[0:15]
    ds_read_b64_tr_b16 v[80:81], v98 offset:36864
    ds_read_b64_tr_b16 v[82:83], v98 offset:37376
    s_waitcnt lgkmcnt(6)
    v_mfma_f32_32x32x16_bf16 v[16:31], v[84:87], v[64:67], v[16:31]
    ds_read_b64_tr_b16 v[84:85], v99 offset:36864
    ds_read_b64_tr_b16 v[86:87], v99 offset:37376
    s_waitcnt vmcnt(3)
    s_waitcnt lgkmcnt(6)
    v_mfma_f32_32x32x16_bf16 v[0:15], v[88:91], v[68:71], v[0:15]
    ds_read_b64_tr_b16 v[88:89], v98 offset:38912
    ds_read_b64_tr_b16 v[90:91], v98 offset:39424
    s_waitcnt lgkmcnt(6)
    v_mfma_f32_32x32x16_bf16 v[16:31], v[92:95], v[68:71], v[16:31]
    ds_read_b64_tr_b16 v[92:93], v99 offset:38912
    ds_read_b64_tr_b16 v[94:95], v99 offset:39424
    s_waitcnt vmcnt(2)
    s_waitcnt lgkmcnt(6)
    v_mfma_f32_32x32x16_bf16 v[0:15], v[80:83], v[72:75], v[0:15]
    s_waitcnt lgkmcnt(4)
    v_mfma_f32_32x32x16_bf16 v[16:31], v[84:87], v[72:75], v[16:31]
    s_waitcnt vmcnt(1)
    s_waitcnt lgkmcnt(2)
    v_mfma_f32_32x32x16_bf16 v[0:15], v[88:91], v[76:79], v[0:15]
    s_waitcnt lgkmcnt(0)
    v_mfma_f32_32x32x16_bf16 v[16:31], v[92:95], v[76:79], v[16:31]
    s_mul_i32 s56, s68, 24576
    s_add_u32 s56, s56, 0
    v_add_u32 v80, s56, v250
    s_cmp_eq_u32 s67, 1
    s_nop 7
    s_cbranch_scc1 L_red1_96
    s_cmp_eq_u32 s67, 2
    s_cbranch_scc1 L_red2_97
    s_cmp_eq_u32 s67, 3
    s_cbranch_scc1 L_red3_98
    ds_write_b128 v80, v[8:11] offset:10240
    ds_write_b128 v80, v[12:15] offset:11264
    ds_write_b128 v80, v[16:19] offset:14336
    ds_write_b128 v80, v[20:23] offset:15360
    ds_write_b128 v80, v[24:27] offset:18432
    ds_write_b128 v80, v[28:31] offset:19456
    v_mov_b32 v64, v0
    v_mov_b32 v65, v1
    v_mov_b32 v66, v2
    v_mov_b32 v67, v3
    v_mov_b32 v68, v4
    v_mov_b32 v69, v5
    v_mov_b32 v70, v6
    v_mov_b32 v71, v7
    s_nop 2
    s_branch L_rede_99
L_red1_96:
    ds_write_b128 v80, v[0:3] offset:0
    ds_write_b128 v80, v[4:7] offset:1024
    ds_write_b128 v80, v[16:19] offset:16384
    ds_write_b128 v80, v[20:23] offset:17408
    ds_write_b128 v80, v[24:27] offset:20480
    ds_write_b128 v80, v[28:31] offset:21504
    v_mov_b32 v64, v8
    v_mov_b32 v65, v9
    v_mov_b32 v66, v10
    v_mov_b32 v67, v11
    v_mov_b32 v68, v12
    v_mov_b32 v69, v13
    v_mov_b32 v70, v14
    v_mov_b32 v71, v15
    s_nop 2
    s_branch L_rede_99
L_red2_97:
    ds_write_b128 v80, v[0:3] offset:2048
    ds_write_b128 v80, v[4:7] offset:3072
    ds_write_b128 v80, v[8:11] offset:6144
    ds_write_b128 v80, v[12:15] offset:7168
    ds_write_b128 v80, v[24:27] offset:22528
    ds_write_b128 v80, v[28:31] offset:23552
    v_mov_b32 v64, v16
    v_mov_b32 v65, v17
    v_mov_b32 v66, v18
    v_mov_b32 v67, v19
    v_mov_b32 v68, v20
    v_mov_b32 v69, v21
    v_mov_b32 v70, v22
    v_mov_b32 v71, v23
    s_nop 2
    s_branch L_rede_99
L_red3_98:
    ds_write_b128 v80, v[0:3] offset:4096
    ds_write_b128 v80, v[4:7] offset:5120
    ds_write_b128 v80, v[8:11] offset:8192
    ds_write_b128 v80, v[12:15] offset:9216
    ds_write_b128 v80, v[16:19] offset:12288
    ds_write_b128 v80, v[20:23] offset:13312
    v_mov_b32 v64, v24
    v_mov_b32 v65, v25
    v_mov_b32 v66, v26
    v_mov_b32 v67, v27
    v_mov_b32 v68, v28
    v_mov_b32 v69, v29
    v_mov_b32 v70, v30
    v_mov_b32 v71, v31
    s_nop 2
L_rede_99:
    s_mul_i32 s56, s67, 6144
    v_add_u32 v80, s56, v80
    s_waitcnt lgkmcnt(0)
    s_barrier
    ds_read_b128 v[32:35], v80 offset:0
    ds_read_b128 v[36:39], v80 offset:1024
    ds_read_b128 v[40:43], v80 offset:2048
    ds_read_b128 v[44:47], v80 offset:3072
    ds_read_b128 v[48:51], v80 offset:4096
    ds_read_b128 v[52:55], v80 offset:5120
    s_waitcnt lgkmcnt(4)
    v_add_f32 v64, v64, v32
    v_add_f32 v65, v65, v33
    v_add_f32 v66, v66, v34
    v_add_f32 v67, v67, v35
    v_add_f32 v68, v68, v36
    v_add_f32 v69, v69, v37
    v_add_f32 v70, v70, v38
    v_add_f32 v71, v71, v39
    s_waitcnt lgkmcnt(2)
    v_add_f32 v64, v64, v40
    v_add_f32 v65, v65, v41
    v_add_f32 v66, v66, v42
    v_add_f32 v67, v67, v43
    v_add_f32 v68, v68, v44
    v_add_f32 v69, v69, v45
    v_add_f32 v70, v70, v46
    v_add_f32 v71, v71, v47
    s_waitcnt lgkmcnt(0)
    v_add_f32 v64, v64, v48
    v_add_f32 v65, v65, v49
    v_add_f32 v66, v66, v50
    v_add_f32 v67, v67, v51
    v_add_f32 v68, v68, v52
    v_add_f32 v69, v69, v53
    v_add_f32 v70, v70, v54
    v_add_f32 v71, v71, v55
    v_permlane32_swap_b32 v64, v68
    v_permlane32_swap_b32 v65, v69
    v_permlane32_swap_b32 v66, v70
    v_permlane32_swap_b32 v67, v71
    s_waitcnt vmcnt(0)
    v_lshlrev_b32 v32, 16, v104
    v_and_b32 v33, s61, v104
    v_lshlrev_b32 v34, 16, v105
    v_and_b32 v35, s61, v105
    v_lshlrev_b32 v36, 16, v106
    v_and_b32 v37, s61, v106
    v_lshlrev_b32 v38, 16, v107
    v_and_b32 v39, s61, v107
    v_add_f32 v64, v64, v32
    v_add_f32 v65, v65, v33
    v_add_f32 v66, v66, v34
    v_add_f32 v67, v67, v35
    v_add_f32 v68, v68, v36
    v_add_f32 v69, v69, v37
    v_add_f32 v70, v70, v38
    v_add_f32 v71, v71, v39
    v_cvt_pk_bf16_f32 v40, v64, v65
    v_cvt_pk_bf16_f32 v41, v66, v67
    v_cvt_pk_bf16_f32 v42, v68, v69
    v_cvt_pk_bf16_f32 v43, v70, v71
    buffer_store_dwordx4 v[40:43], v102, s[28:31], 0 offen
    s_or_b32 s58, s2, s40
    s_cmp_lg_u32 s58, 0
    s_cbranch_scc1 L_noclr_100
    s_mov_b32 s55, 0
L_ecr_101:
    v_xor_b32 v149, s94, v149
    v_xor_b32 v150, s94, v150
    v_xor_b32 v151, s94, v151
    v_xor_b32 v152, s94, v152
    v_or_b32 v149, v149, v150
    v_or_b32 v151, v151, v152
    v_or_b32 v149, v149, v151
    v_cmp_ne_u32 vcc, 0, v149
    s_nop 4
    s_cbranch_vccz L_ecc_102
    s_sleep 4
    v_lshrrev_b32 v148, 8, v250
    v_lshlrev_b32 v148, 7, v148
    s_nop 0
    v_bfe_u32 v149, v250, 4, 4
    v_lshl_add_u32 v148, v149, 2, v148
    v_add_u32 v148, 0x1001000, v148
    buffer_load_dword v149, v148, s[32:35], 0 offen offset:0 sc0 sc1
    buffer_load_dword v150, v148, s[32:35], 0 offen offset:512 sc0 sc1
    buffer_load_dword v151, v148, s[32:35], 0 offen offset:1024 sc0 sc1
    buffer_load_dword v152, v148, s[32:35], 0 offen offset:1536 sc0 sc1
    s_waitcnt vmcnt(0)
    s_add_u32 s55, s55, 1
    s_cmp_lt_u32 s55, 0x100000
    s_cbranch_scc1 L_ecr_101
L_ecc_102:
    v_mov_b32 v148, 0
    buffer_store_dword v148, off, s[36:39], 0 sc0 sc1
    s_nop 1
L_noclr_100:
L_end:
    s_endpgm
L_kend:
.section .rodata,"a"
.p2align 6
.amdhsa_kernel parallel_sum__sliding_block__glu_gated_geglu__prompt_kernel
  .amdhsa_next_free_vgpr 256
  .amdhsa_next_free_sgpr 102
  .amdhsa_accum_offset 256
  .amdhsa_group_segment_fixed_size 0
  .amdhsa_kernarg_size 80
  .amdhsa_user_sgpr_count 2
  .amdhsa_user_sgpr_kernarg_segment_ptr 1
  .amdhsa_system_sgpr_workgroup_id_x 1
.end_amdhsa_kernel
```
